```python
import torch

def _softmax(x, axis=-1):
    return torch.softmax(x, dim=axis)

def _gelu(x):
    return torch.nn.functional.gelu(x, approximate='tanh')

def _silu(x):
    return torch.nn.functional.silu(x)

def _sigmoid(x):
    return torch.sigmoid(x)

def _layernorm(x, axis=-1, eps=1e-05):
    m = x.mean(dim=axis, keepdim=True)
    v = x.var(dim=axis, keepdim=True, unbiased=False)
    return (x - m) / torch.sqrt(v + eps)

def _scatter_add(tgt, idx, src, axis=0):
    return tgt.clone().index_add_(axis, idx, src)

def _segment_sum(src, seg, n):
    out = torch.zeros((n,) + src.shape[1:], dtype=src.dtype)
    return out.index_add_(0, seg, src)

def _pad(x, pw):
    flat = tuple((v for pair in reversed(pw) for v in pair))
    return torch.nn.functional.pad(x, flat)
kernel_name = 'standalone__swin_window_attn__vision'

def setup_inputs():

    _w = lambda a: (lambda t: t.to(torch.bfloat16) if t.is_floating_point() else t)(torch.as_tensor(a))
    H = W = 256 // 7 * 7
    C, win = (384, 7)
    return {'x': _w((lambda *s: torch.randn(*s, dtype=torch.bfloat16) * 0.2)(1, H, W, C)), 'wqkv': _w((lambda *s: torch.randn(*s, dtype=torch.bfloat16) * 0.2)(C, 3 * C)), 'wo': _w((lambda *s: torch.randn(*s, dtype=torch.bfloat16) * 0.05)(C, C))}

def reference(x, wqkv, wo):
    B, H, W, C = x.shape
    win = 7
    nh, nw = (H // win, W // win)
    xw = (lambda x, *d: x.permute(*d))(x.reshape(B, nh, win, nw, win, C), 0, 1, 3, 2, 4, 5)
    xw = xw.reshape(B * nh * nw, win * win, C)
    qkv = xw @ wqkv
    q, k, v = (qkv[..., :C].clone(), qkv[..., C:2 * C].clone(), qkv[..., 2 * C:].clone())
    scale = C ** (-0.5)
    p = _softmax(torch.einsum('bqc,bkc->bqk', q, k) * scale, axis=-1)
    o = torch.einsum('bqk,bkc->bqc', p, v) @ wo
    o = (lambda x, *d: x.permute(*d))(o.reshape(B, nh, nw, win, win, C), 0, 1, 3, 2, 4, 5)
    return o.reshape(B, H, W, C)
```

```asm
; @launch grid=(256,1,1) block=(256,1,1) lds=163840
.amdgcn_target "amdgcn-amd-amdhsa--gfx950"
.text
.globl standalone__swin_window_attn__vision_kernel
.p2align 8
.type standalone__swin_window_attn__vision_kernel,@function
standalone__swin_window_attn__vision_kernel:

s_cmp_ge_u32 s2, 256
s_cbranch_scc1 L_end
s_load_dwordx2 s[84:85], s[0:1], 8
s_load_dwordx2 s[88:89], s[0:1], 16
s_load_dwordx2 s[20:21], s[0:1], 40
s_load_dwordx2 s[8:9], s[0:1], 0
s_load_dwordx2 s[16:17], s[0:1], 24
s_load_dwordx2 s[92:93], s[0:1], 32
v_lshrrev_b32 v1, 6, v0
v_bfe_u32 v3, v0, 4, 2
v_readfirstlane_b32 s24, v1
v_bfe_u32 v4, v0, 5, 1
v_bfe_u32 v5, v0, 3, 2
v_lshl_add_u32 v4, v4, 3, v5
v_and_b32 v7, 7, v0
v_xor_b32 v7, v7, v3
v_lshlrev_b32 v7, 4, v7
v_xor_b32 v186, 64, v7
v_and_b32 v1, 63, v0
s_mov_b32 s86, 884736
s_mov_b32 s87, 0x20000
s_mov_b32 s96, s2
s_mov_b32 s97, 0
s_mov_b32 s69, 72
s_mov_b32 s58, 0
s_cmp_ge_u32 s2, 144
s_cbranch_scc1 L_nounit
L_unit:
s_bfe_u32 s25, s96, 0x10002
s_lshr_b32 s26, s96, 3
s_mul_i32 s27, s26, 43
s_lshr_b32 s27, s27, 7
s_mul_i32 s28, s27, 3
s_sub_u32 s28, s26, s28
s_bfe_u32 s26, s96, 0x10001
s_mul_i32 s26, s26, 3
s_add_u32 s28, s28, s26
s_and_b32 s26, s96, 1
s_mul_i32 s26, s26, 6
s_add_u32 s27, s27, s26
s_and_b32 s29, s24, 1
s_lshr_b32 s37, s24, 1
s_lshl_b32 s31, s28, 1
s_add_u32 s30, s37, s31
s_lshl_b32 s31, s30, 5
s_lshl_b32 s32, s29, 2
s_add_u32 s31, s31, s32
v_add_u32 v6, s31, v4
v_mul_u32_u24 v6, 2304, v6
s_mul_i32 s31, s25, 1536
v_add_u32 v6, s31, v6
v_add_u32 v14, 36864, v6
v_add_u32 v6, v6, v7
v_add_u32 v14, v14, v186
s_mul_i32 s33, s24, 12288
s_mov_b32 s22, 602112
s_mov_b32 s23, 0x20000
s_and_b32 s34, s2, 31
s_mul_i32 s34, s34, 384
s_add_u32 s34, s34, 589824
v_lshl_add_u32 v183, v1, 7, s34
s_mov_b32 s95, 0x20000
s_or_b32 s35, s24, s97
s_waitcnt lgkmcnt(0)
s_cbranch_scc1 L_nosnap1
s_mov_b64 exec, 7
buffer_load_dword v181, v183, s[20:23], 0 offen sc1
s_mov_b64 exec, -1
L_nosnap1:
s_add_u32 m0, s33, 0
s_mov_b32 s90, 294912
buffer_load_dwordx4 v6, s[84:87], 0 offen offset:0 lds
s_add_u32 m0, s33, 1024
s_mov_b32 s91, 0x20000
buffer_load_dwordx4 v14, s[84:87], 0 offen offset:0 lds
s_add_u32 m0, s33, 1920
s_mov_b32 s10, 48771072
buffer_load_dwordx4 v6, s[84:87], 0 offen offset:128 lds
s_add_u32 m0, s33, 2944
s_mov_b32 s11, 0x20000
buffer_load_dwordx4 v14, s[84:87], 0 offen offset:128 lds
s_add_u32 m0, s33, 3840
s_mov_b32 s18, 48771072
buffer_load_dwordx4 v6, s[84:87], 0 offen offset:256 lds
s_add_u32 m0, s33, 4864
s_mov_b32 s19, 0x20000
buffer_load_dwordx4 v14, s[84:87], 0 offen offset:256 lds
s_add_u32 m0, s33, 5760
s_mov_b32 s94, 144
buffer_load_dwordx4 v6, s[84:87], 0 offen offset:384 lds
s_add_u32 m0, s33, 6784
s_nop 0
buffer_load_dwordx4 v14, s[84:87], 0 offen offset:384 lds
s_add_u32 m0, s33, 7680
s_nop 0
buffer_load_dwordx4 v6, s[84:87], 0 offen offset:512 lds
s_add_u32 m0, s33, 8704
s_nop 0
buffer_load_dwordx4 v14, s[84:87], 0 offen offset:512 lds
s_add_u32 m0, s33, 9600
s_nop 0
buffer_load_dwordx4 v6, s[84:87], 0 offen offset:640 lds
s_add_u32 m0, s33, 10624
s_nop 0
buffer_load_dwordx4 v14, s[84:87], 0 offen offset:640 lds
s_cmp_eq_u32 s25, 1
s_cbranch_scc1 L_uN
s_lshl_b32 s31, s27, 5
s_add_u32 s31, s31, s32
v_add_u32 v8, s31, v4
v_mul_u32_u24 v8, 2304, v8
s_mul_i32 s31, s37, 384
s_add_u32 s31, s31, 768
v_add_u32 v8, s31, v8
v_add_u32 v15, 36864, v8
v_add_u32 v8, v8, v7
v_add_u32 v15, v15, v186
s_mul_i32 s33, s29, 12288
s_mul_i32 s34, s37, 6144
s_add_u32 s34, s34, s33
s_add_u32 m0, s34, 49152
s_nop 0
buffer_load_dwordx4 v8, s[84:87], 0 offen offset:0 lds
s_add_u32 m0, s34, 50176
s_nop 0
buffer_load_dwordx4 v15, s[84:87], 0 offen offset:0 lds
s_add_u32 m0, s34, 51072
s_nop 0
buffer_load_dwordx4 v8, s[84:87], 0 offen offset:128 lds
s_add_u32 m0, s34, 52096
s_nop 0
buffer_load_dwordx4 v15, s[84:87], 0 offen offset:128 lds
s_add_u32 m0, s34, 52992
s_nop 0
buffer_load_dwordx4 v8, s[84:87], 0 offen offset:256 lds
s_add_u32 m0, s34, 54016
s_nop 0
buffer_load_dwordx4 v15, s[84:87], 0 offen offset:256 lds

v_mov_b32 v185, v0
v_and_b32 v2, 15, v0
v_lshlrev_b32 v228, 4, v1
v_bfe_u32 v5, v0, 3, 1
v_lshlrev_b32 v5, 1, v5
v_xor_b32 v5, v5, v3
v_lshlrev_b32 v5, 4, v5
v_lshl_add_u32 v5, v2, 6, v5
v_lshrrev_b32 v187, 1, v2
v_xor_b32 v187, v187, v3
v_lshlrev_b32 v187, 4, v187
v_lshl_add_u32 v187, v2, 7, v187
s_bfe_u32 s36, s2, 0x10003
s_bitcmp1_b32 s2, 2
s_cselect_b32 s36, 2, s36
s_lshl_b32 s36, s36, 7
s_add_u32 s36, s36, 589824
v_mul_u32_u24 v184, 384, v1
v_add_u32 v184, s36, v184
s_add_u32 s33, s33, 49152
v_add_u32 v11, s33, v187
v_xor_b32 v189, 64, v11
v_mov_b32 v9, v228
s_lshl_b32 s33, s27, 1
s_add_u32 s33, s33, s29
s_and_b32 s34, s30, 1
s_cmp_lt_u32 s33, 16
s_cselect_b32 s35, 32, 16
s_cselect_b32 s36, 0, 160
s_mul_i32 s35, s35, s28
s_add_u32 s35, s35, s36
s_lshl_b32 s33, s33, 1
s_add_u32 s35, s35, s33
s_add_u32 s35, s35, s34
s_lshl_b32 s35, s35, 10
s_branch L_uw
L_uN:
v_lshrrev_b32 v8, 2, v1
v_mul_u32_u24 v8, 768, v8
v_and_b32 v12, 3, v1
v_lshl_add_u32 v8, v12, 4, v8
s_lshl_b32 s31, s27, 6
s_mul_i32 s33, s24, 73728
s_add_u32 s31, s31, s33
v_add_u32 v8, s31, v8
s_mul_i32 s34, s24, 6144
s_add_u32 m0, s34, 49152
s_mov_b32 s33, 0
buffer_load_dwordx4 v8, s[88:91], s33 offen lds
s_add_u32 m0, s34, 50176
s_mov_b32 s33, 12288
buffer_load_dwordx4 v8, s[88:91], s33 offen lds
s_add_u32 m0, s34, 51200
s_mov_b32 s33, 24576
buffer_load_dwordx4 v8, s[88:91], s33 offen lds
s_add_u32 m0, s34, 52224
s_mov_b32 s33, 36864
buffer_load_dwordx4 v8, s[88:91], s33 offen lds
s_add_u32 m0, s34, 53248
s_mov_b32 s33, 49152
buffer_load_dwordx4 v8, s[88:91], s33 offen lds
s_add_u32 m0, s34, 54272
s_mov_b32 s33, 61440
buffer_load_dwordx4 v8, s[88:91], s33 offen lds

v_mov_b32 v185, v0
v_and_b32 v2, 15, v0
v_lshlrev_b32 v228, 4, v1
v_bfe_u32 v5, v0, 3, 1
v_lshlrev_b32 v5, 1, v5
v_xor_b32 v5, v5, v3
v_lshlrev_b32 v5, 4, v5
v_lshl_add_u32 v5, v2, 6, v5
v_lshrrev_b32 v187, 1, v2
v_xor_b32 v187, v187, v3
v_lshlrev_b32 v187, 4, v187
v_lshl_add_u32 v187, v2, 7, v187
s_bfe_u32 s36, s2, 0x10003
s_bitcmp1_b32 s2, 2
s_cselect_b32 s36, 2, s36
s_lshl_b32 s36, s36, 7
s_add_u32 s36, s36, 589824
v_mul_u32_u24 v184, 384, v1
v_add_u32 v184, s36, v184
v_lshlrev_b32 v11, 9, v3
v_bfe_u32 v13, v1, 2, 2
v_lshl_add_u32 v11, v13, 6, v11
v_lshl_add_u32 v11, v12, 3, v11
s_lshl_b32 s33, s29, 5
s_add_u32 s33, s33, 49152
v_add_u32 v11, s33, v11
v_mul_u32_u24 v9, 12288, v12
v_lshl_add_u32 v9, v3, 8, v9
v_lshl_add_u32 v9, v13, 4, v9
s_lshr_b32 s35, s27, 1
s_mul_i32 s35, s35, 48
s_add_u32 s35, s35, s30
s_add_u32 s35, s35, 288
s_lshl_b32 s35, s35, 10
s_and_b32 s33, s27, 1
s_lshl_b32 s33, s33, 1
s_add_u32 s33, s33, s29
s_lshl_b32 s33, s33, 6
s_add_u32 s35, s35, s33
s_cmp_lt_u32 s27, 10
s_cbranch_scc1 L_uw
v_and_b32 v9, 1, v1
v_mul_u32_u24 v9, 12288, v9
v_lshl_add_u32 v9, v3, 8, v9
v_bfe_u32 v13, v1, 1, 3
v_lshl_add_u32 v9, v13, 4, v9
s_mul_i32 s35, s27, 24
s_add_u32 s35, s35, s30
s_add_u32 s35, s35, 288
s_lshl_b32 s35, s35, 10
s_lshl_b32 s33, s29, 7
s_add_u32 s35, s35, s33
L_uw:
s_mul_i32 s33, s37, 24576
v_add_u32 v10, s33, v187
v_xor_b32 v188, 64, v10
v_bfe_u32 v176, v185, 2, 4
v_and_b32 v177, 3, v185
v_bfe_u32 v179, v185, 5, 1
v_lshlrev_b32 v179, 1, v179
v_xor_b32 v177, v177, v179
v_lshlrev_b32 v177, 4, v177
s_and_b32 s50, s2, 15
s_mul_i32 s50, s50, 81
s_lshr_b32 s51, s2, 4
s_mul_i32 s52, s51, 5
s_add_u32 s52, s52, s50
s_add_u32 s50, s50, 80
s_mul_i32 s53, s50, 1821
s_lshr_b32 s53, s53, 16
s_mul_i32 s100, s53, 1161216
s_mul_i32 s53, s50, 5376
s_add_u32 s100, s100, s53
s_add_u32 s50, s52, 4
s_mul_i32 s53, s50, 1821
s_lshr_b32 s53, s53, 16
s_mul_i32 s99, s53, 1161216
s_mul_i32 s53, s50, 5376
s_add_u32 s99, s99, s53
s_add_u32 s50, s52, s24
s_mul_i32 s53, s50, 1821
s_lshr_b32 s53, s53, 16
s_mul_i32 s98, s53, 1161216
s_mul_i32 s53, s50, 5376
s_add_u32 s98, s98, s53
v_add_u32 v178, 0, v176
v_mul_u32_u24 v179, 37, v178
v_lshrrev_b32 v179, 8, v179
v_mul_u32_u24 v179, 188160, v179
v_mul_u32_u24 v224, 768, v178
v_add_u32 v224, v224, v179
v_add_u32 v224, s98, v224
v_add_u32 v178, 16, v176
v_mul_u32_u24 v179, 37, v178
v_lshrrev_b32 v179, 8, v179
v_mul_u32_u24 v179, 188160, v179
v_mul_u32_u24 v225, 768, v178
v_add_u32 v225, v225, v179
v_add_u32 v225, s98, v225
v_add_u32 v178, 32, v176
v_mul_u32_u24 v179, 37, v178
v_lshrrev_b32 v179, 8, v179
v_mul_u32_u24 v179, 188160, v179
v_mul_u32_u24 v226, 768, v178
v_add_u32 v226, v226, v179
v_add_u32 v226, s98, v226
s_mul_i32 s50, s24, 15
s_sub_u32 s50, s50, 1
v_add_u32 v178, s50, v176
s_mul_i32 s50, s51, 11
s_sub_u32 s50, s50, 170
v_add_u32 v180, s50, v178
v_cmp_gt_u32 vcc, 49, v178
v_mov_b32 v227, s100
v_mov_b32 v179, s99
v_cndmask_b32 v178, v180, v178, vcc
v_cndmask_b32 v227, v227, v179, vcc
v_cmp_eq_u32 vcc, 0, v176
v_mov_b32 v179, s98
v_mov_b32 v180, 48
v_cndmask_b32 v227, v227, v179, vcc
v_cndmask_b32 v178, v178, v180, vcc
v_cmp_gt_u32 vcc, 49, v178
v_min_u32 v178, 48, v178
v_mul_u32_u24 v179, 37, v178
v_lshrrev_b32 v179, 8, v179
v_mul_u32_u24 v179, 188160, v179
v_mul_u32_u24 v180, 768, v178
v_add_u32 v180, v180, v179
v_add_u32 v227, v227, v180
v_mov_b32 v179, 0x70000000
v_cndmask_b32 v227, v179, v227, vcc
s_lshl_b32 s59, s24, 13
s_add_u32 s59, s59, 98304
v_bfe_u32 v178, v1, 3, 3
v_lshlrev_b32 v178, 4, v178
ds_bpermute_b32 v248, v178, v224 offset:0
ds_bpermute_b32 v249, v178, v224 offset:128
ds_bpermute_b32 v250, v178, v225 offset:0
ds_bpermute_b32 v251, v178, v225 offset:128
ds_bpermute_b32 v252, v178, v226 offset:0
ds_bpermute_b32 v253, v178, v226 offset:128
ds_bpermute_b32 v254, v178, v227 offset:0
ds_bpermute_b32 v255, v178, v227 offset:128
v_add_u32 v230, s59, v187
v_xor_b32 v247, 64, v230
s_waitcnt lgkmcnt(0)
v_add_u32 v248, v248, v7
v_add_u32 v249, v249, v186
v_add_u32 v250, v250, v7
v_add_u32 v251, v251, v186
v_add_u32 v252, v252, v7
v_add_u32 v253, v253, v186
v_add_u32 v254, v254, v7
v_add_u32 v255, v255, v186
s_waitcnt vmcnt(0)
s_barrier
s_cmp_lg_u32 s97, 0
s_cbranch_scc1 L_noann
s_lshl_b32 s58, s24, 1
s_or_b32 s58, s58, s25
s_cmp_lg_u32 s58, 1
s_cbranch_scc1 L_noann
v_mov_b32 v14, 1
v_mov_b32 v15, 0
buffer_atomic_add v14, v184, s[20:23], 0 offen
s_mov_b64 exec, 1
buffer_atomic_add v14, v15, s[92:95], 0 offen
s_mov_b64 exec, -1
L_noann:
s_cmp_eq_u32 s25, 1
s_cbranch_scc1 L_uN2
ds_read_b128 v[16:19], v10 offset:0
ds_read_b128 v[64:67], v10 offset:12288
ds_read_b128 v[112:115], v11 offset:0
ds_read_b128 v[20:23], v188 offset:0
ds_read_b128 v[68:71], v188 offset:12288
ds_read_b128 v[116:119], v189 offset:0
ds_read_b128 v[24:27], v10 offset:2048
ds_read_b128 v[72:75], v10 offset:14336
ds_read_b128 v[120:123], v11 offset:2048
ds_read_b128 v[28:31], v188 offset:2048
ds_read_b128 v[76:79], v188 offset:14336
ds_read_b128 v[124:127], v189 offset:2048
s_waitcnt lgkmcnt(9)
v_mfma_f32_16x16x32_bf16 v[160:163], v[16:19], v[112:115], 0
v_mfma_f32_16x16x32_bf16 v[164:167], v[64:67], v[112:115], 0
ds_read_b128 v[32:35], v10 offset:4096
ds_read_b128 v[80:83], v10 offset:16384
ds_read_b128 v[128:131], v11 offset:4096
s_waitcnt lgkmcnt(9)
v_mfma_f32_16x16x32_bf16 v[160:163], v[20:23], v[116:119], v[160:163]
v_mfma_f32_16x16x32_bf16 v[164:167], v[68:71], v[116:119], v[164:167]
ds_read_b128 v[36:39], v188 offset:4096
ds_read_b128 v[84:87], v188 offset:16384
ds_read_b128 v[132:135], v189 offset:4096
s_waitcnt lgkmcnt(9)
v_mfma_f32_16x16x32_bf16 v[160:163], v[24:27], v[120:123], v[160:163]
v_mfma_f32_16x16x32_bf16 v[164:167], v[72:75], v[120:123], v[164:167]
ds_read_b128 v[40:43], v10 offset:6144
ds_read_b128 v[88:91], v10 offset:18432
ds_read_b128 v[136:139], v11 offset:6144
s_waitcnt lgkmcnt(9)
v_mfma_f32_16x16x32_bf16 v[160:163], v[28:31], v[124:127], v[160:163]
v_mfma_f32_16x16x32_bf16 v[164:167], v[76:79], v[124:127], v[164:167]
ds_read_b128 v[44:47], v188 offset:6144
ds_read_b128 v[92:95], v188 offset:18432
ds_read_b128 v[140:143], v189 offset:6144
s_waitcnt lgkmcnt(9)
v_mfma_f32_16x16x32_bf16 v[160:163], v[32:35], v[128:131], v[160:163]
v_mfma_f32_16x16x32_bf16 v[164:167], v[80:83], v[128:131], v[164:167]
ds_read_b128 v[48:51], v10 offset:8192
ds_read_b128 v[96:99], v10 offset:20480
ds_read_b128 v[144:147], v11 offset:8192
s_waitcnt lgkmcnt(9)
v_mfma_f32_16x16x32_bf16 v[160:163], v[36:39], v[132:135], v[160:163]
v_mfma_f32_16x16x32_bf16 v[164:167], v[84:87], v[132:135], v[164:167]
ds_read_b128 v[52:55], v188 offset:8192
ds_read_b128 v[100:103], v188 offset:20480
ds_read_b128 v[148:151], v189 offset:8192
s_waitcnt lgkmcnt(9)
v_mfma_f32_16x16x32_bf16 v[160:163], v[40:43], v[136:139], v[160:163]
v_mfma_f32_16x16x32_bf16 v[164:167], v[88:91], v[136:139], v[164:167]
ds_read_b128 v[56:59], v10 offset:10240
ds_read_b128 v[104:107], v10 offset:22528
ds_read_b128 v[152:155], v11 offset:10240
s_waitcnt lgkmcnt(9)
v_mfma_f32_16x16x32_bf16 v[160:163], v[44:47], v[140:143], v[160:163]
v_mfma_f32_16x16x32_bf16 v[164:167], v[92:95], v[140:143], v[164:167]
ds_read_b128 v[60:63], v188 offset:10240
ds_read_b128 v[108:111], v188 offset:22528
ds_read_b128 v[156:159], v189 offset:10240
s_waitcnt lgkmcnt(9)
v_mfma_f32_16x16x32_bf16 v[160:163], v[48:51], v[144:147], v[160:163]
v_mfma_f32_16x16x32_bf16 v[164:167], v[96:99], v[144:147], v[164:167]
s_waitcnt lgkmcnt(6)
v_mfma_f32_16x16x32_bf16 v[160:163], v[52:55], v[148:151], v[160:163]
v_mfma_f32_16x16x32_bf16 v[164:167], v[100:103], v[148:151], v[164:167]
s_waitcnt lgkmcnt(3)
v_mfma_f32_16x16x32_bf16 v[160:163], v[56:59], v[152:155], v[160:163]
v_mfma_f32_16x16x32_bf16 v[164:167], v[104:107], v[152:155], v[164:167]
s_waitcnt lgkmcnt(0)
v_mfma_f32_16x16x32_bf16 v[160:163], v[60:63], v[156:159], v[160:163]
v_mfma_f32_16x16x32_bf16 v[164:167], v[108:111], v[156:159], v[164:167]
s_branch L_umm
L_uN2:
ds_read_b128 v[16:19], v10 offset:0
ds_read_b128 v[64:67], v10 offset:12288
ds_read_b64_tr_b16 v[112:113], v11 offset:0
ds_read_b64_tr_b16 v[114:115], v11 offset:256
ds_read_b128 v[20:23], v188 offset:0
ds_read_b128 v[68:71], v188 offset:12288
ds_read_b64_tr_b16 v[116:117], v11 offset:2048
ds_read_b64_tr_b16 v[118:119], v11 offset:2304
ds_read_b128 v[24:27], v10 offset:2048
ds_read_b128 v[72:75], v10 offset:14336
ds_read_b64_tr_b16 v[120:121], v11 offset:4096
ds_read_b64_tr_b16 v[122:123], v11 offset:4352
ds_read_b128 v[28:31], v188 offset:2048
ds_read_b128 v[76:79], v188 offset:14336
ds_read_b64_tr_b16 v[124:125], v11 offset:6144
ds_read_b64_tr_b16 v[126:127], v11 offset:6400
s_waitcnt lgkmcnt(12)
v_mfma_f32_16x16x32_bf16 v[160:163], v[16:19], v[112:115], 0
v_mfma_f32_16x16x32_bf16 v[164:167], v[64:67], v[112:115], 0
ds_read_b128 v[32:35], v10 offset:4096
ds_read_b128 v[80:83], v10 offset:16384
ds_read_b64_tr_b16 v[128:129], v11 offset:8192
ds_read_b64_tr_b16 v[130:131], v11 offset:8448
s_waitcnt lgkmcnt(12)
v_mfma_f32_16x16x32_bf16 v[160:163], v[20:23], v[116:119], v[160:163]
v_mfma_f32_16x16x32_bf16 v[164:167], v[68:71], v[116:119], v[164:167]
ds_read_b128 v[36:39], v188 offset:4096
ds_read_b128 v[84:87], v188 offset:16384
ds_read_b64_tr_b16 v[132:133], v11 offset:10240
ds_read_b64_tr_b16 v[134:135], v11 offset:10496
s_waitcnt lgkmcnt(12)
v_mfma_f32_16x16x32_bf16 v[160:163], v[24:27], v[120:123], v[160:163]
v_mfma_f32_16x16x32_bf16 v[164:167], v[72:75], v[120:123], v[164:167]
ds_read_b128 v[40:43], v10 offset:6144
ds_read_b128 v[88:91], v10 offset:18432
ds_read_b64_tr_b16 v[136:137], v11 offset:12288
ds_read_b64_tr_b16 v[138:139], v11 offset:12544
s_waitcnt lgkmcnt(12)
v_mfma_f32_16x16x32_bf16 v[160:163], v[28:31], v[124:127], v[160:163]
v_mfma_f32_16x16x32_bf16 v[164:167], v[76:79], v[124:127], v[164:167]
ds_read_b128 v[44:47], v188 offset:6144
ds_read_b128 v[92:95], v188 offset:18432
ds_read_b64_tr_b16 v[140:141], v11 offset:14336
ds_read_b64_tr_b16 v[142:143], v11 offset:14592
s_waitcnt lgkmcnt(12)
v_mfma_f32_16x16x32_bf16 v[160:163], v[32:35], v[128:131], v[160:163]
v_mfma_f32_16x16x32_bf16 v[164:167], v[80:83], v[128:131], v[164:167]
ds_read_b128 v[48:51], v10 offset:8192
ds_read_b128 v[96:99], v10 offset:20480
ds_read_b64_tr_b16 v[144:145], v11 offset:16384
ds_read_b64_tr_b16 v[146:147], v11 offset:16640
s_waitcnt lgkmcnt(12)
v_mfma_f32_16x16x32_bf16 v[160:163], v[36:39], v[132:135], v[160:163]
v_mfma_f32_16x16x32_bf16 v[164:167], v[84:87], v[132:135], v[164:167]
ds_read_b128 v[52:55], v188 offset:8192
ds_read_b128 v[100:103], v188 offset:20480
ds_read_b64_tr_b16 v[148:149], v11 offset:18432
ds_read_b64_tr_b16 v[150:151], v11 offset:18688
s_waitcnt lgkmcnt(12)
v_mfma_f32_16x16x32_bf16 v[160:163], v[40:43], v[136:139], v[160:163]
v_mfma_f32_16x16x32_bf16 v[164:167], v[88:91], v[136:139], v[164:167]
ds_read_b128 v[56:59], v10 offset:10240
ds_read_b128 v[104:107], v10 offset:22528
ds_read_b64_tr_b16 v[152:153], v11 offset:20480
ds_read_b64_tr_b16 v[154:155], v11 offset:20736
s_waitcnt lgkmcnt(12)
v_mfma_f32_16x16x32_bf16 v[160:163], v[44:47], v[140:143], v[160:163]
v_mfma_f32_16x16x32_bf16 v[164:167], v[92:95], v[140:143], v[164:167]
ds_read_b128 v[60:63], v188 offset:10240
ds_read_b128 v[108:111], v188 offset:22528
ds_read_b64_tr_b16 v[156:157], v11 offset:22528
ds_read_b64_tr_b16 v[158:159], v11 offset:22784
s_waitcnt lgkmcnt(12)
v_mfma_f32_16x16x32_bf16 v[160:163], v[48:51], v[144:147], v[160:163]
v_mfma_f32_16x16x32_bf16 v[164:167], v[96:99], v[144:147], v[164:167]
s_waitcnt lgkmcnt(8)
v_mfma_f32_16x16x32_bf16 v[160:163], v[52:55], v[148:151], v[160:163]
v_mfma_f32_16x16x32_bf16 v[164:167], v[100:103], v[148:151], v[164:167]
s_waitcnt lgkmcnt(4)
v_mfma_f32_16x16x32_bf16 v[160:163], v[56:59], v[152:155], v[160:163]
v_mfma_f32_16x16x32_bf16 v[164:167], v[104:107], v[152:155], v[164:167]
s_waitcnt lgkmcnt(0)
v_mfma_f32_16x16x32_bf16 v[160:163], v[60:63], v[156:159], v[160:163]
v_mfma_f32_16x16x32_bf16 v[164:167], v[108:111], v[156:159], v[164:167]
L_umm:

s_nop 7
v_cvt_pk_bf16_f32 v168, v160, v161
v_cvt_pk_bf16_f32 v169, v162, v163
v_cvt_pk_bf16_f32 v170, v164, v165
v_cvt_pk_bf16_f32 v171, v166, v167
buffer_store_dwordx4 v[168:171], v9, s[20:23], s35 offen sc1
s_cmp_lg_u32 s97, 0
s_cbranch_scc1 L_fb
s_cmp_eq_u32 s25, 1
s_cbranch_scc1 L_x01
s_add_u32 m0, s59, 0
s_nop 0
buffer_load_dwordx4 v248, s[8:11], 0 offen offset:0 nt lds
s_add_u32 m0, s59, 1024
s_nop 0
buffer_load_dwordx4 v249, s[8:11], 0 offen offset:0 nt lds
s_add_u32 m0, s59, 2048
s_nop 0
buffer_load_dwordx4 v250, s[8:11], 0 offen offset:0 nt lds
s_add_u32 m0, s59, 3072
s_nop 0
buffer_load_dwordx4 v251, s[8:11], 0 offen offset:0 nt lds
s_add_u32 m0, s59, 4096
s_nop 0
buffer_load_dwordx4 v252, s[8:11], 0 offen offset:0 nt lds
s_add_u32 m0, s59, 5120
s_nop 0
buffer_load_dwordx4 v253, s[8:11], 0 offen offset:0 nt lds
s_add_u32 m0, s59, 6144
s_nop 0
buffer_load_dwordx4 v254, s[8:11], 0 offen offset:0 nt lds
s_add_u32 m0, s59, 7168
s_nop 0
buffer_load_dwordx4 v255, s[8:11], 0 offen offset:0 nt lds
s_waitcnt vmcnt(8)
L_sig:
s_barrier
s_cmp_lg_u32 s24, 0
s_cbranch_scc1 L_nos2
v_mov_b32 v14, 1
v_mov_b32 v15, 0
buffer_atomic_add v14, v184, s[20:23], 0 offen
s_mov_b64 exec, 1
buffer_atomic_add v14, v15, s[92:95], 0 offen
s_mov_b64 exec, -1
L_nos2:
s_add_u32 m0, s59, 32640
s_nop 0
buffer_load_dwordx4 v248, s[8:11], 0 offen offset:128 nt lds
s_add_u32 m0, s59, 33664
s_nop 0
buffer_load_dwordx4 v249, s[8:11], 0 offen offset:128 nt lds
s_add_u32 m0, s59, 34688
s_nop 0
buffer_load_dwordx4 v250, s[8:11], 0 offen offset:128 nt lds
s_add_u32 m0, s59, 35712
s_nop 0
buffer_load_dwordx4 v251, s[8:11], 0 offen offset:128 nt lds
s_add_u32 m0, s59, 36736
s_nop 0
buffer_load_dwordx4 v252, s[8:11], 0 offen offset:128 nt lds
s_add_u32 m0, s59, 37760
s_nop 0
buffer_load_dwordx4 v253, s[8:11], 0 offen offset:128 nt lds
s_add_u32 m0, s59, 38784
s_nop 0
buffer_load_dwordx4 v254, s[8:11], 0 offen offset:128 nt lds
s_add_u32 m0, s59, 39808
s_nop 0
buffer_load_dwordx4 v255, s[8:11], 0 offen offset:128 nt lds
s_branch L_x01

L_fb:
s_waitcnt vmcnt(0)
s_barrier
s_add_u32 s96, s96, 1
s_cmp_lt_u32 s96, 144
s_cbranch_scc1 L_unit
s_branch L_go
L_nounit:
s_cmp_lt_u32 s2, 248
s_cbranch_scc1 L_nocpf
s_getpc_b64 s[26:27]
L_pc:
s_sub_u32 s26, s26, L_pc-standalone__swin_window_attn__vision_kernel
s_subb_u32 s27, s27, 0
v_lshlrev_b32 v190, 7, v0
v_add_u32 v191, 32768, v190
v_min_u32 v191, L_end-standalone__swin_window_attn__vision_kernel, v191
global_load_dword v192, v190, s[26:27]
global_load_dword v193, v191, s[26:27]
L_nocpf:
s_mov_b32 s22, 602112
s_mov_b32 s23, 0x20000
s_and_b32 s34, s2, 31
s_mul_i32 s34, s34, 384
s_add_u32 s34, s34, 589824
s_mov_b32 s90, 294912
s_mov_b32 s91, 0x20000
s_mov_b32 s10, 48771072
s_mov_b32 s11, 0x20000
s_mov_b32 s18, 48771072
s_mov_b32 s19, 0x20000
s_mov_b32 s94, 144
s_mov_b32 s25, 2
s_waitcnt lgkmcnt(0)
v_lshl_add_u32 v183, v1, 7, s34
s_mov_b32 s95, 0x20000
s_cmp_lg_u32 s24, 0
s_cbranch_scc1 L_nosnap2
s_mov_b64 exec, 7
buffer_load_dword v181, v183, s[20:23], 0 offen sc1
s_mov_b64 exec, -1
L_nosnap2:
v_mov_b32 v185, v0
v_and_b32 v2, 15, v0
v_lshlrev_b32 v228, 4, v1
v_bfe_u32 v5, v0, 3, 1
v_lshlrev_b32 v5, 1, v5
v_xor_b32 v5, v5, v3
v_lshlrev_b32 v5, 4, v5
v_lshl_add_u32 v5, v2, 6, v5
v_lshrrev_b32 v187, 1, v2
v_xor_b32 v187, v187, v3
v_lshlrev_b32 v187, 4, v187
v_lshl_add_u32 v187, v2, 7, v187
s_bfe_u32 s36, s2, 0x10003
s_bitcmp1_b32 s2, 2
s_cselect_b32 s36, 2, s36
s_lshl_b32 s36, s36, 7
s_add_u32 s36, s36, 589824
v_mul_u32_u24 v184, 384, v1
v_add_u32 v184, s36, v184
v_bfe_u32 v176, v185, 2, 4
v_and_b32 v177, 3, v185
v_bfe_u32 v179, v185, 5, 1
v_lshlrev_b32 v179, 1, v179
v_xor_b32 v177, v177, v179
v_lshlrev_b32 v177, 4, v177
s_and_b32 s50, s2, 15
s_mul_i32 s50, s50, 81
s_lshr_b32 s51, s2, 4
s_mul_i32 s52, s51, 5
s_add_u32 s52, s52, s50
s_add_u32 s50, s50, 80
s_mul_i32 s53, s50, 1821
s_lshr_b32 s53, s53, 16
s_mul_i32 s100, s53, 1161216
s_mul_i32 s53, s50, 5376
s_add_u32 s100, s100, s53
s_add_u32 s50, s52, 4
s_mul_i32 s53, s50, 1821
s_lshr_b32 s53, s53, 16
s_mul_i32 s99, s53, 1161216
s_mul_i32 s53, s50, 5376
s_add_u32 s99, s99, s53
s_add_u32 s50, s52, s24
s_mul_i32 s53, s50, 1821
s_lshr_b32 s53, s53, 16
s_mul_i32 s98, s53, 1161216
s_mul_i32 s53, s50, 5376
s_add_u32 s98, s98, s53
v_add_u32 v178, 0, v176
v_mul_u32_u24 v179, 37, v178
v_lshrrev_b32 v179, 8, v179
v_mul_u32_u24 v179, 188160, v179
v_mul_u32_u24 v224, 768, v178
v_add_u32 v224, v224, v179
v_add_u32 v224, s98, v224
v_add_u32 v178, 16, v176
v_mul_u32_u24 v179, 37, v178
v_lshrrev_b32 v179, 8, v179
v_mul_u32_u24 v179, 188160, v179
v_mul_u32_u24 v225, 768, v178
v_add_u32 v225, v225, v179
v_add_u32 v225, s98, v225
v_add_u32 v178, 32, v176
v_mul_u32_u24 v179, 37, v178
v_lshrrev_b32 v179, 8, v179
v_mul_u32_u24 v179, 188160, v179
v_mul_u32_u24 v226, 768, v178
v_add_u32 v226, v226, v179
v_add_u32 v226, s98, v226
s_mul_i32 s50, s24, 15
s_sub_u32 s50, s50, 1
v_add_u32 v178, s50, v176
s_mul_i32 s50, s51, 11
s_sub_u32 s50, s50, 170
v_add_u32 v180, s50, v178
v_cmp_gt_u32 vcc, 49, v178
v_mov_b32 v227, s100
v_mov_b32 v179, s99
v_cndmask_b32 v178, v180, v178, vcc
v_cndmask_b32 v227, v227, v179, vcc
v_cmp_eq_u32 vcc, 0, v176
v_mov_b32 v179, s98
v_mov_b32 v180, 48
v_cndmask_b32 v227, v227, v179, vcc
v_cndmask_b32 v178, v178, v180, vcc
v_cmp_gt_u32 vcc, 49, v178
v_min_u32 v178, 48, v178
v_mul_u32_u24 v179, 37, v178
v_lshrrev_b32 v179, 8, v179
v_mul_u32_u24 v179, 188160, v179
v_mul_u32_u24 v180, 768, v178
v_add_u32 v180, v180, v179
v_add_u32 v227, v227, v180
v_mov_b32 v179, 0x70000000
v_cndmask_b32 v227, v179, v227, vcc
s_lshl_b32 s59, s24, 13
s_add_u32 s59, s59, 98304
v_bfe_u32 v178, v1, 3, 3
v_lshlrev_b32 v178, 4, v178
ds_bpermute_b32 v248, v178, v224 offset:0
ds_bpermute_b32 v249, v178, v224 offset:128
ds_bpermute_b32 v250, v178, v225 offset:0
ds_bpermute_b32 v251, v178, v225 offset:128
ds_bpermute_b32 v252, v178, v226 offset:0
ds_bpermute_b32 v253, v178, v226 offset:128
ds_bpermute_b32 v254, v178, v227 offset:0
ds_bpermute_b32 v255, v178, v227 offset:128
v_add_u32 v230, s59, v187
v_xor_b32 v247, 64, v230
s_waitcnt lgkmcnt(0)
v_add_u32 v248, v248, v7
v_add_u32 v249, v249, v186
v_add_u32 v250, v250, v7
v_add_u32 v251, v251, v186
v_add_u32 v252, v252, v7
v_add_u32 v253, v253, v186
v_add_u32 v254, v254, v7
v_add_u32 v255, v255, v186
s_add_u32 m0, s59, 0
s_nop 0
buffer_load_dwordx4 v248, s[8:11], 0 offen offset:0 nt lds
s_add_u32 m0, s59, 1024
s_nop 0
buffer_load_dwordx4 v249, s[8:11], 0 offen offset:0 nt lds
s_add_u32 m0, s59, 2048
s_nop 0
buffer_load_dwordx4 v250, s[8:11], 0 offen offset:0 nt lds
s_add_u32 m0, s59, 3072
s_nop 0
buffer_load_dwordx4 v251, s[8:11], 0 offen offset:0 nt lds
s_add_u32 m0, s59, 4096
s_nop 0
buffer_load_dwordx4 v252, s[8:11], 0 offen offset:0 nt lds
s_add_u32 m0, s59, 5120
s_nop 0
buffer_load_dwordx4 v253, s[8:11], 0 offen offset:0 nt lds
s_add_u32 m0, s59, 6144
s_nop 0
buffer_load_dwordx4 v254, s[8:11], 0 offen offset:0 nt lds
s_add_u32 m0, s59, 7168
s_nop 0
buffer_load_dwordx4 v255, s[8:11], 0 offen offset:0 nt lds
s_add_u32 m0, s59, 32640
s_nop 0
buffer_load_dwordx4 v248, s[8:11], 0 offen offset:128 nt lds
s_add_u32 m0, s59, 33664
s_nop 0
buffer_load_dwordx4 v249, s[8:11], 0 offen offset:128 nt lds
s_add_u32 m0, s59, 34688
s_nop 0
buffer_load_dwordx4 v250, s[8:11], 0 offen offset:128 nt lds
s_add_u32 m0, s59, 35712
s_nop 0
buffer_load_dwordx4 v251, s[8:11], 0 offen offset:128 nt lds
s_add_u32 m0, s59, 36736
s_nop 0
buffer_load_dwordx4 v252, s[8:11], 0 offen offset:128 nt lds
s_add_u32 m0, s59, 37760
s_nop 0
buffer_load_dwordx4 v253, s[8:11], 0 offen offset:128 nt lds
s_add_u32 m0, s59, 38784
s_nop 0
buffer_load_dwordx4 v254, s[8:11], 0 offen offset:128 nt lds
s_add_u32 m0, s59, 39808
s_nop 0
buffer_load_dwordx4 v255, s[8:11], 0 offen offset:128 nt lds
s_waitcnt vmcnt(8)
ds_read_b128 a[0:3], v230 offset:0
ds_read_b128 a[16:19], v247 offset:0
ds_read_b128 a[4:7], v230 offset:2048
ds_read_b128 a[20:23], v247 offset:2048
ds_read_b128 a[8:11], v230 offset:4096
ds_read_b128 a[24:27], v247 offset:4096
ds_read_b128 a[12:15], v230 offset:6144
ds_read_b128 a[28:31], v247 offset:6144
s_add_u32 m0, s59, -256
s_waitcnt vmcnt(15) lgkmcnt(0)
buffer_load_dwordx4 v248, s[8:11], 0 offen offset:256 nt lds
s_add_u32 m0, s59, 768
s_waitcnt vmcnt(15)
buffer_load_dwordx4 v249, s[8:11], 0 offen offset:256 nt lds
s_add_u32 m0, s59, 1792
s_waitcnt vmcnt(15)
buffer_load_dwordx4 v250, s[8:11], 0 offen offset:256 nt lds
s_add_u32 m0, s59, 2816
s_waitcnt vmcnt(15)
buffer_load_dwordx4 v251, s[8:11], 0 offen offset:256 nt lds
s_add_u32 m0, s59, 3840
s_waitcnt vmcnt(15)
buffer_load_dwordx4 v252, s[8:11], 0 offen offset:256 nt lds
s_add_u32 m0, s59, 4864
s_waitcnt vmcnt(15)
buffer_load_dwordx4 v253, s[8:11], 0 offen offset:256 nt lds
s_add_u32 m0, s59, 5888
s_waitcnt vmcnt(15)
buffer_load_dwordx4 v254, s[8:11], 0 offen offset:256 nt lds
s_add_u32 m0, s59, 6912
s_waitcnt vmcnt(15)
buffer_load_dwordx4 v255, s[8:11], 0 offen offset:256 nt lds
L_x01:
v_add_u32 v229, 49152, v228
s_mul_i32 s32, s24, 8192
s_mul_i32 s33, s24, 4096
s_mul_i32 s34, s24, 6144
s_mov_b32 s35, 1033291584
s_mov_b32 s36, 0x00010001
s_mov_b32 s37, 0x00010001
s_mov_b32 s38, 0xffff
s_mov_b32 s39, 0
s_mul_i32 s28, s24, 15
s_sub_u32 s28, s28, 1
v_add_u32 v14, s28, v2
v_cmp_gt_u32 s[40:41], 49, v14
v_cmp_le_u32 s[42:43], 49, v14
s_mov_b32 s44, 128
s_sub_u32 s45, s100, s99
s_cmp_ge_u32 s51, 11
s_cselect_b32 s45, s45, 0x40000000
s_add_u32 s46, s45, 64
s_add_u32 s47, s45, 128
s_andn2_b64 s[40:41], s[40:41], s[36:37]
s_andn2_b64 s[42:43], s[42:43], s[36:37]
s_mul_i32 s48, s24, 3072
s_mul_i32 s56, s24, 1024
s_and_b32 s28, s24, 1
s_cmp_eq_u32 s28, 0
s_mov_b32 s49, 148480
s_cselect_b32 s49, 110592, s49
s_cselect_b32 s57, 0, s45
v_add_u32 v15, 0, v176
v_mul_u32_u24 v6, 37, v15
v_lshrrev_b32 v6, 8, v6
v_mul_u32_u24 v6, 188160, v6
v_mul_u32_u24 v231, 768, v15
v_add_u32 v231, v231, v6
v_add_u32 v231, s99, v231
v_add_u32 v231, v231, v177
v_add_u32 v15, 16, v176
v_mul_u32_u24 v6, 37, v15
v_lshrrev_b32 v6, 8, v6
v_mul_u32_u24 v6, 188160, v6
v_mul_u32_u24 v232, 768, v15
v_add_u32 v232, v232, v6
v_add_u32 v232, s99, v232
v_add_u32 v232, v232, v177
v_add_u32 v15, 32, v176
v_mul_u32_u24 v6, 37, v15
v_lshrrev_b32 v6, 8, v6
v_mul_u32_u24 v6, 188160, v6
v_mul_u32_u24 v233, 768, v15
v_add_u32 v233, v233, v6
v_add_u32 v233, s99, v233
v_add_u32 v233, v233, v177
s_mul_i32 s28, s24, 192
v_add_u32 v231, s28, v231
v_add_u32 v232, s28, v232
v_add_u32 v233, s28, v233
s_add_u32 s28, s99, 1165824
s_add_u32 s28, s28, s57
v_add_u32 v234, s28, v228
s_add_u32 s28, s98, 1165824
v_add_u32 v235, s28, v228
v_cmp_gt_u32 vcc, 48, v1
v_mov_b32 v15, 0x70000000
v_add_u32 v236, 73728, v5
v_cndmask_b32 v234, v15, v234, vcc
v_cndmask_b32 v235, v15, v235, vcc
v_add_u32 v237, 111616, v5
v_lshlrev_b32 v6, 4, v3
v_add_u32 v238, 110592, v6
v_add_u32 v14, 148480, v6
v_cmp_eq_u32 vcc, 2, v2
s_add_u32 s28, s56, 149504
v_add_u32 v6, s28, v6
v_cndmask_b32 v238, v238, v14, vcc
v_cmp_eq_u32 vcc, 1, v2
s_nop 1
s_nop 0
v_cndmask_b32 v238, v238, v6, vcc
v_lshl_add_u32 v6, v176, 6, v177
v_add_u32 v239, 73728, v6
v_add_u32 v240, 111616, v6
s_cmp_eq_u64 s[42:43], 0
s_cselect_b64 vcc, 0, -1
s_cmp_ge_u32 s51, 11
s_cselect_b64 vcc, vcc, 0
v_mov_b32 v14, 111616
v_cndmask_b32 v240, v14, v240, vcc
v_and_b32 v15, 3, v1
v_lshlrev_b32 v15, 4, v15
v_add_u32 v14, 148480, v15
v_cmp_eq_u32 vcc, 2, v176
v_add_u32 v241, 110592, v15
s_nop 0
v_cndmask_b32 v241, v241, v14, vcc
s_add_u32 s28, s56, 149504
v_add_u32 v6, s28, v15
v_cmp_eq_u32 vcc, 1, v176
v_mov_b32 v243, 0xff800000
v_mov_b32 v13, 0x3f800000
v_cndmask_b32 v241, v241, v6, vcc
v_cmp_eq_u32 vcc, 0, v1
v_lshrrev_b32 v15, 2, v2
v_and_b32 v14, 1, v2
v_cndmask_b32 v246, 0, v13, vcc
v_cmp_eq_u32 vcc, v15, v3
v_lshlrev_b32 v14, 4, v14
v_mov_b32 v6, 0x3f80
v_lshlrev_b32 v6, v14, v6
v_cndmask_b32 v6, 0, v6, vcc
v_and_b32 v14, 2, v2
v_cmp_eq_u32 vcc, 0, v14
s_mov_b32 s60, 4
s_mov_b32 s61, 0
v_cndmask_b32 v244, 0, v6, vcc
v_cndmask_b32_e64 v245, v6, 0, vcc
s_add_u32 s63, s34, 442368
s_cmp_lt_u32 s2, 144
s_cselect_b32 s28, 0x10000, 0
s_or_b32 s56, s56, s28
v_mov_b32 v12, 90112
v_mov_b32 v242, 1

s_cmp_eq_u32 s25, 0
s_cbranch_scc1 L_xdone
L_nosig:

s_cmp_eq_u32 s25, 2
s_cbranch_scc1 L_xdone
s_add_u32 m0, s59, 0
s_nop 0
buffer_load_dwordx4 v248, s[8:11], 0 offen offset:0 nt lds
s_add_u32 m0, s59, 1024
s_nop 0
buffer_load_dwordx4 v249, s[8:11], 0 offen offset:0 nt lds
s_add_u32 m0, s59, 2048
s_nop 0
buffer_load_dwordx4 v250, s[8:11], 0 offen offset:0 nt lds
s_add_u32 m0, s59, 3072
s_nop 0
buffer_load_dwordx4 v251, s[8:11], 0 offen offset:0 nt lds
s_add_u32 m0, s59, 4096
s_nop 0
buffer_load_dwordx4 v252, s[8:11], 0 offen offset:0 nt lds
s_add_u32 m0, s59, 5120
s_nop 0
buffer_load_dwordx4 v253, s[8:11], 0 offen offset:0 nt lds
s_add_u32 m0, s59, 6144
s_nop 0
buffer_load_dwordx4 v254, s[8:11], 0 offen offset:0 nt lds
s_add_u32 m0, s59, 7168
s_nop 0
buffer_load_dwordx4 v255, s[8:11], 0 offen offset:0 nt lds
s_add_u32 m0, s59, 32640
s_nop 0
buffer_load_dwordx4 v248, s[8:11], 0 offen offset:128 nt lds
s_add_u32 m0, s59, 33664
s_nop 0
buffer_load_dwordx4 v249, s[8:11], 0 offen offset:128 nt lds
s_add_u32 m0, s59, 34688
s_nop 0
buffer_load_dwordx4 v250, s[8:11], 0 offen offset:128 nt lds
s_add_u32 m0, s59, 35712
s_nop 0
buffer_load_dwordx4 v251, s[8:11], 0 offen offset:128 nt lds
s_add_u32 m0, s59, 36736
s_nop 0
buffer_load_dwordx4 v252, s[8:11], 0 offen offset:128 nt lds
s_add_u32 m0, s59, 37760
s_nop 0
buffer_load_dwordx4 v253, s[8:11], 0 offen offset:128 nt lds
s_add_u32 m0, s59, 38784
s_nop 0
buffer_load_dwordx4 v254, s[8:11], 0 offen offset:128 nt lds
s_add_u32 m0, s59, 39808
s_nop 0
buffer_load_dwordx4 v255, s[8:11], 0 offen offset:128 nt lds
L_xdone:
s_cmp_lg_u32 s24, 0
s_cbranch_scc1 L_join
s_mov_b32 s28, 7
s_mov_b32 s29, 0
s_mov_b32 s31, 20000
s_cmp_lt_u32 s2, 144
s_cselect_b32 s30, 5, 10
s_sub_u32 s30, s31, s30
v_mov_b32 v15, 4727844
v_lshlrev_b32 v13, 3, v1
v_lshrrev_b32 v15, v13, v15
v_and_b32 v15, 0xff, v15
s_waitcnt vmcnt(0)
v_add_u32 v181, v181, v15
s_mov_b64 exec, 7
L_poll:
buffer_load_dword v13, v183, s[20:23], 0 offen sc1
s_waitcnt vmcnt(0)
v_cmp_eq_u32 vcc, v13, v181
s_nop 3
s_and_b64 vcc, vcc, s[28:29]
s_cmp_eq_u64 vcc, s[28:29]
s_cbranch_scc1 L_polled
s_sleep 8
s_sub_u32 s31, s31, 1
s_cmp_gt_u32 s31, s30
s_cbranch_scc1 L_poll
v_mov_b32 v15, 0
buffer_load_dword v14, v15, s[92:95], 0 offen sc1
s_waitcnt vmcnt(0)
v_readfirstlane_b32 s12, v14
s_nop 0
s_cmp_eq_u32 s12, 144
s_cbranch_scc1 L_polled
s_sleep 24
s_cmp_lg_u32 s31, 0
s_cbranch_scc1 L_poll
L_polled:
s_mov_b64 exec, -1
v_mov_b32 v6, s31
ds_write_b32 v12, v6
s_waitcnt lgkmcnt(0)
L_join:
s_barrier
ds_read_b32 v6, v12
s_branch L_go2
L_fail:
s_mov_b32 s96, 0
s_mov_b32 s97, 1
s_mov_b32 s69, 0
s_waitcnt vmcnt(0)
s_barrier
s_branch L_unit
L_go:

s_mul_i32 s32, s24, 8192
s_mul_i32 s33, s24, 4096
s_mul_i32 s34, s24, 6144
s_mov_b32 s35, 1033291584
s_mov_b32 s36, 0x00010001
s_mov_b32 s37, 0x00010001

v_mov_b32 v6, 1
L_go2:
s_add_u32 m0, s32, 0
s_add_u32 s50, s32, 0
buffer_load_dwordx4 v228, s[20:23], s50 offen offset:0 sc1 lds
buffer_load_dwordx4 v228, s[20:23], s50 offen offset:1024 sc1 lds
buffer_load_dwordx4 v228, s[20:23], s50 offen offset:2048 sc1 lds
buffer_load_dwordx4 v228, s[20:23], s50 offen offset:3072 sc1 lds
s_add_u32 m0, s32, 4096
s_add_u32 s51, s32, 4096
buffer_load_dwordx4 v228, s[20:23], s51 offen offset:0 sc1 lds
buffer_load_dwordx4 v228, s[20:23], s51 offen offset:1024 sc1 lds
buffer_load_dwordx4 v228, s[20:23], s51 offen offset:2048 sc1 lds
buffer_load_dwordx4 v228, s[20:23], s51 offen offset:3072 sc1 lds
s_waitcnt vmcnt(8)
ds_read_b128 a[32:35], v230 offset:32768
ds_read_b128 a[48:51], v247 offset:32768
ds_read_b128 a[36:39], v230 offset:34816
ds_read_b128 a[52:55], v247 offset:34816
ds_read_b128 a[40:43], v230 offset:36864
ds_read_b128 a[56:59], v247 offset:36864
ds_read_b128 a[44:47], v230 offset:38912
ds_read_b128 a[60:63], v247 offset:38912
s_add_u32 m0, s32, 32768
s_add_u32 s52, s32, 32768
buffer_load_dwordx4 v228, s[20:23], s52 offen offset:0 sc1 lds
buffer_load_dwordx4 v228, s[20:23], s52 offen offset:1024 sc1 lds
buffer_load_dwordx4 v228, s[20:23], s52 offen offset:2048 sc1 lds
buffer_load_dwordx4 v228, s[20:23], s52 offen offset:3072 sc1 lds
s_add_u32 m0, s32, 36864
s_add_u32 s53, s32, 36864
buffer_load_dwordx4 v228, s[20:23], s53 offen offset:0 sc1 lds
buffer_load_dwordx4 v228, s[20:23], s53 offen offset:1024 sc1 lds
buffer_load_dwordx4 v228, s[20:23], s53 offen offset:2048 sc1 lds
buffer_load_dwordx4 v228, s[20:23], s53 offen offset:3072 sc1 lds
s_cmp_lt_u32 s56, 0x10000
s_cbranch_scc1 L_nolate
s_and_b32 s56, s56, 0xffff
ds_read_b128 a[0:3], v230 offset:0
ds_read_b128 a[16:19], v247 offset:0
ds_read_b128 a[4:7], v230 offset:2048
ds_read_b128 a[20:23], v247 offset:2048
ds_read_b128 a[8:11], v230 offset:4096
ds_read_b128 a[24:27], v247 offset:4096
ds_read_b128 a[12:15], v230 offset:6144
ds_read_b128 a[28:31], v247 offset:6144
s_add_u32 m0, s59, -256
s_waitcnt lgkmcnt(0)
buffer_load_dwordx4 v248, s[8:11], 0 offen offset:256 nt lds
s_add_u32 m0, s59, 768
s_nop 0
buffer_load_dwordx4 v249, s[8:11], 0 offen offset:256 nt lds
s_add_u32 m0, s59, 1792
s_nop 0
buffer_load_dwordx4 v250, s[8:11], 0 offen offset:256 nt lds
s_add_u32 m0, s59, 2816
s_nop 0
buffer_load_dwordx4 v251, s[8:11], 0 offen offset:256 nt lds
s_add_u32 m0, s59, 3840
s_nop 0
buffer_load_dwordx4 v252, s[8:11], 0 offen offset:256 nt lds
s_add_u32 m0, s59, 4864
s_nop 0
buffer_load_dwordx4 v253, s[8:11], 0 offen offset:256 nt lds
s_add_u32 m0, s59, 5888
s_nop 0
buffer_load_dwordx4 v254, s[8:11], 0 offen offset:256 nt lds
s_add_u32 m0, s59, 6912
s_nop 0
buffer_load_dwordx4 v255, s[8:11], 0 offen offset:256 nt lds
L_nolate:
s_waitcnt lgkmcnt(0)
v_readfirstlane_b32 s31, v6
s_nop 3
s_cmp_eq_u32 s31, 0
s_cbranch_scc1 L_fail
s_waitcnt vmcnt(8)
s_barrier
ds_read_b128 a[192:195], v228 offset:0
ds_read_b128 a[196:199], v228 offset:1024
s_waitcnt lgkmcnt(0)
v_mfma_f32_16x16x32_bf16 v[0:3], a[192:195], a[0:3], 0
ds_read_b128 a[200:203], v228 offset:2048
v_mfma_f32_16x16x32_bf16 v[0:3], a[196:199], a[16:19], v[0:3]
ds_read_b128 a[204:207], v228 offset:3072
v_mfma_f32_16x16x32_bf16 v[4:7], a[192:195], a[4:7], 0
ds_read_b128 a[208:211], v228 offset:4096
v_mfma_f32_16x16x32_bf16 v[4:7], a[196:199], a[20:23], v[4:7]
ds_read_b128 a[212:215], v228 offset:5120
v_mfma_f32_16x16x32_bf16 v[8:11], a[192:195], a[8:11], 0
s_cmp_lg_u32 s58, 1
s_cbranch_scc1 L_ndone
s_mov_b64 exec, 1
buffer_atomic_add v242, v242, s[92:95], 0 offen offset:3
s_mov_b64 exec, -1
L_ndone:
ds_read_b128 a[216:219], v228 offset:6144
v_mfma_f32_16x16x32_bf16 v[8:11], a[196:199], a[24:27], v[8:11]
s_add_u32 m0, s32, 65536
ds_read_b128 a[220:223], v228 offset:7168
v_mfma_f32_16x16x32_bf16 v[12:15], a[192:195], a[12:15], 0
s_add_u32 s54, s32, 65536
ds_read_b128 a[192:195], v228 offset:8192
v_mfma_f32_16x16x32_bf16 v[12:15], a[196:199], a[28:31], v[12:15]
s_waitcnt lgkmcnt(5)
ds_read_b128 a[196:199], v228 offset:9216
v_mfma_f32_16x16x32_bf16 v[16:19], a[200:203], a[0:3], 0
buffer_load_dwordx4 v228, s[20:23], s54 offen offset:0 sc1 lds
v_mfma_f32_16x16x32_bf16 v[16:19], a[204:207], a[16:19], v[16:19]
v_mfma_f32_16x16x32_bf16 v[20:23], a[200:203], a[4:7], 0
v_mfma_f32_16x16x32_bf16 v[20:23], a[204:207], a[20:23], v[20:23]
v_mfma_f32_16x16x32_bf16 v[24:27], a[200:203], a[8:11], 0
v_mfma_f32_16x16x32_bf16 v[24:27], a[204:207], a[24:27], v[24:27]
v_mfma_f32_16x16x32_bf16 v[28:31], a[200:203], a[12:15], 0
ds_read_b128 a[200:203], v228 offset:10240
v_mfma_f32_16x16x32_bf16 v[28:31], a[204:207], a[28:31], v[28:31]
s_waitcnt lgkmcnt(5)
ds_read_b128 a[204:207], v228 offset:11264
v_mfma_f32_16x16x32_bf16 v[32:35], a[208:211], a[0:3], 0
buffer_load_dwordx4 v228, s[20:23], s54 offen offset:1024 sc1 lds
v_mfma_f32_16x16x32_bf16 v[32:35], a[212:215], a[16:19], v[32:35]
v_mfma_f32_16x16x32_bf16 v[36:39], a[208:211], a[4:7], 0
v_mfma_f32_16x16x32_bf16 v[36:39], a[212:215], a[20:23], v[36:39]
v_mfma_f32_16x16x32_bf16 v[40:43], a[208:211], a[8:11], 0
v_mfma_f32_16x16x32_bf16 v[40:43], a[212:215], a[24:27], v[40:43]
v_mfma_f32_16x16x32_bf16 v[44:47], a[208:211], a[12:15], 0
ds_read_b128 a[208:211], v228 offset:12288
v_mfma_f32_16x16x32_bf16 v[44:47], a[212:215], a[28:31], v[44:47]
s_waitcnt lgkmcnt(5)
ds_read_b128 a[212:215], v228 offset:13312
v_mfma_f32_16x16x32_bf16 v[48:51], a[216:219], a[0:3], 0
buffer_load_dwordx4 v228, s[20:23], s54 offen offset:2048 sc1 lds
v_mfma_f32_16x16x32_bf16 v[48:51], a[220:223], a[16:19], v[48:51]
v_mfma_f32_16x16x32_bf16 v[52:55], a[216:219], a[4:7], 0
v_mfma_f32_16x16x32_bf16 v[52:55], a[220:223], a[20:23], v[52:55]
v_mfma_f32_16x16x32_bf16 v[56:59], a[216:219], a[8:11], 0
v_mfma_f32_16x16x32_bf16 v[56:59], a[220:223], a[24:27], v[56:59]
v_mfma_f32_16x16x32_bf16 v[60:63], a[216:219], a[12:15], 0
ds_read_b128 a[216:219], v228 offset:14336
v_mfma_f32_16x16x32_bf16 v[60:63], a[220:223], a[28:31], v[60:63]
s_waitcnt lgkmcnt(5)
ds_read_b128 a[220:223], v228 offset:15360
v_mfma_f32_16x16x32_bf16 v[64:67], a[192:195], a[0:3], 0
buffer_load_dwordx4 v228, s[20:23], s54 offen offset:3072 sc1 lds
v_mfma_f32_16x16x32_bf16 v[64:67], a[196:199], a[16:19], v[64:67]
s_add_u32 m0, s32, 69632
s_add_u32 s55, s32, 69632
v_mfma_f32_16x16x32_bf16 v[68:71], a[192:195], a[4:7], 0
v_mfma_f32_16x16x32_bf16 v[68:71], a[196:199], a[20:23], v[68:71]
v_mfma_f32_16x16x32_bf16 v[72:75], a[192:195], a[8:11], 0
v_mfma_f32_16x16x32_bf16 v[72:75], a[196:199], a[24:27], v[72:75]
v_mfma_f32_16x16x32_bf16 v[76:79], a[192:195], a[12:15], 0
ds_read_b128 a[192:195], v228 offset:16384
v_mfma_f32_16x16x32_bf16 v[76:79], a[196:199], a[28:31], v[76:79]
s_waitcnt lgkmcnt(5)
ds_read_b128 a[196:199], v228 offset:17408
v_mfma_f32_16x16x32_bf16 v[80:83], a[200:203], a[0:3], 0
buffer_load_dwordx4 v228, s[20:23], s55 offen offset:0 sc1 lds
v_mfma_f32_16x16x32_bf16 v[80:83], a[204:207], a[16:19], v[80:83]
v_mfma_f32_16x16x32_bf16 v[84:87], a[200:203], a[4:7], 0
v_mfma_f32_16x16x32_bf16 v[84:87], a[204:207], a[20:23], v[84:87]
v_mfma_f32_16x16x32_bf16 v[88:91], a[200:203], a[8:11], 0
v_mfma_f32_16x16x32_bf16 v[88:91], a[204:207], a[24:27], v[88:91]
v_mfma_f32_16x16x32_bf16 v[92:95], a[200:203], a[12:15], 0
ds_read_b128 a[200:203], v228 offset:18432
v_mfma_f32_16x16x32_bf16 v[92:95], a[204:207], a[28:31], v[92:95]
s_waitcnt lgkmcnt(5)
ds_read_b128 a[204:207], v228 offset:19456
v_mfma_f32_16x16x32_bf16 v[96:99], a[208:211], a[0:3], 0
buffer_load_dwordx4 v228, s[20:23], s55 offen offset:1024 sc1 lds
v_mfma_f32_16x16x32_bf16 v[96:99], a[212:215], a[16:19], v[96:99]
v_mfma_f32_16x16x32_bf16 v[100:103], a[208:211], a[4:7], 0
v_mfma_f32_16x16x32_bf16 v[100:103], a[212:215], a[20:23], v[100:103]
v_mfma_f32_16x16x32_bf16 v[104:107], a[208:211], a[8:11], 0
v_mfma_f32_16x16x32_bf16 v[104:107], a[212:215], a[24:27], v[104:107]
v_mfma_f32_16x16x32_bf16 v[108:111], a[208:211], a[12:15], 0
ds_read_b128 a[208:211], v228 offset:20480
v_mfma_f32_16x16x32_bf16 v[108:111], a[212:215], a[28:31], v[108:111]
s_waitcnt lgkmcnt(5)
ds_read_b128 a[212:215], v228 offset:21504
v_mfma_f32_16x16x32_bf16 v[112:115], a[216:219], a[0:3], 0
buffer_load_dwordx4 v228, s[20:23], s55 offen offset:2048 sc1 lds
v_mfma_f32_16x16x32_bf16 v[112:115], a[220:223], a[16:19], v[112:115]
v_mfma_f32_16x16x32_bf16 v[116:119], a[216:219], a[4:7], 0
v_mfma_f32_16x16x32_bf16 v[116:119], a[220:223], a[20:23], v[116:119]
v_mfma_f32_16x16x32_bf16 v[120:123], a[216:219], a[8:11], 0
v_mfma_f32_16x16x32_bf16 v[120:123], a[220:223], a[24:27], v[120:123]
v_mfma_f32_16x16x32_bf16 v[124:127], a[216:219], a[12:15], 0
ds_read_b128 a[216:219], v228 offset:22528
v_mfma_f32_16x16x32_bf16 v[124:127], a[220:223], a[28:31], v[124:127]
s_waitcnt lgkmcnt(5)
ds_read_b128 a[220:223], v228 offset:23552
v_mfma_f32_16x16x32_bf16 v[128:131], a[192:195], a[0:3], 0
buffer_load_dwordx4 v228, s[20:23], s55 offen offset:3072 sc1 lds
v_mfma_f32_16x16x32_bf16 v[128:131], a[196:199], a[16:19], v[128:131]
s_add_u32 m0, s59, 32384
v_mfma_f32_16x16x32_bf16 v[132:135], a[192:195], a[4:7], 0
v_mfma_f32_16x16x32_bf16 v[132:135], a[196:199], a[20:23], v[132:135]
v_mfma_f32_16x16x32_bf16 v[136:139], a[192:195], a[8:11], 0
v_mfma_f32_16x16x32_bf16 v[136:139], a[196:199], a[24:27], v[136:139]
v_mfma_f32_16x16x32_bf16 v[140:143], a[192:195], a[12:15], 0
ds_read_b128 a[192:195], v228 offset:24576
v_mfma_f32_16x16x32_bf16 v[140:143], a[196:199], a[28:31], v[140:143]
s_waitcnt lgkmcnt(5)
ds_read_b128 a[196:199], v228 offset:25600
v_mfma_f32_16x16x32_bf16 v[144:147], a[200:203], a[0:3], 0
v_mfma_f32_16x16x32_bf16 v[144:147], a[204:207], a[16:19], v[144:147]
v_mfma_f32_16x16x32_bf16 v[148:151], a[200:203], a[4:7], 0
v_mfma_f32_16x16x32_bf16 v[148:151], a[204:207], a[20:23], v[148:151]
v_mfma_f32_16x16x32_bf16 v[152:155], a[200:203], a[8:11], 0
v_mfma_f32_16x16x32_bf16 v[152:155], a[204:207], a[24:27], v[152:155]
v_mfma_f32_16x16x32_bf16 v[156:159], a[200:203], a[12:15], 0
ds_read_b128 a[200:203], v228 offset:26624
v_mfma_f32_16x16x32_bf16 v[156:159], a[204:207], a[28:31], v[156:159]
s_waitcnt lgkmcnt(5)
ds_read_b128 a[204:207], v228 offset:27648
v_mfma_f32_16x16x32_bf16 v[160:163], a[208:211], a[0:3], 0
v_mfma_f32_16x16x32_bf16 v[160:163], a[212:215], a[16:19], v[160:163]
v_mfma_f32_16x16x32_bf16 v[164:167], a[208:211], a[4:7], 0
v_mfma_f32_16x16x32_bf16 v[164:167], a[212:215], a[20:23], v[164:167]
v_mfma_f32_16x16x32_bf16 v[168:171], a[208:211], a[8:11], 0
v_mfma_f32_16x16x32_bf16 v[168:171], a[212:215], a[24:27], v[168:171]
v_mfma_f32_16x16x32_bf16 v[172:175], a[208:211], a[12:15], 0
ds_read_b128 a[208:211], v228 offset:28672
v_mfma_f32_16x16x32_bf16 v[172:175], a[212:215], a[28:31], v[172:175]
s_waitcnt lgkmcnt(5)
ds_read_b128 a[212:215], v228 offset:29696
v_mfma_f32_16x16x32_bf16 v[176:179], a[216:219], a[0:3], 0
v_mfma_f32_16x16x32_bf16 v[176:179], a[220:223], a[16:19], v[176:179]
v_mfma_f32_16x16x32_bf16 v[180:183], a[216:219], a[4:7], 0
v_mfma_f32_16x16x32_bf16 v[180:183], a[220:223], a[20:23], v[180:183]
v_mfma_f32_16x16x32_bf16 v[184:187], a[216:219], a[8:11], 0
v_mfma_f32_16x16x32_bf16 v[184:187], a[220:223], a[24:27], v[184:187]
v_mfma_f32_16x16x32_bf16 v[188:191], a[216:219], a[12:15], 0
ds_read_b128 a[216:219], v228 offset:30720
v_mfma_f32_16x16x32_bf16 v[188:191], a[220:223], a[28:31], v[188:191]
s_waitcnt lgkmcnt(5)
ds_read_b128 a[220:223], v228 offset:31744
v_mfma_f32_16x16x32_bf16 v[192:195], a[192:195], a[0:3], 0
v_mfma_f32_16x16x32_bf16 v[192:195], a[196:199], a[16:19], v[192:195]
v_mfma_f32_16x16x32_bf16 v[196:199], a[192:195], a[4:7], 0
v_mfma_f32_16x16x32_bf16 v[196:199], a[196:199], a[20:23], v[196:199]
v_mfma_f32_16x16x32_bf16 v[200:203], a[192:195], a[8:11], 0
buffer_load_dwordx4 v248, s[8:11], 0 offen offset:384 nt lds
v_mfma_f32_16x16x32_bf16 v[200:203], a[196:199], a[24:27], v[200:203]
s_add_u32 m0, s59, 33408
v_mfma_f32_16x16x32_bf16 v[204:207], a[192:195], a[12:15], 0
v_mfma_f32_16x16x32_bf16 v[204:207], a[196:199], a[28:31], v[204:207]
s_waitcnt lgkmcnt(4)
v_mfma_f32_16x16x32_bf16 v[208:211], a[200:203], a[0:3], 0
s_waitcnt vmcnt(9) lgkmcnt(0)
s_barrier
ds_read_b128 a[192:195], v228 offset:32768
v_mfma_f32_16x16x32_bf16 v[208:211], a[204:207], a[16:19], v[208:211]
ds_read_b128 a[196:199], v228 offset:33792
v_mfma_f32_16x16x32_bf16 v[212:215], a[200:203], a[4:7], 0
v_mfma_f32_16x16x32_bf16 v[212:215], a[204:207], a[20:23], v[212:215]
v_mfma_f32_16x16x32_bf16 v[216:219], a[200:203], a[8:11], 0
buffer_load_dwordx4 v249, s[8:11], 0 offen offset:384 nt lds
v_mfma_f32_16x16x32_bf16 v[216:219], a[204:207], a[24:27], v[216:219]
s_add_u32 m0, s59, 34432
v_mfma_f32_16x16x32_bf16 v[220:223], a[200:203], a[12:15], 0
ds_read_b128 a[200:203], v228 offset:34816
v_mfma_f32_16x16x32_bf16 v[220:223], a[204:207], a[28:31], v[220:223]
ds_read_b128 a[204:207], v228 offset:35840
v_mfma_f32_16x16x32_bf16 a[224:227], a[208:211], a[0:3], 0
v_mfma_f32_16x16x32_bf16 a[224:227], a[212:215], a[16:19], a[224:227]
v_mfma_f32_16x16x32_bf16 a[228:231], a[208:211], a[4:7], 0
v_mfma_f32_16x16x32_bf16 a[228:231], a[212:215], a[20:23], a[228:231]
v_mfma_f32_16x16x32_bf16 a[232:235], a[208:211], a[8:11], 0
buffer_load_dwordx4 v250, s[8:11], 0 offen offset:384 nt lds
v_mfma_f32_16x16x32_bf16 a[232:235], a[212:215], a[24:27], a[232:235]
s_add_u32 m0, s59, 35456
v_mfma_f32_16x16x32_bf16 a[236:239], a[208:211], a[12:15], 0
ds_read_b128 a[208:211], v228 offset:36864
v_mfma_f32_16x16x32_bf16 a[236:239], a[212:215], a[28:31], a[236:239]
ds_read_b128 a[212:215], v228 offset:37888
v_mfma_f32_16x16x32_bf16 a[240:243], a[216:219], a[0:3], 0
v_mfma_f32_16x16x32_bf16 a[240:243], a[220:223], a[16:19], a[240:243]
v_mfma_f32_16x16x32_bf16 a[244:247], a[216:219], a[4:7], 0
v_mfma_f32_16x16x32_bf16 a[244:247], a[220:223], a[20:23], a[244:247]
v_mfma_f32_16x16x32_bf16 a[248:251], a[216:219], a[8:11], 0
buffer_load_dwordx4 v251, s[8:11], 0 offen offset:384 nt lds
v_mfma_f32_16x16x32_bf16 a[248:251], a[220:223], a[24:27], a[248:251]
s_add_u32 m0, s59, 36480
v_mfma_f32_16x16x32_bf16 a[252:255], a[216:219], a[12:15], 0
ds_read_b128 a[216:219], v228 offset:38912
v_mfma_f32_16x16x32_bf16 a[252:255], a[220:223], a[28:31], a[252:255]
s_waitcnt lgkmcnt(5)
ds_read_b128 a[220:223], v228 offset:39936
v_mfma_f32_16x16x32_bf16 v[0:3], a[192:195], a[32:35], v[0:3]
v_mfma_f32_16x16x32_bf16 v[0:3], a[196:199], a[48:51], v[0:3]
v_mfma_f32_16x16x32_bf16 v[4:7], a[192:195], a[36:39], v[4:7]
v_mfma_f32_16x16x32_bf16 v[4:7], a[196:199], a[52:55], v[4:7]
v_mfma_f32_16x16x32_bf16 v[8:11], a[192:195], a[40:43], v[8:11]
buffer_load_dwordx4 v252, s[8:11], 0 offen offset:384 nt lds
v_mfma_f32_16x16x32_bf16 v[8:11], a[196:199], a[56:59], v[8:11]
s_add_u32 m0, s59, 37504
v_mfma_f32_16x16x32_bf16 v[12:15], a[192:195], a[44:47], v[12:15]
ds_read_b128 a[192:195], v228 offset:40960
v_mfma_f32_16x16x32_bf16 v[12:15], a[196:199], a[60:63], v[12:15]
s_waitcnt lgkmcnt(5)
ds_read_b128 a[196:199], v228 offset:41984
v_mfma_f32_16x16x32_bf16 v[16:19], a[200:203], a[32:35], v[16:19]
v_mfma_f32_16x16x32_bf16 v[16:19], a[204:207], a[48:51], v[16:19]
v_mfma_f32_16x16x32_bf16 v[20:23], a[200:203], a[36:39], v[20:23]
v_mfma_f32_16x16x32_bf16 v[20:23], a[204:207], a[52:55], v[20:23]
v_mfma_f32_16x16x32_bf16 v[24:27], a[200:203], a[40:43], v[24:27]
buffer_load_dwordx4 v253, s[8:11], 0 offen offset:384 nt lds
v_mfma_f32_16x16x32_bf16 v[24:27], a[204:207], a[56:59], v[24:27]
s_add_u32 m0, s59, 38528
v_mfma_f32_16x16x32_bf16 v[28:31], a[200:203], a[44:47], v[28:31]
ds_read_b128 a[200:203], v228 offset:43008
v_mfma_f32_16x16x32_bf16 v[28:31], a[204:207], a[60:63], v[28:31]
s_waitcnt lgkmcnt(5)
ds_read_b128 a[204:207], v228 offset:44032
v_mfma_f32_16x16x32_bf16 v[32:35], a[208:211], a[32:35], v[32:35]
v_mfma_f32_16x16x32_bf16 v[32:35], a[212:215], a[48:51], v[32:35]
v_mfma_f32_16x16x32_bf16 v[36:39], a[208:211], a[36:39], v[36:39]
v_mfma_f32_16x16x32_bf16 v[36:39], a[212:215], a[52:55], v[36:39]
v_mfma_f32_16x16x32_bf16 v[40:43], a[208:211], a[40:43], v[40:43]
buffer_load_dwordx4 v254, s[8:11], 0 offen offset:384 nt lds
v_mfma_f32_16x16x32_bf16 v[40:43], a[212:215], a[56:59], v[40:43]
s_add_u32 m0, s59, 39552
v_mfma_f32_16x16x32_bf16 v[44:47], a[208:211], a[44:47], v[44:47]
ds_read_b128 a[208:211], v228 offset:45056
v_mfma_f32_16x16x32_bf16 v[44:47], a[212:215], a[60:63], v[44:47]
s_waitcnt lgkmcnt(5)
ds_read_b128 a[212:215], v228 offset:46080
v_mfma_f32_16x16x32_bf16 v[48:51], a[216:219], a[32:35], v[48:51]
v_mfma_f32_16x16x32_bf16 v[48:51], a[220:223], a[48:51], v[48:51]
v_mfma_f32_16x16x32_bf16 v[52:55], a[216:219], a[36:39], v[52:55]
v_mfma_f32_16x16x32_bf16 v[52:55], a[220:223], a[52:55], v[52:55]
v_mfma_f32_16x16x32_bf16 v[56:59], a[216:219], a[40:43], v[56:59]
buffer_load_dwordx4 v255, s[8:11], 0 offen offset:384 nt lds
v_mfma_f32_16x16x32_bf16 v[56:59], a[220:223], a[56:59], v[56:59]
s_add_u32 m0, s32, 0
s_add_u32 s50, s32, 98304
v_mfma_f32_16x16x32_bf16 v[60:63], a[216:219], a[44:47], v[60:63]
ds_read_b128 a[216:219], v228 offset:47104
v_mfma_f32_16x16x32_bf16 v[60:63], a[220:223], a[60:63], v[60:63]
s_waitcnt lgkmcnt(5)
ds_read_b128 a[220:223], v228 offset:48128
v_mfma_f32_16x16x32_bf16 v[64:67], a[192:195], a[32:35], v[64:67]
v_mfma_f32_16x16x32_bf16 v[64:67], a[196:199], a[48:51], v[64:67]
v_mfma_f32_16x16x32_bf16 v[68:71], a[192:195], a[36:39], v[68:71]
v_mfma_f32_16x16x32_bf16 v[68:71], a[196:199], a[52:55], v[68:71]
v_mfma_f32_16x16x32_bf16 v[72:75], a[192:195], a[40:43], v[72:75]
buffer_load_dwordx4 v228, s[20:23], s50 offen offset:0 sc1 lds
v_mfma_f32_16x16x32_bf16 v[72:75], a[196:199], a[56:59], v[72:75]
v_mfma_f32_16x16x32_bf16 v[76:79], a[192:195], a[44:47], v[76:79]
ds_read_b128 a[192:195], v228 offset:49152
v_mfma_f32_16x16x32_bf16 v[76:79], a[196:199], a[60:63], v[76:79]
s_waitcnt lgkmcnt(5)
ds_read_b128 a[196:199], v228 offset:50176
v_mfma_f32_16x16x32_bf16 v[80:83], a[200:203], a[32:35], v[80:83]
v_mfma_f32_16x16x32_bf16 v[80:83], a[204:207], a[48:51], v[80:83]
v_mfma_f32_16x16x32_bf16 v[84:87], a[200:203], a[36:39], v[84:87]
v_mfma_f32_16x16x32_bf16 v[84:87], a[204:207], a[52:55], v[84:87]
v_mfma_f32_16x16x32_bf16 v[88:91], a[200:203], a[40:43], v[88:91]
buffer_load_dwordx4 v228, s[20:23], s50 offen offset:1024 sc1 lds
v_mfma_f32_16x16x32_bf16 v[88:91], a[204:207], a[56:59], v[88:91]
v_mfma_f32_16x16x32_bf16 v[92:95], a[200:203], a[44:47], v[92:95]
ds_read_b128 a[200:203], v228 offset:51200
v_mfma_f32_16x16x32_bf16 v[92:95], a[204:207], a[60:63], v[92:95]
s_waitcnt lgkmcnt(5)
ds_read_b128 a[204:207], v228 offset:52224
v_mfma_f32_16x16x32_bf16 v[96:99], a[208:211], a[32:35], v[96:99]
v_mfma_f32_16x16x32_bf16 v[96:99], a[212:215], a[48:51], v[96:99]
v_mfma_f32_16x16x32_bf16 v[100:103], a[208:211], a[36:39], v[100:103]
v_mfma_f32_16x16x32_bf16 v[100:103], a[212:215], a[52:55], v[100:103]
v_mfma_f32_16x16x32_bf16 v[104:107], a[208:211], a[40:43], v[104:107]
buffer_load_dwordx4 v228, s[20:23], s50 offen offset:2048 sc1 lds
v_mfma_f32_16x16x32_bf16 v[104:107], a[212:215], a[56:59], v[104:107]
v_mfma_f32_16x16x32_bf16 v[108:111], a[208:211], a[44:47], v[108:111]
ds_read_b128 a[208:211], v228 offset:53248
v_mfma_f32_16x16x32_bf16 v[108:111], a[212:215], a[60:63], v[108:111]
s_waitcnt lgkmcnt(5)
ds_read_b128 a[212:215], v228 offset:54272
v_mfma_f32_16x16x32_bf16 v[112:115], a[216:219], a[32:35], v[112:115]
v_mfma_f32_16x16x32_bf16 v[112:115], a[220:223], a[48:51], v[112:115]
v_mfma_f32_16x16x32_bf16 v[116:119], a[216:219], a[36:39], v[116:119]
v_mfma_f32_16x16x32_bf16 v[116:119], a[220:223], a[52:55], v[116:119]
v_mfma_f32_16x16x32_bf16 v[120:123], a[216:219], a[40:43], v[120:123]
buffer_load_dwordx4 v228, s[20:23], s50 offen offset:3072 sc1 lds
v_mfma_f32_16x16x32_bf16 v[120:123], a[220:223], a[56:59], v[120:123]
s_add_u32 m0, s32, 4096
s_add_u32 s51, s32, 102400
v_mfma_f32_16x16x32_bf16 v[124:127], a[216:219], a[44:47], v[124:127]
ds_read_b128 a[216:219], v228 offset:55296
v_mfma_f32_16x16x32_bf16 v[124:127], a[220:223], a[60:63], v[124:127]
s_waitcnt lgkmcnt(5)
ds_read_b128 a[220:223], v228 offset:56320
v_mfma_f32_16x16x32_bf16 v[128:131], a[192:195], a[32:35], v[128:131]
v_mfma_f32_16x16x32_bf16 v[128:131], a[196:199], a[48:51], v[128:131]
v_mfma_f32_16x16x32_bf16 v[132:135], a[192:195], a[36:39], v[132:135]
v_mfma_f32_16x16x32_bf16 v[132:135], a[196:199], a[52:55], v[132:135]
v_mfma_f32_16x16x32_bf16 v[136:139], a[192:195], a[40:43], v[136:139]
buffer_load_dwordx4 v228, s[20:23], s51 offen offset:0 sc1 lds
v_mfma_f32_16x16x32_bf16 v[136:139], a[196:199], a[56:59], v[136:139]
v_mfma_f32_16x16x32_bf16 v[140:143], a[192:195], a[44:47], v[140:143]
ds_read_b128 a[192:195], v228 offset:57344
v_mfma_f32_16x16x32_bf16 v[140:143], a[196:199], a[60:63], v[140:143]
s_waitcnt lgkmcnt(5)
ds_read_b128 a[196:199], v228 offset:58368
v_mfma_f32_16x16x32_bf16 v[144:147], a[200:203], a[32:35], v[144:147]
v_mfma_f32_16x16x32_bf16 v[144:147], a[204:207], a[48:51], v[144:147]
v_mfma_f32_16x16x32_bf16 v[148:151], a[200:203], a[36:39], v[148:151]
v_mfma_f32_16x16x32_bf16 v[148:151], a[204:207], a[52:55], v[148:151]
v_mfma_f32_16x16x32_bf16 v[152:155], a[200:203], a[40:43], v[152:155]
buffer_load_dwordx4 v228, s[20:23], s51 offen offset:1024 sc1 lds
v_mfma_f32_16x16x32_bf16 v[152:155], a[204:207], a[56:59], v[152:155]
v_mfma_f32_16x16x32_bf16 v[156:159], a[200:203], a[44:47], v[156:159]
ds_read_b128 a[200:203], v228 offset:59392
v_mfma_f32_16x16x32_bf16 v[156:159], a[204:207], a[60:63], v[156:159]
s_waitcnt lgkmcnt(5)
ds_read_b128 a[204:207], v228 offset:60416
v_mfma_f32_16x16x32_bf16 v[160:163], a[208:211], a[32:35], v[160:163]
v_mfma_f32_16x16x32_bf16 v[160:163], a[212:215], a[48:51], v[160:163]
v_mfma_f32_16x16x32_bf16 v[164:167], a[208:211], a[36:39], v[164:167]
v_mfma_f32_16x16x32_bf16 v[164:167], a[212:215], a[52:55], v[164:167]
v_mfma_f32_16x16x32_bf16 v[168:171], a[208:211], a[40:43], v[168:171]
buffer_load_dwordx4 v228, s[20:23], s51 offen offset:2048 sc1 lds
v_mfma_f32_16x16x32_bf16 v[168:171], a[212:215], a[56:59], v[168:171]
v_mfma_f32_16x16x32_bf16 v[172:175], a[208:211], a[44:47], v[172:175]
ds_read_b128 a[208:211], v228 offset:61440
v_mfma_f32_16x16x32_bf16 v[172:175], a[212:215], a[60:63], v[172:175]
s_waitcnt lgkmcnt(5)
ds_read_b128 a[212:215], v228 offset:62464
v_mfma_f32_16x16x32_bf16 v[176:179], a[216:219], a[32:35], v[176:179]
v_mfma_f32_16x16x32_bf16 v[176:179], a[220:223], a[48:51], v[176:179]
v_mfma_f32_16x16x32_bf16 v[180:183], a[216:219], a[36:39], v[180:183]
v_mfma_f32_16x16x32_bf16 v[180:183], a[220:223], a[52:55], v[180:183]
v_mfma_f32_16x16x32_bf16 v[184:187], a[216:219], a[40:43], v[184:187]
buffer_load_dwordx4 v228, s[20:23], s51 offen offset:3072 sc1 lds
v_mfma_f32_16x16x32_bf16 v[184:187], a[220:223], a[56:59], v[184:187]
s_add_u32 m0, s59, -512
v_mfma_f32_16x16x32_bf16 v[188:191], a[216:219], a[44:47], v[188:191]
ds_read_b128 a[216:219], v228 offset:63488
v_mfma_f32_16x16x32_bf16 v[188:191], a[220:223], a[60:63], v[188:191]
s_waitcnt lgkmcnt(5)
ds_read_b128 a[220:223], v228 offset:64512
v_mfma_f32_16x16x32_bf16 v[192:195], a[192:195], a[32:35], v[192:195]
v_mfma_f32_16x16x32_bf16 v[192:195], a[196:199], a[48:51], v[192:195]
v_mfma_f32_16x16x32_bf16 v[196:199], a[192:195], a[36:39], v[196:199]
v_mfma_f32_16x16x32_bf16 v[196:199], a[196:199], a[52:55], v[196:199]
v_mfma_f32_16x16x32_bf16 v[200:203], a[192:195], a[40:43], v[200:203]
v_mfma_f32_16x16x32_bf16 v[200:203], a[196:199], a[56:59], v[200:203]
v_mfma_f32_16x16x32_bf16 v[204:207], a[192:195], a[44:47], v[204:207]
v_mfma_f32_16x16x32_bf16 v[204:207], a[196:199], a[60:63], v[204:207]
s_waitcnt lgkmcnt(4)
v_mfma_f32_16x16x32_bf16 v[208:211], a[200:203], a[32:35], v[208:211]
s_waitcnt vmcnt(16) lgkmcnt(0)
s_barrier
ds_read_b128 a[192:195], v229 offset:16384
v_mfma_f32_16x16x32_bf16 v[208:211], a[204:207], a[48:51], v[208:211]
ds_read_b128 a[196:199], v229 offset:17408
v_mfma_f32_16x16x32_bf16 v[212:215], a[200:203], a[36:39], v[212:215]
v_mfma_f32_16x16x32_bf16 v[212:215], a[204:207], a[52:55], v[212:215]
v_mfma_f32_16x16x32_bf16 v[216:219], a[200:203], a[40:43], v[216:219]
v_mfma_f32_16x16x32_bf16 v[216:219], a[204:207], a[56:59], v[216:219]
v_mfma_f32_16x16x32_bf16 v[220:223], a[200:203], a[44:47], v[220:223]
ds_read_b128 a[64:67], v230 offset:0
v_mfma_f32_16x16x32_bf16 v[220:223], a[204:207], a[60:63], v[220:223]
ds_read_b128 a[80:83], v247 offset:0
v_mfma_f32_16x16x32_bf16 a[224:227], a[208:211], a[32:35], a[224:227]
ds_read_b128 a[68:71], v230 offset:2048
v_mfma_f32_16x16x32_bf16 a[224:227], a[212:215], a[48:51], a[224:227]
ds_read_b128 a[84:87], v247 offset:2048
v_mfma_f32_16x16x32_bf16 a[228:231], a[208:211], a[36:39], a[228:231]
ds_read_b128 a[72:75], v230 offset:4096
v_mfma_f32_16x16x32_bf16 a[228:231], a[212:215], a[52:55], a[228:231]
ds_read_b128 a[88:91], v247 offset:4096
v_mfma_f32_16x16x32_bf16 a[232:235], a[208:211], a[40:43], a[232:235]
ds_read_b128 a[76:79], v230 offset:6144
v_mfma_f32_16x16x32_bf16 a[232:235], a[212:215], a[56:59], a[232:235]
ds_read_b128 a[92:95], v247 offset:6144
v_mfma_f32_16x16x32_bf16 a[236:239], a[208:211], a[44:47], a[236:239]
ds_read_b128 a[200:203], v229 offset:18432
v_mfma_f32_16x16x32_bf16 a[236:239], a[212:215], a[60:63], a[236:239]
ds_read_b128 a[204:207], v229 offset:19456
v_mfma_f32_16x16x32_bf16 a[240:243], a[216:219], a[32:35], a[240:243]
ds_read_b128 a[208:211], v229 offset:20480
v_mfma_f32_16x16x32_bf16 a[240:243], a[220:223], a[48:51], a[240:243]
ds_read_b128 a[212:215], v229 offset:21504
v_mfma_f32_16x16x32_bf16 a[244:247], a[216:219], a[36:39], a[244:247]
v_mfma_f32_16x16x32_bf16 a[244:247], a[220:223], a[52:55], a[244:247]
v_mfma_f32_16x16x32_bf16 a[248:251], a[216:219], a[40:43], a[248:251]
v_mfma_f32_16x16x32_bf16 a[248:251], a[220:223], a[56:59], a[248:251]
v_mfma_f32_16x16x32_bf16 a[252:255], a[216:219], a[44:47], a[252:255]
ds_read_b128 a[216:219], v229 offset:22528
v_mfma_f32_16x16x32_bf16 a[252:255], a[220:223], a[60:63], a[252:255]
s_waitcnt lgkmcnt(12)
ds_read_b128 a[220:223], v229 offset:23552
v_mfma_f32_16x16x32_bf16 v[0:3], a[192:195], a[64:67], v[0:3]
s_waitcnt lgkmcnt(6)
buffer_load_dwordx4 v248, s[8:11], 0 offen offset:512 nt lds
v_mfma_f32_16x16x32_bf16 v[0:3], a[196:199], a[80:83], v[0:3]
s_add_u32 m0, s59, 512
v_mfma_f32_16x16x32_bf16 v[4:7], a[192:195], a[68:71], v[4:7]
v_mfma_f32_16x16x32_bf16 v[4:7], a[196:199], a[84:87], v[4:7]
v_mfma_f32_16x16x32_bf16 v[8:11], a[192:195], a[72:75], v[8:11]
v_mfma_f32_16x16x32_bf16 v[8:11], a[196:199], a[88:91], v[8:11]
v_mfma_f32_16x16x32_bf16 v[12:15], a[192:195], a[76:79], v[12:15]
ds_read_b128 a[192:195], v229 offset:24576
v_mfma_f32_16x16x32_bf16 v[12:15], a[196:199], a[92:95], v[12:15]
s_waitcnt lgkmcnt(5)
ds_read_b128 a[196:199], v229 offset:25600
v_mfma_f32_16x16x32_bf16 v[16:19], a[200:203], a[64:67], v[16:19]
buffer_load_dwordx4 v249, s[8:11], 0 offen offset:512 nt lds
v_mfma_f32_16x16x32_bf16 v[16:19], a[204:207], a[80:83], v[16:19]
s_add_u32 m0, s59, 1536
v_mfma_f32_16x16x32_bf16 v[20:23], a[200:203], a[68:71], v[20:23]
v_mfma_f32_16x16x32_bf16 v[20:23], a[204:207], a[84:87], v[20:23]
v_mfma_f32_16x16x32_bf16 v[24:27], a[200:203], a[72:75], v[24:27]
v_mfma_f32_16x16x32_bf16 v[24:27], a[204:207], a[88:91], v[24:27]
v_mfma_f32_16x16x32_bf16 v[28:31], a[200:203], a[76:79], v[28:31]
ds_read_b128 a[200:203], v229 offset:26624
v_mfma_f32_16x16x32_bf16 v[28:31], a[204:207], a[92:95], v[28:31]
s_waitcnt lgkmcnt(5)
ds_read_b128 a[204:207], v229 offset:27648
v_mfma_f32_16x16x32_bf16 v[32:35], a[208:211], a[64:67], v[32:35]
buffer_load_dwordx4 v250, s[8:11], 0 offen offset:512 nt lds
v_mfma_f32_16x16x32_bf16 v[32:35], a[212:215], a[80:83], v[32:35]
s_add_u32 m0, s59, 2560
v_mfma_f32_16x16x32_bf16 v[36:39], a[208:211], a[68:71], v[36:39]
v_mfma_f32_16x16x32_bf16 v[36:39], a[212:215], a[84:87], v[36:39]
v_mfma_f32_16x16x32_bf16 v[40:43], a[208:211], a[72:75], v[40:43]
v_mfma_f32_16x16x32_bf16 v[40:43], a[212:215], a[88:91], v[40:43]
v_mfma_f32_16x16x32_bf16 v[44:47], a[208:211], a[76:79], v[44:47]
ds_read_b128 a[208:211], v229 offset:28672
v_mfma_f32_16x16x32_bf16 v[44:47], a[212:215], a[92:95], v[44:47]
s_waitcnt lgkmcnt(5)
ds_read_b128 a[212:215], v229 offset:29696
v_mfma_f32_16x16x32_bf16 v[48:51], a[216:219], a[64:67], v[48:51]
buffer_load_dwordx4 v251, s[8:11], 0 offen offset:512 nt lds
v_mfma_f32_16x16x32_bf16 v[48:51], a[220:223], a[80:83], v[48:51]
s_add_u32 m0, s59, 3584
v_mfma_f32_16x16x32_bf16 v[52:55], a[216:219], a[68:71], v[52:55]
v_mfma_f32_16x16x32_bf16 v[52:55], a[220:223], a[84:87], v[52:55]
v_mfma_f32_16x16x32_bf16 v[56:59], a[216:219], a[72:75], v[56:59]
v_mfma_f32_16x16x32_bf16 v[56:59], a[220:223], a[88:91], v[56:59]
v_mfma_f32_16x16x32_bf16 v[60:63], a[216:219], a[76:79], v[60:63]
ds_read_b128 a[216:219], v229 offset:30720
v_mfma_f32_16x16x32_bf16 v[60:63], a[220:223], a[92:95], v[60:63]
s_waitcnt lgkmcnt(5)
ds_read_b128 a[220:223], v229 offset:31744
v_mfma_f32_16x16x32_bf16 v[64:67], a[192:195], a[64:67], v[64:67]
buffer_load_dwordx4 v252, s[8:11], 0 offen offset:512 nt lds
v_mfma_f32_16x16x32_bf16 v[64:67], a[196:199], a[80:83], v[64:67]
s_add_u32 m0, s59, 4608
v_mfma_f32_16x16x32_bf16 v[68:71], a[192:195], a[68:71], v[68:71]
v_mfma_f32_16x16x32_bf16 v[68:71], a[196:199], a[84:87], v[68:71]
v_mfma_f32_16x16x32_bf16 v[72:75], a[192:195], a[72:75], v[72:75]
v_mfma_f32_16x16x32_bf16 v[72:75], a[196:199], a[88:91], v[72:75]
v_mfma_f32_16x16x32_bf16 v[76:79], a[192:195], a[76:79], v[76:79]
ds_read_b128 a[192:195], v229 offset:32768
v_mfma_f32_16x16x32_bf16 v[76:79], a[196:199], a[92:95], v[76:79]
s_waitcnt lgkmcnt(5)
ds_read_b128 a[196:199], v229 offset:33792
v_mfma_f32_16x16x32_bf16 v[80:83], a[200:203], a[64:67], v[80:83]
buffer_load_dwordx4 v253, s[8:11], 0 offen offset:512 nt lds
v_mfma_f32_16x16x32_bf16 v[80:83], a[204:207], a[80:83], v[80:83]
s_add_u32 m0, s59, 5632
v_mfma_f32_16x16x32_bf16 v[84:87], a[200:203], a[68:71], v[84:87]
v_mfma_f32_16x16x32_bf16 v[84:87], a[204:207], a[84:87], v[84:87]
v_mfma_f32_16x16x32_bf16 v[88:91], a[200:203], a[72:75], v[88:91]
v_mfma_f32_16x16x32_bf16 v[88:91], a[204:207], a[88:91], v[88:91]
v_mfma_f32_16x16x32_bf16 v[92:95], a[200:203], a[76:79], v[92:95]
ds_read_b128 a[200:203], v229 offset:34816
v_mfma_f32_16x16x32_bf16 v[92:95], a[204:207], a[92:95], v[92:95]
s_waitcnt lgkmcnt(5)
ds_read_b128 a[204:207], v229 offset:35840
v_mfma_f32_16x16x32_bf16 v[96:99], a[208:211], a[64:67], v[96:99]
buffer_load_dwordx4 v254, s[8:11], 0 offen offset:512 nt lds
v_mfma_f32_16x16x32_bf16 v[96:99], a[212:215], a[80:83], v[96:99]
s_add_u32 m0, s59, 6656
v_mfma_f32_16x16x32_bf16 v[100:103], a[208:211], a[68:71], v[100:103]
v_mfma_f32_16x16x32_bf16 v[100:103], a[212:215], a[84:87], v[100:103]
v_mfma_f32_16x16x32_bf16 v[104:107], a[208:211], a[72:75], v[104:107]
v_mfma_f32_16x16x32_bf16 v[104:107], a[212:215], a[88:91], v[104:107]
v_mfma_f32_16x16x32_bf16 v[108:111], a[208:211], a[76:79], v[108:111]
ds_read_b128 a[208:211], v229 offset:36864
v_mfma_f32_16x16x32_bf16 v[108:111], a[212:215], a[92:95], v[108:111]
s_waitcnt lgkmcnt(5)
ds_read_b128 a[212:215], v229 offset:37888
v_mfma_f32_16x16x32_bf16 v[112:115], a[216:219], a[64:67], v[112:115]
buffer_load_dwordx4 v255, s[8:11], 0 offen offset:512 nt lds
v_mfma_f32_16x16x32_bf16 v[112:115], a[220:223], a[80:83], v[112:115]
s_add_u32 m0, s32, 32768
s_add_u32 s52, s32, 131072
v_mfma_f32_16x16x32_bf16 v[116:119], a[216:219], a[68:71], v[116:119]
v_mfma_f32_16x16x32_bf16 v[116:119], a[220:223], a[84:87], v[116:119]
v_mfma_f32_16x16x32_bf16 v[120:123], a[216:219], a[72:75], v[120:123]
v_mfma_f32_16x16x32_bf16 v[120:123], a[220:223], a[88:91], v[120:123]
v_mfma_f32_16x16x32_bf16 v[124:127], a[216:219], a[76:79], v[124:127]
ds_read_b128 a[216:219], v229 offset:38912
v_mfma_f32_16x16x32_bf16 v[124:127], a[220:223], a[92:95], v[124:127]
s_waitcnt lgkmcnt(5)
ds_read_b128 a[220:223], v229 offset:39936
v_mfma_f32_16x16x32_bf16 v[128:131], a[192:195], a[64:67], v[128:131]
buffer_load_dwordx4 v228, s[20:23], s52 offen offset:0 sc1 lds
v_mfma_f32_16x16x32_bf16 v[128:131], a[196:199], a[80:83], v[128:131]
v_mfma_f32_16x16x32_bf16 v[132:135], a[192:195], a[68:71], v[132:135]
v_mfma_f32_16x16x32_bf16 v[132:135], a[196:199], a[84:87], v[132:135]
v_mfma_f32_16x16x32_bf16 v[136:139], a[192:195], a[72:75], v[136:139]
v_mfma_f32_16x16x32_bf16 v[136:139], a[196:199], a[88:91], v[136:139]
v_mfma_f32_16x16x32_bf16 v[140:143], a[192:195], a[76:79], v[140:143]
ds_read_b128 a[192:195], v229 offset:40960
v_mfma_f32_16x16x32_bf16 v[140:143], a[196:199], a[92:95], v[140:143]
s_waitcnt lgkmcnt(5)
ds_read_b128 a[196:199], v229 offset:41984
v_mfma_f32_16x16x32_bf16 v[144:147], a[200:203], a[64:67], v[144:147]
buffer_load_dwordx4 v228, s[20:23], s52 offen offset:1024 sc1 lds
v_mfma_f32_16x16x32_bf16 v[144:147], a[204:207], a[80:83], v[144:147]
v_mfma_f32_16x16x32_bf16 v[148:151], a[200:203], a[68:71], v[148:151]
v_mfma_f32_16x16x32_bf16 v[148:151], a[204:207], a[84:87], v[148:151]
v_mfma_f32_16x16x32_bf16 v[152:155], a[200:203], a[72:75], v[152:155]
v_mfma_f32_16x16x32_bf16 v[152:155], a[204:207], a[88:91], v[152:155]
v_mfma_f32_16x16x32_bf16 v[156:159], a[200:203], a[76:79], v[156:159]
ds_read_b128 a[200:203], v229 offset:43008
v_mfma_f32_16x16x32_bf16 v[156:159], a[204:207], a[92:95], v[156:159]
s_waitcnt lgkmcnt(5)
ds_read_b128 a[204:207], v229 offset:44032
v_mfma_f32_16x16x32_bf16 v[160:163], a[208:211], a[64:67], v[160:163]
buffer_load_dwordx4 v228, s[20:23], s52 offen offset:2048 sc1 lds
v_mfma_f32_16x16x32_bf16 v[160:163], a[212:215], a[80:83], v[160:163]
v_mfma_f32_16x16x32_bf16 v[164:167], a[208:211], a[68:71], v[164:167]
v_mfma_f32_16x16x32_bf16 v[164:167], a[212:215], a[84:87], v[164:167]
v_mfma_f32_16x16x32_bf16 v[168:171], a[208:211], a[72:75], v[168:171]
v_mfma_f32_16x16x32_bf16 v[168:171], a[212:215], a[88:91], v[168:171]
v_mfma_f32_16x16x32_bf16 v[172:175], a[208:211], a[76:79], v[172:175]
ds_read_b128 a[208:211], v229 offset:45056
v_mfma_f32_16x16x32_bf16 v[172:175], a[212:215], a[92:95], v[172:175]
s_waitcnt lgkmcnt(5)
ds_read_b128 a[212:215], v229 offset:46080
v_mfma_f32_16x16x32_bf16 v[176:179], a[216:219], a[64:67], v[176:179]
buffer_load_dwordx4 v228, s[20:23], s52 offen offset:3072 sc1 lds
v_mfma_f32_16x16x32_bf16 v[176:179], a[220:223], a[80:83], v[176:179]
s_add_u32 m0, s32, 36864
s_add_u32 s53, s32, 135168
v_mfma_f32_16x16x32_bf16 v[180:183], a[216:219], a[68:71], v[180:183]
v_mfma_f32_16x16x32_bf16 v[180:183], a[220:223], a[84:87], v[180:183]
v_mfma_f32_16x16x32_bf16 v[184:187], a[216:219], a[72:75], v[184:187]
v_mfma_f32_16x16x32_bf16 v[184:187], a[220:223], a[88:91], v[184:187]
v_mfma_f32_16x16x32_bf16 v[188:191], a[216:219], a[76:79], v[188:191]
ds_read_b128 a[216:219], v229 offset:47104
v_mfma_f32_16x16x32_bf16 v[188:191], a[220:223], a[92:95], v[188:191]
s_waitcnt lgkmcnt(5)
ds_read_b128 a[220:223], v229 offset:48128
v_mfma_f32_16x16x32_bf16 v[192:195], a[192:195], a[64:67], v[192:195]
buffer_load_dwordx4 v228, s[20:23], s53 offen offset:0 sc1 lds
v_mfma_f32_16x16x32_bf16 v[192:195], a[196:199], a[80:83], v[192:195]
v_mfma_f32_16x16x32_bf16 v[196:199], a[192:195], a[68:71], v[196:199]
v_mfma_f32_16x16x32_bf16 v[196:199], a[196:199], a[84:87], v[196:199]
v_mfma_f32_16x16x32_bf16 v[200:203], a[192:195], a[72:75], v[200:203]
v_mfma_f32_16x16x32_bf16 v[200:203], a[196:199], a[88:91], v[200:203]
v_mfma_f32_16x16x32_bf16 v[204:207], a[192:195], a[76:79], v[204:207]
v_mfma_f32_16x16x32_bf16 v[204:207], a[196:199], a[92:95], v[204:207]
s_waitcnt lgkmcnt(4)
v_mfma_f32_16x16x32_bf16 v[208:211], a[200:203], a[64:67], v[208:211]
s_waitcnt vmcnt(13) lgkmcnt(0)
s_barrier
buffer_load_dwordx4 v228, s[20:23], s53 offen offset:1024 sc1 lds
v_mfma_f32_16x16x32_bf16 v[208:211], a[204:207], a[80:83], v[208:211]
ds_read_b128 a[192:195], v228 offset:0
v_mfma_f32_16x16x32_bf16 v[212:215], a[200:203], a[68:71], v[212:215]
ds_read_b128 a[196:199], v228 offset:1024
v_mfma_f32_16x16x32_bf16 v[212:215], a[204:207], a[84:87], v[212:215]
v_mfma_f32_16x16x32_bf16 v[216:219], a[200:203], a[72:75], v[216:219]
v_mfma_f32_16x16x32_bf16 v[216:219], a[204:207], a[88:91], v[216:219]
v_mfma_f32_16x16x32_bf16 v[220:223], a[200:203], a[76:79], v[220:223]
ds_read_b128 a[96:99], v230 offset:32768
v_mfma_f32_16x16x32_bf16 v[220:223], a[204:207], a[92:95], v[220:223]
ds_read_b128 a[112:115], v247 offset:32768
v_mfma_f32_16x16x32_bf16 a[224:227], a[208:211], a[64:67], a[224:227]
buffer_load_dwordx4 v228, s[20:23], s53 offen offset:2048 sc1 lds
v_mfma_f32_16x16x32_bf16 a[224:227], a[212:215], a[80:83], a[224:227]
ds_read_b128 a[100:103], v230 offset:34816
v_mfma_f32_16x16x32_bf16 a[228:231], a[208:211], a[68:71], a[228:231]
ds_read_b128 a[116:119], v247 offset:34816
v_mfma_f32_16x16x32_bf16 a[228:231], a[212:215], a[84:87], a[228:231]
ds_read_b128 a[104:107], v230 offset:36864
v_mfma_f32_16x16x32_bf16 a[232:235], a[208:211], a[72:75], a[232:235]
ds_read_b128 a[120:123], v247 offset:36864
v_mfma_f32_16x16x32_bf16 a[232:235], a[212:215], a[88:91], a[232:235]
ds_read_b128 a[108:111], v230 offset:38912
v_mfma_f32_16x16x32_bf16 a[236:239], a[208:211], a[76:79], a[236:239]
ds_read_b128 a[124:127], v247 offset:38912
v_mfma_f32_16x16x32_bf16 a[236:239], a[212:215], a[92:95], a[236:239]
ds_read_b128 a[200:203], v228 offset:2048
v_mfma_f32_16x16x32_bf16 a[240:243], a[216:219], a[64:67], a[240:243]
buffer_load_dwordx4 v228, s[20:23], s53 offen offset:3072 sc1 lds
v_mfma_f32_16x16x32_bf16 a[240:243], a[220:223], a[80:83], a[240:243]
s_add_u32 m0, s59, 32128
ds_read_b128 a[204:207], v228 offset:3072
v_mfma_f32_16x16x32_bf16 a[244:247], a[216:219], a[68:71], a[244:247]
ds_read_b128 a[208:211], v228 offset:4096
v_mfma_f32_16x16x32_bf16 a[244:247], a[220:223], a[84:87], a[244:247]
ds_read_b128 a[212:215], v228 offset:5120
v_mfma_f32_16x16x32_bf16 a[248:251], a[216:219], a[72:75], a[248:251]
v_mfma_f32_16x16x32_bf16 a[248:251], a[220:223], a[88:91], a[248:251]
v_mfma_f32_16x16x32_bf16 a[252:255], a[216:219], a[76:79], a[252:255]
ds_read_b128 a[216:219], v228 offset:6144
v_mfma_f32_16x16x32_bf16 a[252:255], a[220:223], a[92:95], a[252:255]
s_waitcnt lgkmcnt(12)
ds_read_b128 a[220:223], v228 offset:7168
v_mfma_f32_16x16x32_bf16 v[0:3], a[192:195], a[96:99], v[0:3]
s_waitcnt lgkmcnt(6)
buffer_load_dwordx4 v248, s[8:11], 0 offen offset:640 nt lds
v_mfma_f32_16x16x32_bf16 v[0:3], a[196:199], a[112:115], v[0:3]
s_add_u32 m0, s59, 33152
v_mfma_f32_16x16x32_bf16 v[4:7], a[192:195], a[100:103], v[4:7]
v_mfma_f32_16x16x32_bf16 v[4:7], a[196:199], a[116:119], v[4:7]
v_mfma_f32_16x16x32_bf16 v[8:11], a[192:195], a[104:107], v[8:11]
v_mfma_f32_16x16x32_bf16 v[8:11], a[196:199], a[120:123], v[8:11]
v_mfma_f32_16x16x32_bf16 v[12:15], a[192:195], a[108:111], v[12:15]
ds_read_b128 a[192:195], v228 offset:8192
v_mfma_f32_16x16x32_bf16 v[12:15], a[196:199], a[124:127], v[12:15]
s_waitcnt lgkmcnt(5)
ds_read_b128 a[196:199], v228 offset:9216
v_mfma_f32_16x16x32_bf16 v[16:19], a[200:203], a[96:99], v[16:19]
buffer_load_dwordx4 v249, s[8:11], 0 offen offset:640 nt lds
v_mfma_f32_16x16x32_bf16 v[16:19], a[204:207], a[112:115], v[16:19]
s_add_u32 m0, s59, 34176
v_mfma_f32_16x16x32_bf16 v[20:23], a[200:203], a[100:103], v[20:23]
v_mfma_f32_16x16x32_bf16 v[20:23], a[204:207], a[116:119], v[20:23]
v_mfma_f32_16x16x32_bf16 v[24:27], a[200:203], a[104:107], v[24:27]
v_mfma_f32_16x16x32_bf16 v[24:27], a[204:207], a[120:123], v[24:27]
v_mfma_f32_16x16x32_bf16 v[28:31], a[200:203], a[108:111], v[28:31]
ds_read_b128 a[200:203], v228 offset:10240
v_mfma_f32_16x16x32_bf16 v[28:31], a[204:207], a[124:127], v[28:31]
s_waitcnt lgkmcnt(5)
ds_read_b128 a[204:207], v228 offset:11264
v_mfma_f32_16x16x32_bf16 v[32:35], a[208:211], a[96:99], v[32:35]
buffer_load_dwordx4 v250, s[8:11], 0 offen offset:640 nt lds
v_mfma_f32_16x16x32_bf16 v[32:35], a[212:215], a[112:115], v[32:35]
s_add_u32 m0, s59, 35200
v_mfma_f32_16x16x32_bf16 v[36:39], a[208:211], a[100:103], v[36:39]
v_mfma_f32_16x16x32_bf16 v[36:39], a[212:215], a[116:119], v[36:39]
v_mfma_f32_16x16x32_bf16 v[40:43], a[208:211], a[104:107], v[40:43]
v_mfma_f32_16x16x32_bf16 v[40:43], a[212:215], a[120:123], v[40:43]
v_mfma_f32_16x16x32_bf16 v[44:47], a[208:211], a[108:111], v[44:47]
ds_read_b128 a[208:211], v228 offset:12288
v_mfma_f32_16x16x32_bf16 v[44:47], a[212:215], a[124:127], v[44:47]
s_waitcnt lgkmcnt(5)
ds_read_b128 a[212:215], v228 offset:13312
v_mfma_f32_16x16x32_bf16 v[48:51], a[216:219], a[96:99], v[48:51]
buffer_load_dwordx4 v251, s[8:11], 0 offen offset:640 nt lds
v_mfma_f32_16x16x32_bf16 v[48:51], a[220:223], a[112:115], v[48:51]
s_add_u32 m0, s59, 36224
v_mfma_f32_16x16x32_bf16 v[52:55], a[216:219], a[100:103], v[52:55]
v_mfma_f32_16x16x32_bf16 v[52:55], a[220:223], a[116:119], v[52:55]
v_mfma_f32_16x16x32_bf16 v[56:59], a[216:219], a[104:107], v[56:59]
v_mfma_f32_16x16x32_bf16 v[56:59], a[220:223], a[120:123], v[56:59]
v_mfma_f32_16x16x32_bf16 v[60:63], a[216:219], a[108:111], v[60:63]
ds_read_b128 a[216:219], v228 offset:14336
v_mfma_f32_16x16x32_bf16 v[60:63], a[220:223], a[124:127], v[60:63]
s_waitcnt lgkmcnt(5)
ds_read_b128 a[220:223], v228 offset:15360
v_mfma_f32_16x16x32_bf16 v[64:67], a[192:195], a[96:99], v[64:67]
buffer_load_dwordx4 v252, s[8:11], 0 offen offset:640 nt lds
v_mfma_f32_16x16x32_bf16 v[64:67], a[196:199], a[112:115], v[64:67]
s_add_u32 m0, s59, 37248
v_mfma_f32_16x16x32_bf16 v[68:71], a[192:195], a[100:103], v[68:71]
v_mfma_f32_16x16x32_bf16 v[68:71], a[196:199], a[116:119], v[68:71]
v_mfma_f32_16x16x32_bf16 v[72:75], a[192:195], a[104:107], v[72:75]
v_mfma_f32_16x16x32_bf16 v[72:75], a[196:199], a[120:123], v[72:75]
v_mfma_f32_16x16x32_bf16 v[76:79], a[192:195], a[108:111], v[76:79]
ds_read_b128 a[192:195], v228 offset:16384
v_mfma_f32_16x16x32_bf16 v[76:79], a[196:199], a[124:127], v[76:79]
s_waitcnt lgkmcnt(5)
ds_read_b128 a[196:199], v228 offset:17408
v_mfma_f32_16x16x32_bf16 v[80:83], a[200:203], a[96:99], v[80:83]
buffer_load_dwordx4 v253, s[8:11], 0 offen offset:640 nt lds
v_mfma_f32_16x16x32_bf16 v[80:83], a[204:207], a[112:115], v[80:83]
s_add_u32 m0, s59, 38272
v_mfma_f32_16x16x32_bf16 v[84:87], a[200:203], a[100:103], v[84:87]
v_mfma_f32_16x16x32_bf16 v[84:87], a[204:207], a[116:119], v[84:87]
v_mfma_f32_16x16x32_bf16 v[88:91], a[200:203], a[104:107], v[88:91]
v_mfma_f32_16x16x32_bf16 v[88:91], a[204:207], a[120:123], v[88:91]
v_mfma_f32_16x16x32_bf16 v[92:95], a[200:203], a[108:111], v[92:95]
ds_read_b128 a[200:203], v228 offset:18432
v_mfma_f32_16x16x32_bf16 v[92:95], a[204:207], a[124:127], v[92:95]
s_waitcnt lgkmcnt(5)
ds_read_b128 a[204:207], v228 offset:19456
v_mfma_f32_16x16x32_bf16 v[96:99], a[208:211], a[96:99], v[96:99]
buffer_load_dwordx4 v254, s[8:11], 0 offen offset:640 nt lds
v_mfma_f32_16x16x32_bf16 v[96:99], a[212:215], a[112:115], v[96:99]
s_add_u32 m0, s59, 39296
v_mfma_f32_16x16x32_bf16 v[100:103], a[208:211], a[100:103], v[100:103]
v_mfma_f32_16x16x32_bf16 v[100:103], a[212:215], a[116:119], v[100:103]
v_mfma_f32_16x16x32_bf16 v[104:107], a[208:211], a[104:107], v[104:107]
v_mfma_f32_16x16x32_bf16 v[104:107], a[212:215], a[120:123], v[104:107]
v_mfma_f32_16x16x32_bf16 v[108:111], a[208:211], a[108:111], v[108:111]
ds_read_b128 a[208:211], v228 offset:20480
v_mfma_f32_16x16x32_bf16 v[108:111], a[212:215], a[124:127], v[108:111]
s_waitcnt lgkmcnt(5)
ds_read_b128 a[212:215], v228 offset:21504
v_mfma_f32_16x16x32_bf16 v[112:115], a[216:219], a[96:99], v[112:115]
buffer_load_dwordx4 v255, s[8:11], 0 offen offset:640 nt lds
v_mfma_f32_16x16x32_bf16 v[112:115], a[220:223], a[112:115], v[112:115]
s_add_u32 m0, s32, 65536
s_add_u32 s54, s32, 163840
v_mfma_f32_16x16x32_bf16 v[116:119], a[216:219], a[100:103], v[116:119]
v_mfma_f32_16x16x32_bf16 v[116:119], a[220:223], a[116:119], v[116:119]
v_mfma_f32_16x16x32_bf16 v[120:123], a[216:219], a[104:107], v[120:123]
v_mfma_f32_16x16x32_bf16 v[120:123], a[220:223], a[120:123], v[120:123]
v_mfma_f32_16x16x32_bf16 v[124:127], a[216:219], a[108:111], v[124:127]
ds_read_b128 a[216:219], v228 offset:22528
v_mfma_f32_16x16x32_bf16 v[124:127], a[220:223], a[124:127], v[124:127]
s_waitcnt lgkmcnt(5)
ds_read_b128 a[220:223], v228 offset:23552
v_mfma_f32_16x16x32_bf16 v[128:131], a[192:195], a[96:99], v[128:131]
buffer_load_dwordx4 v228, s[20:23], s54 offen offset:0 sc1 lds
v_mfma_f32_16x16x32_bf16 v[128:131], a[196:199], a[112:115], v[128:131]
v_mfma_f32_16x16x32_bf16 v[132:135], a[192:195], a[100:103], v[132:135]
v_mfma_f32_16x16x32_bf16 v[132:135], a[196:199], a[116:119], v[132:135]
v_mfma_f32_16x16x32_bf16 v[136:139], a[192:195], a[104:107], v[136:139]
v_mfma_f32_16x16x32_bf16 v[136:139], a[196:199], a[120:123], v[136:139]
v_mfma_f32_16x16x32_bf16 v[140:143], a[192:195], a[108:111], v[140:143]
ds_read_b128 a[192:195], v228 offset:24576
v_mfma_f32_16x16x32_bf16 v[140:143], a[196:199], a[124:127], v[140:143]
s_waitcnt lgkmcnt(5)
ds_read_b128 a[196:199], v228 offset:25600
v_mfma_f32_16x16x32_bf16 v[144:147], a[200:203], a[96:99], v[144:147]
buffer_load_dwordx4 v228, s[20:23], s54 offen offset:1024 sc1 lds
v_mfma_f32_16x16x32_bf16 v[144:147], a[204:207], a[112:115], v[144:147]
v_mfma_f32_16x16x32_bf16 v[148:151], a[200:203], a[100:103], v[148:151]
v_mfma_f32_16x16x32_bf16 v[148:151], a[204:207], a[116:119], v[148:151]
v_mfma_f32_16x16x32_bf16 v[152:155], a[200:203], a[104:107], v[152:155]
v_mfma_f32_16x16x32_bf16 v[152:155], a[204:207], a[120:123], v[152:155]
v_mfma_f32_16x16x32_bf16 v[156:159], a[200:203], a[108:111], v[156:159]
ds_read_b128 a[200:203], v228 offset:26624
v_mfma_f32_16x16x32_bf16 v[156:159], a[204:207], a[124:127], v[156:159]
s_waitcnt lgkmcnt(5)
ds_read_b128 a[204:207], v228 offset:27648
v_mfma_f32_16x16x32_bf16 v[160:163], a[208:211], a[96:99], v[160:163]
buffer_load_dwordx4 v228, s[20:23], s54 offen offset:2048 sc1 lds
v_mfma_f32_16x16x32_bf16 v[160:163], a[212:215], a[112:115], v[160:163]
v_mfma_f32_16x16x32_bf16 v[164:167], a[208:211], a[100:103], v[164:167]
v_mfma_f32_16x16x32_bf16 v[164:167], a[212:215], a[116:119], v[164:167]
v_mfma_f32_16x16x32_bf16 v[168:171], a[208:211], a[104:107], v[168:171]
v_mfma_f32_16x16x32_bf16 v[168:171], a[212:215], a[120:123], v[168:171]
v_mfma_f32_16x16x32_bf16 v[172:175], a[208:211], a[108:111], v[172:175]
ds_read_b128 a[208:211], v228 offset:28672
v_mfma_f32_16x16x32_bf16 v[172:175], a[212:215], a[124:127], v[172:175]
s_waitcnt lgkmcnt(5)
ds_read_b128 a[212:215], v228 offset:29696
v_mfma_f32_16x16x32_bf16 v[176:179], a[216:219], a[96:99], v[176:179]
buffer_load_dwordx4 v228, s[20:23], s54 offen offset:3072 sc1 lds
v_mfma_f32_16x16x32_bf16 v[176:179], a[220:223], a[112:115], v[176:179]
s_add_u32 m0, s32, 69632
s_add_u32 s55, s32, 167936
v_mfma_f32_16x16x32_bf16 v[180:183], a[216:219], a[100:103], v[180:183]
v_mfma_f32_16x16x32_bf16 v[180:183], a[220:223], a[116:119], v[180:183]
v_mfma_f32_16x16x32_bf16 v[184:187], a[216:219], a[104:107], v[184:187]
v_mfma_f32_16x16x32_bf16 v[184:187], a[220:223], a[120:123], v[184:187]
v_mfma_f32_16x16x32_bf16 v[188:191], a[216:219], a[108:111], v[188:191]
ds_read_b128 a[216:219], v228 offset:30720
v_mfma_f32_16x16x32_bf16 v[188:191], a[220:223], a[124:127], v[188:191]
s_waitcnt lgkmcnt(5)
ds_read_b128 a[220:223], v228 offset:31744
v_mfma_f32_16x16x32_bf16 v[192:195], a[192:195], a[96:99], v[192:195]
buffer_load_dwordx4 v228, s[20:23], s55 offen offset:0 sc1 lds
v_mfma_f32_16x16x32_bf16 v[192:195], a[196:199], a[112:115], v[192:195]
v_mfma_f32_16x16x32_bf16 v[196:199], a[192:195], a[100:103], v[196:199]
v_mfma_f32_16x16x32_bf16 v[196:199], a[196:199], a[116:119], v[196:199]
v_mfma_f32_16x16x32_bf16 v[200:203], a[192:195], a[104:107], v[200:203]
v_mfma_f32_16x16x32_bf16 v[200:203], a[196:199], a[120:123], v[200:203]
v_mfma_f32_16x16x32_bf16 v[204:207], a[192:195], a[108:111], v[204:207]
v_mfma_f32_16x16x32_bf16 v[204:207], a[196:199], a[124:127], v[204:207]
s_waitcnt lgkmcnt(4)
v_mfma_f32_16x16x32_bf16 v[208:211], a[200:203], a[96:99], v[208:211]
s_waitcnt vmcnt(13) lgkmcnt(0)
s_barrier
buffer_load_dwordx4 v228, s[20:23], s55 offen offset:1024 sc1 lds
v_mfma_f32_16x16x32_bf16 v[208:211], a[204:207], a[112:115], v[208:211]
ds_read_b128 a[192:195], v228 offset:32768
v_mfma_f32_16x16x32_bf16 v[212:215], a[200:203], a[100:103], v[212:215]
ds_read_b128 a[196:199], v228 offset:33792
v_mfma_f32_16x16x32_bf16 v[212:215], a[204:207], a[116:119], v[212:215]
v_mfma_f32_16x16x32_bf16 v[216:219], a[200:203], a[104:107], v[216:219]
v_mfma_f32_16x16x32_bf16 v[216:219], a[204:207], a[120:123], v[216:219]
v_mfma_f32_16x16x32_bf16 v[220:223], a[200:203], a[108:111], v[220:223]
ds_read_b128 a[128:131], v230 offset:0
v_mfma_f32_16x16x32_bf16 v[220:223], a[204:207], a[124:127], v[220:223]
ds_read_b128 a[144:147], v247 offset:0
v_mfma_f32_16x16x32_bf16 a[224:227], a[208:211], a[96:99], a[224:227]
buffer_load_dwordx4 v228, s[20:23], s55 offen offset:2048 sc1 lds
v_mfma_f32_16x16x32_bf16 a[224:227], a[212:215], a[112:115], a[224:227]
ds_read_b128 a[132:135], v230 offset:2048
v_mfma_f32_16x16x32_bf16 a[228:231], a[208:211], a[100:103], a[228:231]
ds_read_b128 a[148:151], v247 offset:2048
v_mfma_f32_16x16x32_bf16 a[228:231], a[212:215], a[116:119], a[228:231]
ds_read_b128 a[136:139], v230 offset:4096
v_mfma_f32_16x16x32_bf16 a[232:235], a[208:211], a[104:107], a[232:235]
ds_read_b128 a[152:155], v247 offset:4096
v_mfma_f32_16x16x32_bf16 a[232:235], a[212:215], a[120:123], a[232:235]
ds_read_b128 a[140:143], v230 offset:6144
v_mfma_f32_16x16x32_bf16 a[236:239], a[208:211], a[108:111], a[236:239]
ds_read_b128 a[156:159], v247 offset:6144
v_mfma_f32_16x16x32_bf16 a[236:239], a[212:215], a[124:127], a[236:239]
ds_read_b128 a[200:203], v228 offset:34816
v_mfma_f32_16x16x32_bf16 a[240:243], a[216:219], a[96:99], a[240:243]
buffer_load_dwordx4 v228, s[20:23], s55 offen offset:3072 sc1 lds
v_mfma_f32_16x16x32_bf16 a[240:243], a[220:223], a[112:115], a[240:243]
s_add_u32 m0, s33, 0
ds_read_b128 a[204:207], v228 offset:35840
v_mfma_f32_16x16x32_bf16 a[244:247], a[216:219], a[100:103], a[244:247]
s_add_u32 s50, s33, 196608
ds_read_b128 a[208:211], v228 offset:36864
v_mfma_f32_16x16x32_bf16 a[244:247], a[220:223], a[116:119], a[244:247]
ds_read_b128 a[212:215], v228 offset:37888
v_mfma_f32_16x16x32_bf16 a[248:251], a[216:219], a[104:107], a[248:251]
v_mfma_f32_16x16x32_bf16 a[248:251], a[220:223], a[120:123], a[248:251]
v_mfma_f32_16x16x32_bf16 a[252:255], a[216:219], a[108:111], a[252:255]
ds_read_b128 a[216:219], v228 offset:38912
v_mfma_f32_16x16x32_bf16 a[252:255], a[220:223], a[124:127], a[252:255]
s_waitcnt lgkmcnt(12)
ds_read_b128 a[220:223], v228 offset:39936
v_mfma_f32_16x16x32_bf16 v[0:3], a[192:195], a[128:131], v[0:3]
s_waitcnt lgkmcnt(12)
buffer_load_dwordx4 v228, s[20:23], s50 offen offset:0 sc1 lds
v_mfma_f32_16x16x32_bf16 v[0:3], a[196:199], a[144:147], v[0:3]
s_waitcnt lgkmcnt(11)
v_mfma_f32_16x16x32_bf16 v[4:7], a[192:195], a[132:135], v[4:7]
s_waitcnt lgkmcnt(10)
v_mfma_f32_16x16x32_bf16 v[4:7], a[196:199], a[148:151], v[4:7]
s_waitcnt lgkmcnt(9)
v_mfma_f32_16x16x32_bf16 v[8:11], a[192:195], a[136:139], v[8:11]
s_waitcnt lgkmcnt(8)
v_mfma_f32_16x16x32_bf16 v[8:11], a[196:199], a[152:155], v[8:11]
s_waitcnt lgkmcnt(7)
v_mfma_f32_16x16x32_bf16 v[12:15], a[192:195], a[140:143], v[12:15]
s_waitcnt lgkmcnt(6)
ds_read_b128 a[192:195], v228 offset:40960
v_mfma_f32_16x16x32_bf16 v[12:15], a[196:199], a[156:159], v[12:15]
s_waitcnt lgkmcnt(5)
ds_read_b128 a[196:199], v228 offset:41984
v_mfma_f32_16x16x32_bf16 v[16:19], a[200:203], a[128:131], v[16:19]
buffer_load_dwordx4 v228, s[20:23], s50 offen offset:1024 sc1 lds
v_mfma_f32_16x16x32_bf16 v[16:19], a[204:207], a[144:147], v[16:19]
v_mfma_f32_16x16x32_bf16 v[20:23], a[200:203], a[132:135], v[20:23]
v_mfma_f32_16x16x32_bf16 v[20:23], a[204:207], a[148:151], v[20:23]
v_mfma_f32_16x16x32_bf16 v[24:27], a[200:203], a[136:139], v[24:27]
v_mfma_f32_16x16x32_bf16 v[24:27], a[204:207], a[152:155], v[24:27]
v_mfma_f32_16x16x32_bf16 v[28:31], a[200:203], a[140:143], v[28:31]
ds_read_b128 a[200:203], v228 offset:43008
v_mfma_f32_16x16x32_bf16 v[28:31], a[204:207], a[156:159], v[28:31]
s_waitcnt lgkmcnt(5)
ds_read_b128 a[204:207], v228 offset:44032
v_mfma_f32_16x16x32_bf16 v[32:35], a[208:211], a[128:131], v[32:35]
buffer_load_dwordx4 v228, s[20:23], s50 offen offset:2048 sc1 lds
v_mfma_f32_16x16x32_bf16 v[32:35], a[212:215], a[144:147], v[32:35]
v_mfma_f32_16x16x32_bf16 v[36:39], a[208:211], a[132:135], v[36:39]
v_mfma_f32_16x16x32_bf16 v[36:39], a[212:215], a[148:151], v[36:39]
v_mfma_f32_16x16x32_bf16 v[40:43], a[208:211], a[136:139], v[40:43]
v_mfma_f32_16x16x32_bf16 v[40:43], a[212:215], a[152:155], v[40:43]
v_mfma_f32_16x16x32_bf16 v[44:47], a[208:211], a[140:143], v[44:47]
ds_read_b128 a[208:211], v228 offset:45056
v_mfma_f32_16x16x32_bf16 v[44:47], a[212:215], a[156:159], v[44:47]
s_waitcnt lgkmcnt(5)
ds_read_b128 a[212:215], v228 offset:46080
v_mfma_f32_16x16x32_bf16 v[48:51], a[216:219], a[128:131], v[48:51]
buffer_load_dwordx4 v228, s[20:23], s50 offen offset:3072 sc1 lds
v_mfma_f32_16x16x32_bf16 v[48:51], a[220:223], a[144:147], v[48:51]
v_mfma_f32_16x16x32_bf16 v[52:55], a[216:219], a[132:135], v[52:55]
v_mfma_f32_16x16x32_bf16 v[52:55], a[220:223], a[148:151], v[52:55]
v_mfma_f32_16x16x32_bf16 v[56:59], a[216:219], a[136:139], v[56:59]
v_mfma_f32_16x16x32_bf16 v[56:59], a[220:223], a[152:155], v[56:59]
v_mfma_f32_16x16x32_bf16 v[60:63], a[216:219], a[140:143], v[60:63]
ds_read_b128 a[216:219], v228 offset:47104
v_mfma_f32_16x16x32_bf16 v[60:63], a[220:223], a[156:159], v[60:63]
s_waitcnt lgkmcnt(5)
ds_read_b128 a[220:223], v228 offset:48128
v_mfma_f32_16x16x32_bf16 v[64:67], a[192:195], a[128:131], v[64:67]
v_mfma_f32_16x16x32_bf16 v[64:67], a[196:199], a[144:147], v[64:67]
v_mfma_f32_16x16x32_bf16 v[68:71], a[192:195], a[132:135], v[68:71]
v_mfma_f32_16x16x32_bf16 v[68:71], a[196:199], a[148:151], v[68:71]
v_mfma_f32_16x16x32_bf16 v[72:75], a[192:195], a[136:139], v[72:75]
v_mfma_f32_16x16x32_bf16 v[72:75], a[196:199], a[152:155], v[72:75]
v_mfma_f32_16x16x32_bf16 v[76:79], a[192:195], a[140:143], v[76:79]
ds_read_b128 a[192:195], v228 offset:49152
v_mfma_f32_16x16x32_bf16 v[76:79], a[196:199], a[156:159], v[76:79]
s_waitcnt lgkmcnt(5)
ds_read_b128 a[196:199], v228 offset:50176
v_mfma_f32_16x16x32_bf16 v[80:83], a[200:203], a[128:131], v[80:83]
v_mfma_f32_16x16x32_bf16 v[80:83], a[204:207], a[144:147], v[80:83]
v_mfma_f32_16x16x32_bf16 v[84:87], a[200:203], a[132:135], v[84:87]
v_mfma_f32_16x16x32_bf16 v[84:87], a[204:207], a[148:151], v[84:87]
v_mfma_f32_16x16x32_bf16 v[88:91], a[200:203], a[136:139], v[88:91]
v_mfma_f32_16x16x32_bf16 v[88:91], a[204:207], a[152:155], v[88:91]
v_mfma_f32_16x16x32_bf16 v[92:95], a[200:203], a[140:143], v[92:95]
ds_read_b128 a[200:203], v228 offset:51200
v_mfma_f32_16x16x32_bf16 v[92:95], a[204:207], a[156:159], v[92:95]
s_waitcnt lgkmcnt(5)
ds_read_b128 a[204:207], v228 offset:52224
v_mfma_f32_16x16x32_bf16 v[96:99], a[208:211], a[128:131], v[96:99]
v_mfma_f32_16x16x32_bf16 v[96:99], a[212:215], a[144:147], v[96:99]
v_mfma_f32_16x16x32_bf16 v[100:103], a[208:211], a[132:135], v[100:103]
v_mfma_f32_16x16x32_bf16 v[100:103], a[212:215], a[148:151], v[100:103]
v_mfma_f32_16x16x32_bf16 v[104:107], a[208:211], a[136:139], v[104:107]
v_mfma_f32_16x16x32_bf16 v[104:107], a[212:215], a[152:155], v[104:107]
v_mfma_f32_16x16x32_bf16 v[108:111], a[208:211], a[140:143], v[108:111]
ds_read_b128 a[208:211], v228 offset:53248
v_mfma_f32_16x16x32_bf16 v[108:111], a[212:215], a[156:159], v[108:111]
s_waitcnt lgkmcnt(5)
ds_read_b128 a[212:215], v228 offset:54272
v_mfma_f32_16x16x32_bf16 v[112:115], a[216:219], a[128:131], v[112:115]
v_mfma_f32_16x16x32_bf16 v[112:115], a[220:223], a[144:147], v[112:115]
v_mfma_f32_16x16x32_bf16 v[116:119], a[216:219], a[132:135], v[116:119]
v_mfma_f32_16x16x32_bf16 v[116:119], a[220:223], a[148:151], v[116:119]
v_mfma_f32_16x16x32_bf16 v[120:123], a[216:219], a[136:139], v[120:123]
v_mfma_f32_16x16x32_bf16 v[120:123], a[220:223], a[152:155], v[120:123]
v_mfma_f32_16x16x32_bf16 v[124:127], a[216:219], a[140:143], v[124:127]
ds_read_b128 a[216:219], v228 offset:55296
v_mfma_f32_16x16x32_bf16 v[124:127], a[220:223], a[156:159], v[124:127]
s_waitcnt lgkmcnt(5)
ds_read_b128 a[220:223], v228 offset:56320
v_mfma_f32_16x16x32_bf16 v[128:131], a[192:195], a[128:131], v[128:131]
v_mfma_f32_16x16x32_bf16 v[128:131], a[196:199], a[144:147], v[128:131]
v_mfma_f32_16x16x32_bf16 v[132:135], a[192:195], a[132:135], v[132:135]
v_mfma_f32_16x16x32_bf16 v[132:135], a[196:199], a[148:151], v[132:135]
v_mfma_f32_16x16x32_bf16 v[136:139], a[192:195], a[136:139], v[136:139]
v_mfma_f32_16x16x32_bf16 v[136:139], a[196:199], a[152:155], v[136:139]
v_mfma_f32_16x16x32_bf16 v[140:143], a[192:195], a[140:143], v[140:143]
ds_read_b128 a[192:195], v228 offset:57344
v_mfma_f32_16x16x32_bf16 v[140:143], a[196:199], a[156:159], v[140:143]
s_waitcnt lgkmcnt(5)
ds_read_b128 a[196:199], v228 offset:58368
v_mfma_f32_16x16x32_bf16 v[144:147], a[200:203], a[128:131], v[144:147]
v_mfma_f32_16x16x32_bf16 v[144:147], a[204:207], a[144:147], v[144:147]
v_mfma_f32_16x16x32_bf16 v[148:151], a[200:203], a[132:135], v[148:151]
v_mfma_f32_16x16x32_bf16 v[148:151], a[204:207], a[148:151], v[148:151]
v_mfma_f32_16x16x32_bf16 v[152:155], a[200:203], a[136:139], v[152:155]
v_mfma_f32_16x16x32_bf16 v[152:155], a[204:207], a[152:155], v[152:155]
v_mfma_f32_16x16x32_bf16 v[156:159], a[200:203], a[140:143], v[156:159]
ds_read_b128 a[200:203], v228 offset:59392
v_mfma_f32_16x16x32_bf16 v[156:159], a[204:207], a[156:159], v[156:159]
s_waitcnt lgkmcnt(5)
ds_read_b128 a[204:207], v228 offset:60416
v_mfma_f32_16x16x32_bf16 v[160:163], a[208:211], a[128:131], v[160:163]
v_mfma_f32_16x16x32_bf16 v[160:163], a[212:215], a[144:147], v[160:163]
v_mfma_f32_16x16x32_bf16 v[164:167], a[208:211], a[132:135], v[164:167]
v_mfma_f32_16x16x32_bf16 v[164:167], a[212:215], a[148:151], v[164:167]
v_mfma_f32_16x16x32_bf16 v[168:171], a[208:211], a[136:139], v[168:171]
v_mfma_f32_16x16x32_bf16 v[168:171], a[212:215], a[152:155], v[168:171]
v_mfma_f32_16x16x32_bf16 v[172:175], a[208:211], a[140:143], v[172:175]
ds_read_b128 a[208:211], v228 offset:61440
v_mfma_f32_16x16x32_bf16 v[172:175], a[212:215], a[156:159], v[172:175]
s_waitcnt lgkmcnt(5)
ds_read_b128 a[212:215], v228 offset:62464
v_mfma_f32_16x16x32_bf16 v[176:179], a[216:219], a[128:131], v[176:179]
v_mfma_f32_16x16x32_bf16 v[176:179], a[220:223], a[144:147], v[176:179]
v_mfma_f32_16x16x32_bf16 v[180:183], a[216:219], a[132:135], v[180:183]
v_mfma_f32_16x16x32_bf16 v[180:183], a[220:223], a[148:151], v[180:183]
v_mfma_f32_16x16x32_bf16 v[184:187], a[216:219], a[136:139], v[184:187]
v_mfma_f32_16x16x32_bf16 v[184:187], a[220:223], a[152:155], v[184:187]
v_mfma_f32_16x16x32_bf16 v[188:191], a[216:219], a[140:143], v[188:191]
ds_read_b128 a[216:219], v228 offset:63488
v_mfma_f32_16x16x32_bf16 v[188:191], a[220:223], a[156:159], v[188:191]
s_waitcnt lgkmcnt(5)
ds_read_b128 a[220:223], v228 offset:64512
v_mfma_f32_16x16x32_bf16 v[192:195], a[192:195], a[128:131], v[192:195]
v_mfma_f32_16x16x32_bf16 v[192:195], a[196:199], a[144:147], v[192:195]
v_mfma_f32_16x16x32_bf16 v[196:199], a[192:195], a[132:135], v[196:199]
v_mfma_f32_16x16x32_bf16 v[196:199], a[196:199], a[148:151], v[196:199]
v_mfma_f32_16x16x32_bf16 v[200:203], a[192:195], a[136:139], v[200:203]
v_mfma_f32_16x16x32_bf16 v[200:203], a[196:199], a[152:155], v[200:203]
v_mfma_f32_16x16x32_bf16 v[204:207], a[192:195], a[140:143], v[204:207]
v_mfma_f32_16x16x32_bf16 v[204:207], a[196:199], a[156:159], v[204:207]
s_waitcnt lgkmcnt(4)
v_mfma_f32_16x16x32_bf16 v[208:211], a[200:203], a[128:131], v[208:211]
s_waitcnt vmcnt(4) lgkmcnt(0)
s_barrier
ds_read_b128 a[192:195], v229 offset:45056
v_mfma_f32_16x16x32_bf16 v[208:211], a[204:207], a[144:147], v[208:211]
s_add_u32 m0, s33, 16384
ds_read_b128 a[196:199], v229 offset:46080
v_mfma_f32_16x16x32_bf16 v[212:215], a[200:203], a[132:135], v[212:215]
s_add_u32 s51, s33, 212992
buffer_load_dwordx4 v228, s[20:23], s51 offen offset:0 sc1 lds
v_mfma_f32_16x16x32_bf16 v[212:215], a[204:207], a[148:151], v[212:215]
v_mfma_f32_16x16x32_bf16 v[216:219], a[200:203], a[136:139], v[216:219]
v_mfma_f32_16x16x32_bf16 v[216:219], a[204:207], a[152:155], v[216:219]
v_mfma_f32_16x16x32_bf16 v[220:223], a[200:203], a[140:143], v[220:223]
ds_read_b128 a[160:163], v230 offset:32768
v_mfma_f32_16x16x32_bf16 v[220:223], a[204:207], a[156:159], v[220:223]
ds_read_b128 a[176:179], v247 offset:32768
v_mfma_f32_16x16x32_bf16 a[224:227], a[208:211], a[128:131], a[224:227]
ds_read_b128 a[164:167], v230 offset:34816
v_mfma_f32_16x16x32_bf16 a[224:227], a[212:215], a[144:147], a[224:227]
ds_read_b128 a[180:183], v247 offset:34816
v_mfma_f32_16x16x32_bf16 a[228:231], a[208:211], a[132:135], a[228:231]
ds_read_b128 a[168:171], v230 offset:36864
v_mfma_f32_16x16x32_bf16 a[228:231], a[212:215], a[148:151], a[228:231]
ds_read_b128 a[184:187], v247 offset:36864
v_mfma_f32_16x16x32_bf16 a[232:235], a[208:211], a[136:139], a[232:235]
ds_read_b128 a[172:175], v230 offset:38912
v_add_u32 v230, 24576, v228
v_mfma_f32_16x16x32_bf16 a[232:235], a[212:215], a[152:155], a[232:235]
ds_read_b128 a[188:191], v247 offset:38912
v_bfe_u32 v247, v228, 4, 4
v_mfma_f32_16x16x32_bf16 a[236:239], a[208:211], a[140:143], a[236:239]
ds_read_b128 a[200:203], v229 offset:47104
v_lshlrev_b32 v247, 3, v247
v_mfma_f32_16x16x32_bf16 a[236:239], a[212:215], a[156:159], a[236:239]
ds_read_b128 a[204:207], v229 offset:48128
v_mfma_f32_16x16x32_bf16 a[240:243], a[216:219], a[128:131], a[240:243]
ds_read_b128 a[208:211], v229 offset:16384
v_mfma_f32_16x16x32_bf16 a[240:243], a[220:223], a[144:147], a[240:243]
ds_read_b128 a[212:215], v229 offset:17408
v_mfma_f32_16x16x32_bf16 a[244:247], a[216:219], a[132:135], a[244:247]
buffer_load_dwordx4 v228, s[20:23], s51 offen offset:1024 sc1 lds
v_mfma_f32_16x16x32_bf16 a[244:247], a[220:223], a[148:151], a[244:247]
v_mfma_f32_16x16x32_bf16 a[248:251], a[216:219], a[136:139], a[248:251]
v_mfma_f32_16x16x32_bf16 a[248:251], a[220:223], a[152:155], a[248:251]
v_mfma_f32_16x16x32_bf16 a[252:255], a[216:219], a[140:143], a[252:255]
ds_read_b128 a[216:219], v229 offset:18432
v_mfma_f32_16x16x32_bf16 a[252:255], a[220:223], a[156:159], a[252:255]
s_waitcnt lgkmcnt(12)
ds_read_b128 a[220:223], v229 offset:19456
v_mfma_f32_16x16x32_bf16 a[224:227], a[192:195], a[160:163], a[224:227]
s_waitcnt lgkmcnt(12)
v_mfma_f32_16x16x32_bf16 a[224:227], a[196:199], a[176:179], a[224:227]
s_waitcnt lgkmcnt(11)
v_mfma_f32_16x16x32_bf16 a[228:231], a[192:195], a[164:167], a[228:231]
s_waitcnt lgkmcnt(10)
buffer_load_dwordx4 v228, s[20:23], s51 offen offset:2048 sc1 lds
v_mfma_f32_16x16x32_bf16 a[228:231], a[196:199], a[180:183], a[228:231]
s_waitcnt lgkmcnt(9)
v_mfma_f32_16x16x32_bf16 a[232:235], a[192:195], a[168:171], a[232:235]
s_waitcnt lgkmcnt(8)
v_mfma_f32_16x16x32_bf16 a[232:235], a[196:199], a[184:187], a[232:235]
s_waitcnt lgkmcnt(7)
v_mfma_f32_16x16x32_bf16 a[236:239], a[192:195], a[172:175], a[236:239]
s_waitcnt lgkmcnt(6)
ds_read_b128 a[192:195], v229 offset:20480
v_mfma_f32_16x16x32_bf16 a[236:239], a[196:199], a[188:191], a[236:239]
s_waitcnt lgkmcnt(5)
ds_read_b128 a[196:199], v229 offset:21504
v_mfma_f32_16x16x32_bf16 a[240:243], a[200:203], a[160:163], a[240:243]
buffer_load_dwordx4 v228, s[20:23], s51 offen offset:3072 sc1 lds
v_mfma_f32_16x16x32_bf16 a[240:243], a[204:207], a[176:179], a[240:243]
v_mfma_f32_16x16x32_bf16 a[244:247], a[200:203], a[164:167], a[244:247]
v_mfma_f32_16x16x32_bf16 a[244:247], a[204:207], a[180:183], a[244:247]
v_mfma_f32_16x16x32_bf16 a[248:251], a[200:203], a[168:171], a[248:251]
v_mfma_f32_16x16x32_bf16 a[248:251], a[204:207], a[184:187], a[248:251]
v_mfma_f32_16x16x32_bf16 a[252:255], a[200:203], a[172:175], a[252:255]
ds_read_b128 a[200:203], v229 offset:22528
v_mfma_f32_16x16x32_bf16 a[252:255], a[204:207], a[188:191], a[252:255]
s_waitcnt lgkmcnt(5)
ds_read_b128 a[204:207], v229 offset:23552
v_mfma_f32_16x16x32_bf16 v[0:3], a[208:211], a[160:163], v[0:3]
v_mfma_f32_16x16x32_bf16 v[0:3], a[212:215], a[176:179], v[0:3]
v_mfma_f32_16x16x32_bf16 v[4:7], a[208:211], a[164:167], v[4:7]
v_mfma_f32_16x16x32_bf16 v[4:7], a[212:215], a[180:183], v[4:7]
v_mfma_f32_16x16x32_bf16 v[8:11], a[208:211], a[168:171], v[8:11]
v_mfma_f32_16x16x32_bf16 v[8:11], a[212:215], a[184:187], v[8:11]
v_mfma_f32_16x16x32_bf16 v[12:15], a[208:211], a[172:175], v[12:15]
ds_read_b128 a[208:211], v229 offset:24576
v_mfma_f32_16x16x32_bf16 v[12:15], a[212:215], a[188:191], v[12:15]
s_waitcnt lgkmcnt(5)
ds_read_b128 a[212:215], v229 offset:25600
v_cvt_pk_bf16_f32 v0, v0, v1
v_mfma_f32_16x16x32_bf16 v[16:19], a[216:219], a[160:163], v[16:19]
v_cvt_pk_bf16_f32 v1, v2, v3
v_cvt_pk_bf16_f32 v4, v4, v5
v_mfma_f32_16x16x32_bf16 v[16:19], a[220:223], a[176:179], v[16:19]
v_cvt_pk_bf16_f32 v8, v8, v9
v_cvt_pk_bf16_f32 v5, v6, v7
v_mfma_f32_16x16x32_bf16 v[20:23], a[216:219], a[164:167], v[20:23]
v_cvt_pk_bf16_f32 v12, v12, v13
v_cvt_pk_bf16_f32 v9, v10, v11
v_mfma_f32_16x16x32_bf16 v[20:23], a[220:223], a[180:183], v[20:23]
v_cvt_pk_bf16_f32 v13, v14, v15
v_mfma_f32_16x16x32_bf16 v[24:27], a[216:219], a[168:171], v[24:27]
v_cvt_pk_bf16_f32 v2, v16, v17
v_cvt_pk_bf16_f32 v3, v18, v19
v_mfma_f32_16x16x32_bf16 v[24:27], a[220:223], a[184:187], v[24:27]
v_mfma_f32_16x16x32_bf16 v[28:31], a[216:219], a[172:175], v[28:31]
ds_read_b128 a[216:219], v229 offset:26624
v_mfma_f32_16x16x32_bf16 v[28:31], a[220:223], a[188:191], v[28:31]
s_waitcnt lgkmcnt(5)
ds_read_b128 a[220:223], v229 offset:27648
v_cvt_pk_bf16_f32 v6, v20, v21
v_mfma_f32_16x16x32_bf16 v[32:35], a[192:195], a[160:163], v[32:35]
v_cvt_pk_bf16_f32 v7, v22, v23
v_mfma_f32_16x16x32_bf16 v[32:35], a[196:199], a[176:179], v[32:35]
v_cvt_pk_bf16_f32 v10, v24, v25
v_cvt_pk_bf16_f32 v11, v26, v27
v_mfma_f32_16x16x32_bf16 v[36:39], a[192:195], a[164:167], v[36:39]
v_cvt_pk_bf16_f32 v14, v28, v29
v_cvt_pk_bf16_f32 v15, v30, v31
v_mfma_f32_16x16x32_bf16 v[36:39], a[196:199], a[180:183], v[36:39]
v_mfma_f32_16x16x32_bf16 v[40:43], a[192:195], a[168:171], v[40:43]
v_mfma_f32_16x16x32_bf16 v[40:43], a[196:199], a[184:187], v[40:43]
v_cvt_pk_bf16_f32 v32, v32, v33
v_cvt_pk_bf16_f32 v33, v34, v35
v_mfma_f32_16x16x32_bf16 v[44:47], a[192:195], a[172:175], v[44:47]
ds_read_b128 a[192:195], v229 offset:28672
v_mfma_f32_16x16x32_bf16 v[44:47], a[196:199], a[188:191], v[44:47]
s_waitcnt lgkmcnt(5)
ds_read_b128 a[196:199], v229 offset:29696
v_cvt_pk_bf16_f32 v36, v36, v37
v_mfma_f32_16x16x32_bf16 v[48:51], a[200:203], a[160:163], v[48:51]
v_cvt_pk_bf16_f32 v40, v40, v41
v_cvt_pk_bf16_f32 v37, v38, v39
v_mfma_f32_16x16x32_bf16 v[48:51], a[204:207], a[176:179], v[48:51]
v_cvt_pk_bf16_f32 v41, v42, v43
v_mfma_f32_16x16x32_bf16 v[52:55], a[200:203], a[164:167], v[52:55]
v_cvt_pk_bf16_f32 v44, v44, v45
v_cvt_pk_bf16_f32 v45, v46, v47
v_mfma_f32_16x16x32_bf16 v[52:55], a[204:207], a[180:183], v[52:55]
v_mfma_f32_16x16x32_bf16 v[56:59], a[200:203], a[168:171], v[56:59]
v_mfma_f32_16x16x32_bf16 v[56:59], a[204:207], a[184:187], v[56:59]
v_mfma_f32_16x16x32_bf16 v[60:63], a[200:203], a[172:175], v[60:63]
ds_read_b128 a[200:203], v229 offset:30720
v_cvt_pk_bf16_f32 v34, v48, v49
v_mfma_f32_16x16x32_bf16 v[60:63], a[204:207], a[188:191], v[60:63]
s_waitcnt lgkmcnt(5)
ds_read_b128 a[204:207], v229 offset:31744
v_cvt_pk_bf16_f32 v35, v50, v51
v_mfma_f32_16x16x32_bf16 v[64:67], a[208:211], a[160:163], v[64:67]
v_cvt_pk_bf16_f32 v38, v52, v53
v_cvt_pk_bf16_f32 v39, v54, v55
v_mfma_f32_16x16x32_bf16 v[64:67], a[212:215], a[176:179], v[64:67]
v_accvgpr_read_b32 v48, a224
v_accvgpr_read_b32 v49, a225
v_mfma_f32_16x16x32_bf16 v[68:71], a[208:211], a[164:167], v[68:71]
v_accvgpr_read_b32 v50, a226
v_accvgpr_read_b32 v51, a227
v_mfma_f32_16x16x32_bf16 v[68:71], a[212:215], a[180:183], v[68:71]
v_cvt_pk_bf16_f32 v42, v56, v57
v_accvgpr_read_b32 v52, a240
v_mfma_f32_16x16x32_bf16 v[72:75], a[208:211], a[168:171], v[72:75]
v_accvgpr_read_b32 v53, a241
v_accvgpr_read_b32 v54, a242
v_mfma_f32_16x16x32_bf16 v[72:75], a[212:215], a[184:187], v[72:75]
v_accvgpr_read_b32 v55, a243
v_cvt_pk_bf16_f32 v43, v58, v59
v_mfma_f32_16x16x32_bf16 v[76:79], a[208:211], a[172:175], v[76:79]
ds_read_b128 a[208:211], v229 offset:32768
v_cvt_pk_bf16_f32 v16, v48, v49
v_mfma_f32_16x16x32_bf16 v[76:79], a[212:215], a[188:191], v[76:79]
s_waitcnt lgkmcnt(5)
ds_read_b128 a[212:215], v229 offset:33792
v_cvt_pk_bf16_f32 v17, v50, v51
v_mfma_f32_16x16x32_bf16 v[80:83], a[216:219], a[160:163], v[80:83]
v_accvgpr_read_b32 v56, a228
v_accvgpr_read_b32 v57, a229
v_mfma_f32_16x16x32_bf16 v[80:83], a[220:223], a[176:179], v[80:83]
v_cvt_pk_bf16_f32 v18, v52, v53
v_cvt_pk_bf16_f32 v19, v54, v55
v_mfma_f32_16x16x32_bf16 v[84:87], a[216:219], a[164:167], v[84:87]
v_accvgpr_read_b32 v48, a232
v_accvgpr_read_b32 v49, a233
v_mfma_f32_16x16x32_bf16 v[84:87], a[220:223], a[180:183], v[84:87]
v_accvgpr_read_b32 v58, a230
v_accvgpr_read_b32 v59, a231
v_mfma_f32_16x16x32_bf16 v[88:91], a[216:219], a[168:171], v[88:91]
v_accvgpr_read_b32 v50, a234
v_accvgpr_read_b32 v51, a235
v_mfma_f32_16x16x32_bf16 v[88:91], a[220:223], a[184:187], v[88:91]
v_cvt_pk_bf16_f32 v46, v60, v61
v_cvt_pk_bf16_f32 v20, v56, v57
v_mfma_f32_16x16x32_bf16 v[92:95], a[216:219], a[172:175], v[92:95]
ds_read_b128 a[216:219], v229 offset:34816
v_cvt_pk_bf16_f32 v47, v62, v63
v_mfma_f32_16x16x32_bf16 v[92:95], a[220:223], a[188:191], v[92:95]
s_waitcnt lgkmcnt(5)
ds_read_b128 a[220:223], v229 offset:35840
v_accvgpr_read_b32 v52, a248
v_mfma_f32_16x16x32_bf16 v[96:99], a[192:195], a[160:163], v[96:99]
v_accvgpr_read_b32 v53, a249
v_accvgpr_read_b32 v54, a250
v_mfma_f32_16x16x32_bf16 v[96:99], a[196:199], a[176:179], v[96:99]
v_accvgpr_read_b32 v55, a251
v_cvt_pk_bf16_f32 v24, v48, v49
v_mfma_f32_16x16x32_bf16 v[100:103], a[192:195], a[164:167], v[100:103]
v_cvt_pk_bf16_f32 v21, v58, v59
v_cvt_pk_bf16_f32 v25, v50, v51
v_mfma_f32_16x16x32_bf16 v[100:103], a[196:199], a[180:183], v[100:103]
v_accvgpr_read_b32 v60, a244
v_accvgpr_read_b32 v61, a245
v_mfma_f32_16x16x32_bf16 v[104:107], a[192:195], a[168:171], v[104:107]
v_accvgpr_read_b32 v56, a236
v_accvgpr_read_b32 v57, a237
v_mfma_f32_16x16x32_bf16 v[104:107], a[196:199], a[184:187], v[104:107]
v_cvt_pk_bf16_f32 v26, v52, v53
v_cvt_pk_bf16_f32 v27, v54, v55
v_mfma_f32_16x16x32_bf16 v[108:111], a[192:195], a[172:175], v[108:111]
ds_read_b128 a[192:195], v229 offset:36864
v_accvgpr_read_b32 v62, a246
v_mfma_f32_16x16x32_bf16 v[108:111], a[196:199], a[188:191], v[108:111]
s_waitcnt lgkmcnt(5)
ds_read_b128 a[196:199], v229 offset:37888
v_accvgpr_read_b32 v63, a247
v_mfma_f32_16x16x32_bf16 v[112:115], a[200:203], a[160:163], v[112:115]
v_accvgpr_read_b32 v58, a238
v_accvgpr_read_b32 v59, a239
v_mfma_f32_16x16x32_bf16 v[112:115], a[204:207], a[176:179], v[112:115]
v_cvt_pk_bf16_f32 v22, v60, v61
v_cvt_pk_bf16_f32 v28, v56, v57
v_mfma_f32_16x16x32_bf16 v[116:119], a[200:203], a[164:167], v[116:119]
v_cvt_pk_bf16_f32 v23, v62, v63
v_cvt_pk_bf16_f32 v29, v58, v59
v_mfma_f32_16x16x32_bf16 v[116:119], a[204:207], a[180:183], v[116:119]
v_accvgpr_read_b32 v60, a252
v_accvgpr_read_b32 v61, a253
v_mfma_f32_16x16x32_bf16 v[120:123], a[200:203], a[168:171], v[120:123]
v_accvgpr_read_b32 v62, a254
v_accvgpr_read_b32 v63, a255
v_mfma_f32_16x16x32_bf16 v[120:123], a[204:207], a[184:187], v[120:123]
v_cvt_pk_bf16_f32 v30, v60, v61
v_cvt_pk_bf16_f32 v31, v62, v63
v_mfma_f32_16x16x32_bf16 v[124:127], a[200:203], a[172:175], v[124:127]
ds_read_b128 a[200:203], v229 offset:38912
v_cvt_pk_bf16_f32 v64, v64, v65
v_mfma_f32_16x16x32_bf16 v[124:127], a[204:207], a[188:191], v[124:127]
s_waitcnt lgkmcnt(5)
ds_read_b128 a[204:207], v229 offset:39936
v_cvt_pk_bf16_f32 v65, v66, v67
v_mfma_f32_16x16x32_bf16 v[128:131], a[208:211], a[160:163], v[128:131]
v_cvt_pk_bf16_f32 v66, v80, v81
v_cvt_pk_bf16_f32 v67, v82, v83
v_mfma_f32_16x16x32_bf16 v[128:131], a[212:215], a[176:179], v[128:131]
v_cvt_pk_bf16_f32 v68, v68, v69
v_cvt_pk_bf16_f32 v69, v70, v71
v_mfma_f32_16x16x32_bf16 v[132:135], a[208:211], a[164:167], v[132:135]
v_cvt_pk_bf16_f32 v70, v84, v85
v_cvt_pk_bf16_f32 v71, v86, v87
v_mfma_f32_16x16x32_bf16 v[132:135], a[212:215], a[180:183], v[132:135]
v_cvt_pk_bf16_f32 v72, v72, v73
v_cvt_pk_bf16_f32 v73, v74, v75
v_mfma_f32_16x16x32_bf16 v[136:139], a[208:211], a[168:171], v[136:139]
v_cvt_pk_bf16_f32 v128, v128, v129
v_cvt_pk_bf16_f32 v129, v130, v131
v_mfma_f32_16x16x32_bf16 v[136:139], a[212:215], a[184:187], v[136:139]
v_cvt_pk_bf16_f32 v74, v88, v89
v_cvt_pk_bf16_f32 v75, v90, v91
v_mfma_f32_16x16x32_bf16 v[140:143], a[208:211], a[172:175], v[140:143]
ds_read_b128 a[208:211], v229 offset:40960
v_cvt_pk_bf16_f32 v132, v132, v133
v_mfma_f32_16x16x32_bf16 v[140:143], a[212:215], a[188:191], v[140:143]
s_waitcnt lgkmcnt(5)
ds_read_b128 a[212:215], v229 offset:41984
v_cvt_pk_bf16_f32 v133, v134, v135
v_mfma_f32_16x16x32_bf16 v[144:147], a[216:219], a[160:163], v[144:147]
v_cvt_pk_bf16_f32 v136, v136, v137
v_cvt_pk_bf16_f32 v137, v138, v139
v_mfma_f32_16x16x32_bf16 v[144:147], a[220:223], a[176:179], v[144:147]
v_cvt_pk_bf16_f32 v76, v76, v77
v_cvt_pk_bf16_f32 v77, v78, v79
v_mfma_f32_16x16x32_bf16 v[148:151], a[216:219], a[164:167], v[148:151]
v_cvt_pk_bf16_f32 v140, v140, v141
v_cvt_pk_bf16_f32 v141, v142, v143
v_mfma_f32_16x16x32_bf16 v[148:151], a[220:223], a[180:183], v[148:151]
v_cvt_pk_bf16_f32 v78, v92, v93
v_cvt_pk_bf16_f32 v79, v94, v95
v_mfma_f32_16x16x32_bf16 v[152:155], a[216:219], a[168:171], v[152:155]
v_cvt_pk_bf16_f32 v130, v144, v145
v_cvt_pk_bf16_f32 v131, v146, v147
v_mfma_f32_16x16x32_bf16 v[152:155], a[220:223], a[184:187], v[152:155]
v_cvt_pk_bf16_f32 v96, v96, v97
v_cvt_pk_bf16_f32 v97, v98, v99
v_mfma_f32_16x16x32_bf16 v[156:159], a[216:219], a[172:175], v[156:159]
ds_read_b128 a[216:219], v229 offset:43008
v_cvt_pk_bf16_f32 v134, v148, v149
v_mfma_f32_16x16x32_bf16 v[156:159], a[220:223], a[188:191], v[156:159]
s_waitcnt lgkmcnt(5)
ds_read_b128 a[220:223], v229 offset:44032
v_cvt_pk_bf16_f32 v135, v150, v151
v_mfma_f32_16x16x32_bf16 v[160:163], a[192:195], a[160:163], v[160:163]
v_cvt_pk_bf16_f32 v138, v152, v153
v_cvt_pk_bf16_f32 v139, v154, v155
v_mfma_f32_16x16x32_bf16 v[160:163], a[196:199], a[176:179], v[160:163]
v_cvt_pk_bf16_f32 v98, v112, v113
v_cvt_pk_bf16_f32 v99, v114, v115
v_mfma_f32_16x16x32_bf16 v[164:167], a[192:195], a[164:167], v[164:167]
v_cvt_pk_bf16_f32 v142, v156, v157
v_cvt_pk_bf16_f32 v143, v158, v159
v_mfma_f32_16x16x32_bf16 v[164:167], a[196:199], a[180:183], v[164:167]
v_cvt_pk_bf16_f32 v100, v100, v101
v_cvt_pk_bf16_f32 v101, v102, v103
v_mfma_f32_16x16x32_bf16 v[168:171], a[192:195], a[168:171], v[168:171]
v_cvt_pk_bf16_f32 v102, v116, v117
v_cvt_pk_bf16_f32 v103, v118, v119
v_mfma_f32_16x16x32_bf16 v[168:171], a[196:199], a[184:187], v[168:171]
v_cvt_pk_bf16_f32 v104, v104, v105
v_cvt_pk_bf16_f32 v105, v106, v107
v_mfma_f32_16x16x32_bf16 v[172:175], a[192:195], a[172:175], v[172:175]
v_cvt_pk_bf16_f32 v106, v120, v121
v_cvt_pk_bf16_f32 v107, v122, v123
v_mfma_f32_16x16x32_bf16 v[172:175], a[196:199], a[188:191], v[172:175]
s_waitcnt lgkmcnt(4)
v_cvt_pk_bf16_f32 v108, v108, v109
v_cvt_pk_bf16_f32 v109, v110, v111
v_mfma_f32_16x16x32_bf16 v[176:179], a[200:203], a[160:163], v[176:179]
s_waitcnt vmcnt(4) lgkmcnt(0)
s_barrier
v_cvt_pk_bf16_f32 v110, v124, v125
v_mfma_f32_16x16x32_bf16 v[176:179], a[204:207], a[176:179], v[176:179]
s_add_u32 m0, s33, 32768
v_cvt_pk_bf16_f32 v111, v126, v127
v_cvt_pk_bf16_f32 v160, v160, v161
v_mfma_f32_16x16x32_bf16 v[180:183], a[200:203], a[164:167], v[180:183]
s_add_u32 s52, s33, 229376
v_cvt_pk_bf16_f32 v161, v162, v163
v_cvt_pk_bf16_f32 v164, v164, v165
v_mfma_f32_16x16x32_bf16 v[180:183], a[204:207], a[180:183], v[180:183]
v_cvt_pk_bf16_f32 v165, v166, v167
v_cvt_pk_bf16_f32 v168, v168, v169
v_mfma_f32_16x16x32_bf16 v[184:187], a[200:203], a[168:171], v[184:187]
v_cvt_pk_bf16_f32 v162, v176, v177
v_cvt_pk_bf16_f32 v163, v178, v179
v_mfma_f32_16x16x32_bf16 v[184:187], a[204:207], a[184:187], v[184:187]
v_cvt_pk_bf16_f32 v169, v170, v171
v_cvt_pk_bf16_f32 v172, v172, v173
v_mfma_f32_16x16x32_bf16 v[188:191], a[200:203], a[172:175], v[188:191]
v_cvt_pk_bf16_f32 v166, v180, v181
v_cvt_pk_bf16_f32 v167, v182, v183
v_mfma_f32_16x16x32_bf16 v[188:191], a[204:207], a[188:191], v[188:191]
v_cvt_pk_bf16_f32 v173, v174, v175
ds_read_b128 a[192:195], v228 offset:0
v_mfma_f32_16x16x32_bf16 v[192:195], a[208:211], a[160:163], v[192:195]
v_cvt_pk_bf16_f32 v170, v184, v185
v_cvt_pk_bf16_f32 v171, v186, v187
v_mfma_f32_16x16x32_bf16 v[192:195], a[212:215], a[176:179], v[192:195]
buffer_load_dwordx4 v228, s[20:23], s52 offen offset:0 sc1 lds
v_mfma_f32_16x16x32_bf16 v[196:199], a[208:211], a[164:167], v[196:199]
v_cvt_pk_bf16_f32 v174, v188, v189
v_cvt_pk_bf16_f32 v175, v190, v191
v_mfma_f32_16x16x32_bf16 v[196:199], a[212:215], a[180:183], v[196:199]
ds_read_b128 a[196:199], v228 offset:1024
v_accvgpr_write_b32 a252, v28
v_mfma_f32_16x16x32_bf16 v[200:203], a[208:211], a[168:171], v[200:203]
v_cvt_pk_bf16_f32 v192, v192, v193
v_cvt_pk_bf16_f32 v193, v194, v195
v_mfma_f32_16x16x32_bf16 v[200:203], a[212:215], a[184:187], v[200:203]
buffer_load_dwordx4 v228, s[20:23], s52 offen offset:1024 sc1 lds
v_mfma_f32_16x16x32_bf16 v[204:207], a[208:211], a[172:175], v[204:207]
v_cvt_pk_bf16_f32 v196, v196, v197
v_cvt_pk_bf16_f32 v197, v198, v199
v_mfma_f32_16x16x32_bf16 v[204:207], a[212:215], a[188:191], v[204:207]
ds_read_b128 a[200:203], v228 offset:2048
v_accvgpr_write_b32 a253, v29
v_mfma_f32_16x16x32_bf16 v[208:211], a[216:219], a[160:163], v[208:211]
v_cvt_pk_bf16_f32 v200, v200, v201
v_cvt_pk_bf16_f32 v201, v202, v203
v_mfma_f32_16x16x32_bf16 v[208:211], a[220:223], a[176:179], v[208:211]
buffer_load_dwordx4 v228, s[20:23], s52 offen offset:2048 sc1 lds
v_mfma_f32_16x16x32_bf16 v[212:215], a[216:219], a[164:167], v[212:215]
v_cvt_pk_bf16_f32 v204, v204, v205
v_cvt_pk_bf16_f32 v205, v206, v207
v_mfma_f32_16x16x32_bf16 v[212:215], a[220:223], a[180:183], v[212:215]
ds_read_b128 a[204:207], v228 offset:3072
v_accvgpr_write_b32 a254, v30
v_mfma_f32_16x16x32_bf16 v[216:219], a[216:219], a[168:171], v[216:219]
v_cvt_pk_bf16_f32 v194, v208, v209
v_cvt_pk_bf16_f32 v195, v210, v211
v_mfma_f32_16x16x32_bf16 v[216:219], a[220:223], a[184:187], v[216:219]
buffer_load_dwordx4 v228, s[20:23], s52 offen offset:3072 sc1 lds
v_mfma_f32_16x16x32_bf16 v[220:223], a[216:219], a[172:175], v[220:223]
s_add_u32 m0, s48, 73728
v_cvt_pk_bf16_f32 v198, v212, v213
v_cvt_pk_bf16_f32 v199, v214, v215
v_mfma_f32_16x16x32_bf16 v[220:223], a[220:223], a[188:191], v[220:223]
v_accvgpr_write_b32 a255, v31
ds_read_b128 a[208:211], v228 offset:4096
v_mfma_f32_16x16x32_bf16 v[144:147], a[0:3], v[0:3], 0
v_cvt_pk_bf16_f32 v202, v216, v217
v_cvt_pk_bf16_f32 v203, v218, v219
v_mfma_f32_16x16x32_bf16 v[144:147], a[16:19], v[32:35], v[144:147]
buffer_load_dwordx4 v231, s[8:11], 0 offen lds
v_mfma_f32_16x16x32_bf16 v[148:151], a[0:3], v[4:7], 0
s_add_u32 m0, s48, 74752
v_cvt_pk_bf16_f32 v206, v220, v221
v_cvt_pk_bf16_f32 v207, v222, v223
v_mfma_f32_16x16x32_bf16 v[148:151], a[16:19], v[36:39], v[148:151]
ds_read_b128 a[212:215], v228 offset:5120
v_accvgpr_write_b32 a232, v76
v_mfma_f32_16x16x32_bf16 v[152:155], a[0:3], v[8:11], 0
v_accvgpr_write_b32 a233, v77
v_accvgpr_write_b32 a234, v78
v_mfma_f32_16x16x32_bf16 v[152:155], a[16:19], v[40:43], v[152:155]
buffer_load_dwordx4 v231, s[8:11], 64 offen lds
v_mfma_f32_16x16x32_bf16 v[156:159], a[0:3], v[12:15], 0
s_add_u32 m0, s48, 75776
v_accvgpr_write_b32 a235, v79
ds_read_b128 a[216:219], v228 offset:6144
v_mfma_f32_16x16x32_bf16 v[156:159], a[16:19], v[44:47], v[156:159]
ds_read_b128 a[220:223], v228 offset:7168
v_accvgpr_write_b32 a240, v140
v_mfma_f32_16x16x32_bf16 v[48:51], a[4:7], v[0:3], 0
v_accvgpr_write_b32 a241, v141
v_accvgpr_write_b32 a242, v142
v_mfma_f32_16x16x32_bf16 v[48:51], a[20:23], v[32:35], v[48:51]
buffer_load_dwordx4 v231, s[8:11], s44 offen lds
v_mfma_f32_16x16x32_bf16 v[52:55], a[4:7], v[4:7], 0
s_add_u32 m0, s48, 86016
v_accvgpr_write_b32 a243, v143
v_accvgpr_write_b32 a228, v44
v_mfma_f32_16x16x32_bf16 v[52:55], a[20:23], v[36:39], v[52:55]
v_accvgpr_write_b32 a229, v45
v_accvgpr_write_b32 a230, v46
v_mfma_f32_16x16x32_bf16 v[56:59], a[4:7], v[8:11], 0
v_accvgpr_write_b32 a231, v47
v_accvgpr_write_b32 a248, v204
v_mfma_f32_16x16x32_bf16 v[56:59], a[20:23], v[40:43], v[56:59]
buffer_load_dwordx4 v232, s[8:11], 0 offen lds
v_mfma_f32_16x16x32_bf16 v[60:63], a[4:7], v[12:15], 0
s_add_u32 m0, s48, 87040
v_accvgpr_write_b32 a249, v205
v_accvgpr_write_b32 a250, v206
v_mfma_f32_16x16x32_bf16 v[60:63], a[20:23], v[44:47], v[60:63]
v_accvgpr_write_b32 a251, v207
v_accvgpr_write_b32 a236, v108
v_mfma_f32_16x16x32_bf16 v[80:83], a[8:11], v[0:3], 0
v_accvgpr_write_b32 a237, v109
v_accvgpr_write_b32 a238, v110
v_mfma_f32_16x16x32_bf16 v[80:83], a[24:27], v[32:35], v[80:83]
buffer_load_dwordx4 v232, s[8:11], 64 offen lds
v_mfma_f32_16x16x32_bf16 v[84:87], a[8:11], v[4:7], 0
s_add_u32 m0, s48, 88064
v_accvgpr_write_b32 a239, v111
v_accvgpr_write_b32 a244, v172
v_mfma_f32_16x16x32_bf16 v[84:87], a[24:27], v[36:39], v[84:87]
v_accvgpr_write_b32 a245, v173
v_accvgpr_write_b32 a246, v174
v_mfma_f32_16x16x32_bf16 v[88:91], a[8:11], v[8:11], 0
v_accvgpr_write_b32 a247, v175
v_accvgpr_write_b32 a224, v12
v_mfma_f32_16x16x32_bf16 v[88:91], a[24:27], v[40:43], v[88:91]
buffer_load_dwordx4 v232, s[8:11], s44 offen lds
v_mfma_f32_16x16x32_bf16 v[92:95], a[8:11], v[12:15], 0
s_add_u32 m0, s48, 98304
v_accvgpr_write_b32 a225, v13
v_accvgpr_write_b32 a226, v14
v_mfma_f32_16x16x32_bf16 v[92:95], a[24:27], v[44:47], v[92:95]
v_accvgpr_write_b32 a227, v15
v_mfma_f32_16x16x32_bf16 v[112:115], a[12:15], v[0:3], 0
v_mfma_f32_16x16x32_bf16 v[112:115], a[28:31], v[32:35], v[112:115]
buffer_load_dwordx4 v233, s[8:11], 0 offen lds
v_mfma_f32_16x16x32_bf16 v[116:119], a[12:15], v[4:7], 0
s_add_u32 m0, s48, 99328
v_mfma_f32_16x16x32_bf16 v[116:119], a[28:31], v[36:39], v[116:119]
v_mfma_f32_16x16x32_bf16 v[120:123], a[12:15], v[8:11], 0
v_mfma_f32_16x16x32_bf16 v[120:123], a[28:31], v[40:43], v[120:123]
buffer_load_dwordx4 v233, s[8:11], 64 offen lds
v_mfma_f32_16x16x32_bf16 v[144:147], a[32:35], v[64:67], v[144:147]
s_add_u32 m0, s48, 100352
v_mfma_f32_16x16x32_bf16 v[144:147], a[48:51], v[96:99], v[144:147]
v_mfma_f32_16x16x32_bf16 v[148:151], a[32:35], v[68:71], v[148:151]
v_mfma_f32_16x16x32_bf16 v[148:151], a[48:51], v[100:103], v[148:151]
buffer_load_dwordx4 v233, s[8:11], s44 offen lds
v_mfma_f32_16x16x32_bf16 v[152:155], a[32:35], v[72:75], v[152:155]
s_mov_b32 m0, s49
v_mfma_f32_16x16x32_bf16 v[152:155], a[48:51], v[104:107], v[152:155]
v_mfma_f32_16x16x32_bf16 v[156:159], a[32:35], v[76:79], v[156:159]
v_mfma_f32_16x16x32_bf16 v[156:159], a[48:51], v[108:111], v[156:159]
buffer_load_dwordx4 v234, s[8:11], 0 offen lds
v_mfma_f32_16x16x32_bf16 v[48:51], a[36:39], v[64:67], v[48:51]
s_add_u32 m0, s56, 149504
v_mfma_f32_16x16x32_bf16 v[48:51], a[52:55], v[96:99], v[48:51]
v_mfma_f32_16x16x32_bf16 v[52:55], a[36:39], v[68:71], v[52:55]
v_mfma_f32_16x16x32_bf16 v[52:55], a[52:55], v[100:103], v[52:55]
buffer_load_dwordx4 v235, s[8:11], 0 offen lds
v_mfma_f32_16x16x32_bf16 v[56:59], a[36:39], v[72:75], v[56:59]
v_mov_b32 v235, 4
v_mfma_f32_16x16x32_bf16 v[56:59], a[52:55], v[104:107], v[56:59]
v_mfma_f32_16x16x32_bf16 v[60:63], a[36:39], v[76:79], v[60:63]
v_mfma_f32_16x16x32_bf16 v[60:63], a[52:55], v[108:111], v[60:63]
v_mfma_f32_16x16x32_bf16 v[80:83], a[40:43], v[64:67], v[80:83]
v_mfma_f32_16x16x32_bf16 v[80:83], a[56:59], v[96:99], v[80:83]
v_mfma_f32_16x16x32_bf16 v[84:87], a[40:43], v[68:71], v[84:87]
v_mfma_f32_16x16x32_bf16 v[84:87], a[56:59], v[100:103], v[84:87]
v_mfma_f32_16x16x32_bf16 v[88:91], a[40:43], v[72:75], v[88:91]
v_mfma_f32_16x16x32_bf16 v[88:91], a[56:59], v[104:107], v[88:91]
v_mfma_f32_16x16x32_bf16 v[92:95], a[40:43], v[76:79], v[92:95]
v_mfma_f32_16x16x32_bf16 v[92:95], a[56:59], v[108:111], v[92:95]
v_mfma_f32_16x16x32_bf16 v[112:115], a[44:47], v[64:67], v[112:115]
v_mfma_f32_16x16x32_bf16 v[112:115], a[60:63], v[96:99], v[112:115]
v_mfma_f32_16x16x32_bf16 v[116:119], a[44:47], v[68:71], v[116:119]
v_mfma_f32_16x16x32_bf16 v[116:119], a[60:63], v[100:103], v[116:119]
v_mfma_f32_16x16x32_bf16 v[120:123], a[44:47], v[72:75], v[120:123]
v_mfma_f32_16x16x32_bf16 v[120:123], a[60:63], v[104:107], v[120:123]
v_mfma_f32_16x16x32_bf16 v[144:147], a[64:67], v[128:131], v[144:147]
v_mfma_f32_16x16x32_bf16 v[144:147], a[80:83], v[160:163], v[144:147]
v_mfma_f32_16x16x32_bf16 v[148:151], a[64:67], v[132:135], v[148:151]
v_mfma_f32_16x16x32_bf16 v[148:151], a[80:83], v[164:167], v[148:151]
v_mfma_f32_16x16x32_bf16 v[152:155], a[64:67], v[136:139], v[152:155]
v_mfma_f32_16x16x32_bf16 v[152:155], a[80:83], v[168:171], v[152:155]
v_mfma_f32_16x16x32_bf16 v[156:159], a[64:67], v[140:143], v[156:159]
v_mfma_f32_16x16x32_bf16 v[156:159], a[80:83], v[172:175], v[156:159]
v_mfma_f32_16x16x32_bf16 v[48:51], a[68:71], v[128:131], v[48:51]
v_mfma_f32_16x16x32_bf16 v[48:51], a[84:87], v[160:163], v[48:51]
v_mfma_f32_16x16x32_bf16 v[52:55], a[68:71], v[132:135], v[52:55]
v_mfma_f32_16x16x32_bf16 v[52:55], a[84:87], v[164:167], v[52:55]
v_mfma_f32_16x16x32_bf16 v[56:59], a[68:71], v[136:139], v[56:59]
v_mfma_f32_16x16x32_bf16 v[56:59], a[84:87], v[168:171], v[56:59]
v_mfma_f32_16x16x32_bf16 v[60:63], a[68:71], v[140:143], v[60:63]
v_mfma_f32_16x16x32_bf16 v[60:63], a[84:87], v[172:175], v[60:63]
v_mfma_f32_16x16x32_bf16 v[80:83], a[72:75], v[128:131], v[80:83]
v_mfma_f32_16x16x32_bf16 v[80:83], a[88:91], v[160:163], v[80:83]
v_mfma_f32_16x16x32_bf16 v[84:87], a[72:75], v[132:135], v[84:87]
v_mfma_f32_16x16x32_bf16 v[84:87], a[88:91], v[164:167], v[84:87]
v_mfma_f32_16x16x32_bf16 v[88:91], a[72:75], v[136:139], v[88:91]
v_mfma_f32_16x16x32_bf16 v[88:91], a[88:91], v[168:171], v[88:91]
v_mfma_f32_16x16x32_bf16 v[92:95], a[72:75], v[140:143], v[92:95]
v_mfma_f32_16x16x32_bf16 v[92:95], a[88:91], v[172:175], v[92:95]
v_mfma_f32_16x16x32_bf16 v[112:115], a[76:79], v[128:131], v[112:115]
v_mfma_f32_16x16x32_bf16 v[112:115], a[92:95], v[160:163], v[112:115]
v_mfma_f32_16x16x32_bf16 v[116:119], a[76:79], v[132:135], v[116:119]
v_mfma_f32_16x16x32_bf16 v[116:119], a[92:95], v[164:167], v[116:119]
v_mfma_f32_16x16x32_bf16 v[120:123], a[76:79], v[136:139], v[120:123]
v_mfma_f32_16x16x32_bf16 v[120:123], a[92:95], v[168:171], v[120:123]
v_mfma_f32_16x16x32_bf16 v[144:147], a[96:99], v[192:195], v[144:147]
v_mfma_f32_16x16x32_bf16 v[144:147], a[112:115], v[16:19], v[144:147]
v_mfma_f32_16x16x32_bf16 v[148:151], a[96:99], v[196:199], v[148:151]
v_mfma_f32_16x16x32_bf16 v[148:151], a[112:115], v[20:23], v[148:151]
v_mfma_f32_16x16x32_bf16 v[152:155], a[96:99], v[200:203], v[152:155]
v_mfma_f32_16x16x32_bf16 v[152:155], a[112:115], v[24:27], v[152:155]
v_mfma_f32_16x16x32_bf16 v[156:159], a[96:99], v[204:207], v[156:159]
v_mfma_f32_16x16x32_bf16 v[156:159], a[112:115], v[28:31], v[156:159]
v_mfma_f32_16x16x32_bf16 v[48:51], a[100:103], v[192:195], v[48:51]
v_mfma_f32_16x16x32_bf16 v[48:51], a[116:119], v[16:19], v[48:51]
v_mfma_f32_16x16x32_bf16 v[52:55], a[100:103], v[196:199], v[52:55]
v_mfma_f32_16x16x32_bf16 v[52:55], a[116:119], v[20:23], v[52:55]
v_mfma_f32_16x16x32_bf16 v[56:59], a[100:103], v[200:203], v[56:59]
v_mfma_f32_16x16x32_bf16 v[56:59], a[116:119], v[24:27], v[56:59]
v_mfma_f32_16x16x32_bf16 v[60:63], a[100:103], v[204:207], v[60:63]
v_mfma_f32_16x16x32_bf16 v[60:63], a[116:119], v[28:31], v[60:63]
v_mfma_f32_16x16x32_bf16 v[80:83], a[104:107], v[192:195], v[80:83]
v_mfma_f32_16x16x32_bf16 v[80:83], a[120:123], v[16:19], v[80:83]
v_mfma_f32_16x16x32_bf16 v[84:87], a[104:107], v[196:199], v[84:87]
v_mfma_f32_16x16x32_bf16 v[84:87], a[120:123], v[20:23], v[84:87]
v_mfma_f32_16x16x32_bf16 v[88:91], a[104:107], v[200:203], v[88:91]
v_mfma_f32_16x16x32_bf16 v[88:91], a[120:123], v[24:27], v[88:91]
v_mfma_f32_16x16x32_bf16 v[92:95], a[104:107], v[204:207], v[92:95]
v_mfma_f32_16x16x32_bf16 v[92:95], a[120:123], v[28:31], v[92:95]
v_mfma_f32_16x16x32_bf16 v[112:115], a[108:111], v[192:195], v[112:115]
v_mfma_f32_16x16x32_bf16 v[112:115], a[124:127], v[16:19], v[112:115]
v_mfma_f32_16x16x32_bf16 v[116:119], a[108:111], v[196:199], v[116:119]
v_mfma_f32_16x16x32_bf16 v[116:119], a[124:127], v[20:23], v[116:119]
v_mfma_f32_16x16x32_bf16 v[120:123], a[108:111], v[200:203], v[120:123]
v_mfma_f32_16x16x32_bf16 v[120:123], a[124:127], v[24:27], v[120:123]
s_waitcnt lgkmcnt(6)
v_mfma_f32_16x16x32_bf16 v[16:19], a[192:195], a[0:3], 0
v_mfma_f32_16x16x32_bf16 v[16:19], a[196:199], a[16:19], v[16:19]
v_mfma_f32_16x16x32_bf16 v[20:23], a[192:195], a[4:7], 0
v_mfma_f32_16x16x32_bf16 v[20:23], a[196:199], a[20:23], v[20:23]
v_mfma_f32_16x16x32_bf16 v[24:27], a[192:195], a[8:11], 0
v_mfma_f32_16x16x32_bf16 v[24:27], a[196:199], a[24:27], v[24:27]
v_mfma_f32_16x16x32_bf16 v[28:31], a[192:195], a[12:15], 0
ds_read_b128 a[192:195], v228 offset:8192
v_mfma_f32_16x16x32_bf16 v[28:31], a[196:199], a[28:31], v[28:31]
s_waitcnt lgkmcnt(5)
ds_read_b128 a[196:199], v228 offset:9216
v_mfma_f32_16x16x32_bf16 v[64:67], a[200:203], a[0:3], 0
v_mfma_f32_16x16x32_bf16 v[64:67], a[204:207], a[16:19], v[64:67]
v_mfma_f32_16x16x32_bf16 v[68:71], a[200:203], a[4:7], 0
v_mfma_f32_16x16x32_bf16 v[68:71], a[204:207], a[20:23], v[68:71]
v_mfma_f32_16x16x32_bf16 v[72:75], a[200:203], a[8:11], 0
v_mfma_f32_16x16x32_bf16 v[72:75], a[204:207], a[24:27], v[72:75]
v_mfma_f32_16x16x32_bf16 v[76:79], a[200:203], a[12:15], 0
ds_read_b128 a[200:203], v228 offset:10240
v_mfma_f32_16x16x32_bf16 v[76:79], a[204:207], a[28:31], v[76:79]
s_waitcnt lgkmcnt(5)
ds_read_b128 a[204:207], v228 offset:11264
v_mfma_f32_16x16x32_bf16 v[208:211], a[208:211], a[0:3], 0
v_mfma_f32_16x16x32_bf16 v[208:211], a[212:215], a[16:19], v[208:211]
v_mfma_f32_16x16x32_bf16 v[212:215], a[208:211], a[4:7], 0
v_mfma_f32_16x16x32_bf16 v[212:215], a[212:215], a[20:23], v[212:215]
v_mfma_f32_16x16x32_bf16 v[216:219], a[208:211], a[8:11], 0
v_mfma_f32_16x16x32_bf16 v[216:219], a[212:215], a[24:27], v[216:219]
v_mfma_f32_16x16x32_bf16 v[220:223], a[208:211], a[12:15], 0
ds_read_b128 a[208:211], v228 offset:12288
v_mfma_f32_16x16x32_bf16 v[220:223], a[212:215], a[28:31], v[220:223]
s_waitcnt lgkmcnt(5)
ds_read_b128 a[212:215], v228 offset:13312
v_mfma_f32_16x16x32_bf16 v[128:131], a[216:219], a[0:3], 0
s_cmp_lg_u32 s24, 0
s_cbranch_scc1 L_nchk0
buffer_load_dword v234, v235, s[92:95], 0 offen sc1
L_nchk0:
v_mfma_f32_16x16x32_bf16 v[128:131], a[220:223], a[16:19], v[128:131]
v_mfma_f32_16x16x32_bf16 v[132:135], a[216:219], a[4:7], 0
v_mfma_f32_16x16x32_bf16 v[132:135], a[220:223], a[20:23], v[132:135]
v_mfma_f32_16x16x32_bf16 v[136:139], a[216:219], a[8:11], 0
v_mfma_f32_16x16x32_bf16 v[136:139], a[220:223], a[24:27], v[136:139]
v_mfma_f32_16x16x32_bf16 v[140:143], a[216:219], a[12:15], 0
ds_read_b128 a[216:219], v228 offset:14336
v_mfma_f32_16x16x32_bf16 v[140:143], a[220:223], a[28:31], v[140:143]
s_waitcnt lgkmcnt(5)
ds_read_b128 a[220:223], v228 offset:15360
v_mfma_f32_16x16x32_bf16 v[32:35], a[192:195], a[0:3], 0
v_mfma_f32_16x16x32_bf16 v[32:35], a[196:199], a[16:19], v[32:35]
v_mfma_f32_16x16x32_bf16 v[36:39], a[192:195], a[4:7], 0
v_mfma_f32_16x16x32_bf16 v[36:39], a[196:199], a[20:23], v[36:39]
v_mfma_f32_16x16x32_bf16 v[40:43], a[192:195], a[8:11], 0
v_mfma_f32_16x16x32_bf16 v[40:43], a[196:199], a[24:27], v[40:43]
v_mfma_f32_16x16x32_bf16 v[44:47], a[192:195], a[12:15], 0
v_mfma_f32_16x16x32_bf16 v[44:47], a[196:199], a[28:31], v[44:47]
s_waitcnt lgkmcnt(4)
v_mfma_f32_16x16x32_bf16 v[192:195], a[200:203], a[0:3], 0
s_waitcnt vmcnt(15) lgkmcnt(0)
s_barrier
s_add_u32 m0, s33, 0
v_mfma_f32_16x16x32_bf16 v[192:195], a[204:207], a[16:19], v[192:195]
s_add_u32 s53, s33, 245760
buffer_load_dwordx4 v228, s[20:23], s53 offen offset:0 sc1 lds
v_mfma_f32_16x16x32_bf16 v[196:199], a[200:203], a[4:7], 0
ds_read_b128 a[192:195], v228 offset:16384
v_mfma_f32_16x16x32_bf16 v[196:199], a[204:207], a[20:23], v[196:199]
ds_read_b128 a[196:199], v228 offset:17408
v_mfma_f32_16x16x32_bf16 v[200:203], a[200:203], a[8:11], 0
v_mfma_f32_16x16x32_bf16 v[200:203], a[204:207], a[24:27], v[200:203]
buffer_load_dwordx4 v228, s[20:23], s53 offen offset:1024 sc1 lds
v_mfma_f32_16x16x32_bf16 v[204:207], a[200:203], a[12:15], 0
ds_read_b128 a[200:203], v228 offset:18432
v_mfma_f32_16x16x32_bf16 v[204:207], a[204:207], a[28:31], v[204:207]
ds_read_b128 a[204:207], v228 offset:19456
v_mfma_f32_16x16x32_bf16 v[96:99], a[208:211], a[0:3], 0
v_mfma_f32_16x16x32_bf16 v[96:99], a[212:215], a[16:19], v[96:99]
buffer_load_dwordx4 v228, s[20:23], s53 offen offset:2048 sc1 lds
v_mfma_f32_16x16x32_bf16 v[100:103], a[208:211], a[4:7], 0
v_mfma_f32_16x16x32_bf16 v[100:103], a[212:215], a[20:23], v[100:103]
v_mfma_f32_16x16x32_bf16 v[104:107], a[208:211], a[8:11], 0
v_mfma_f32_16x16x32_bf16 v[104:107], a[212:215], a[24:27], v[104:107]
buffer_load_dwordx4 v228, s[20:23], s53 offen offset:3072 sc1 lds
v_mfma_f32_16x16x32_bf16 v[108:111], a[208:211], a[12:15], 0
ds_read_b128 a[208:211], v228 offset:20480
v_mfma_f32_16x16x32_bf16 v[108:111], a[212:215], a[28:31], v[108:111]
ds_read_b128 a[212:215], v228 offset:21504
v_mfma_f32_16x16x32_bf16 v[160:163], a[216:219], a[0:3], 0
v_mfma_f32_16x16x32_bf16 v[160:163], a[220:223], a[16:19], v[160:163]
v_mfma_f32_16x16x32_bf16 v[164:167], a[216:219], a[4:7], 0
v_mfma_f32_16x16x32_bf16 v[164:167], a[220:223], a[20:23], v[164:167]
v_mfma_f32_16x16x32_bf16 v[168:171], a[216:219], a[8:11], 0
v_mfma_f32_16x16x32_bf16 v[168:171], a[220:223], a[24:27], v[168:171]
v_mfma_f32_16x16x32_bf16 v[172:175], a[216:219], a[12:15], 0
ds_read_b128 a[216:219], v228 offset:22528
v_mfma_f32_16x16x32_bf16 v[172:175], a[220:223], a[28:31], v[172:175]
s_waitcnt lgkmcnt(5)
ds_read_b128 a[220:223], v228 offset:23552
v_mfma_f32_16x16x32_bf16 v[16:19], a[192:195], a[32:35], v[16:19]
v_mfma_f32_16x16x32_bf16 v[16:19], a[196:199], a[48:51], v[16:19]
v_mfma_f32_16x16x32_bf16 v[20:23], a[192:195], a[36:39], v[20:23]
v_mfma_f32_16x16x32_bf16 v[20:23], a[196:199], a[52:55], v[20:23]
v_mfma_f32_16x16x32_bf16 v[24:27], a[192:195], a[40:43], v[24:27]
v_mfma_f32_16x16x32_bf16 v[24:27], a[196:199], a[56:59], v[24:27]
v_mfma_f32_16x16x32_bf16 v[28:31], a[192:195], a[44:47], v[28:31]
ds_read_b128 a[192:195], v228 offset:24576
v_mfma_f32_16x16x32_bf16 v[28:31], a[196:199], a[60:63], v[28:31]
s_waitcnt lgkmcnt(5)
ds_read_b128 a[196:199], v228 offset:25600
v_mfma_f32_16x16x32_bf16 v[64:67], a[200:203], a[32:35], v[64:67]
v_mfma_f32_16x16x32_bf16 v[64:67], a[204:207], a[48:51], v[64:67]
v_mfma_f32_16x16x32_bf16 v[68:71], a[200:203], a[36:39], v[68:71]
v_mfma_f32_16x16x32_bf16 v[68:71], a[204:207], a[52:55], v[68:71]
v_mfma_f32_16x16x32_bf16 v[72:75], a[200:203], a[40:43], v[72:75]
v_mfma_f32_16x16x32_bf16 v[72:75], a[204:207], a[56:59], v[72:75]
v_mfma_f32_16x16x32_bf16 v[76:79], a[200:203], a[44:47], v[76:79]
ds_read_b128 a[200:203], v228 offset:26624
v_mfma_f32_16x16x32_bf16 v[76:79], a[204:207], a[60:63], v[76:79]
s_waitcnt lgkmcnt(5)
ds_read_b128 a[204:207], v228 offset:27648
v_mfma_f32_16x16x32_bf16 v[208:211], a[208:211], a[32:35], v[208:211]
v_mfma_f32_16x16x32_bf16 v[208:211], a[212:215], a[48:51], v[208:211]
v_mfma_f32_16x16x32_bf16 v[212:215], a[208:211], a[36:39], v[212:215]
v_mfma_f32_16x16x32_bf16 v[212:215], a[212:215], a[52:55], v[212:215]
v_mfma_f32_16x16x32_bf16 v[216:219], a[208:211], a[40:43], v[216:219]
v_mfma_f32_16x16x32_bf16 v[216:219], a[212:215], a[56:59], v[216:219]
v_mfma_f32_16x16x32_bf16 v[220:223], a[208:211], a[44:47], v[220:223]
ds_read_b128 a[208:211], v228 offset:28672
v_mfma_f32_16x16x32_bf16 v[220:223], a[212:215], a[60:63], v[220:223]
s_waitcnt lgkmcnt(5)
ds_read_b128 a[212:215], v228 offset:29696
v_mfma_f32_16x16x32_bf16 v[128:131], a[216:219], a[32:35], v[128:131]
v_mfma_f32_16x16x32_bf16 v[128:131], a[220:223], a[48:51], v[128:131]
v_mfma_f32_16x16x32_bf16 v[132:135], a[216:219], a[36:39], v[132:135]
v_mfma_f32_16x16x32_bf16 v[132:135], a[220:223], a[52:55], v[132:135]
v_mfma_f32_16x16x32_bf16 v[136:139], a[216:219], a[40:43], v[136:139]
v_mfma_f32_16x16x32_bf16 v[136:139], a[220:223], a[56:59], v[136:139]
v_mfma_f32_16x16x32_bf16 v[140:143], a[216:219], a[44:47], v[140:143]
ds_read_b128 a[216:219], v228 offset:30720
v_mfma_f32_16x16x32_bf16 v[140:143], a[220:223], a[60:63], v[140:143]
s_waitcnt lgkmcnt(5)
ds_read_b128 a[220:223], v228 offset:31744
v_mfma_f32_16x16x32_bf16 v[32:35], a[192:195], a[32:35], v[32:35]
s_cmp_lg_u32 s24, 0
s_cbranch_scc1 L_nchk1
s_waitcnt vmcnt(4)
v_readfirstlane_b32 s28, v234
s_nop 0
s_cmp_lt_u32 s28, s69
s_cbranch_scc1 L_nspin
L_nchk1:
v_mfma_f32_16x16x32_bf16 v[32:35], a[196:199], a[48:51], v[32:35]
v_mfma_f32_16x16x32_bf16 v[36:39], a[192:195], a[36:39], v[36:39]
v_mfma_f32_16x16x32_bf16 v[36:39], a[196:199], a[52:55], v[36:39]
v_mfma_f32_16x16x32_bf16 v[40:43], a[192:195], a[40:43], v[40:43]
v_mfma_f32_16x16x32_bf16 v[40:43], a[196:199], a[56:59], v[40:43]
v_mfma_f32_16x16x32_bf16 v[44:47], a[192:195], a[44:47], v[44:47]
v_mfma_f32_16x16x32_bf16 v[44:47], a[196:199], a[60:63], v[44:47]
s_waitcnt lgkmcnt(4)
v_mfma_f32_16x16x32_bf16 v[192:195], a[200:203], a[32:35], v[192:195]
s_waitcnt vmcnt(4) lgkmcnt(0)
s_barrier
ds_read_b128 a[192:195], v228 offset:32768
v_mfma_f32_16x16x32_bf16 v[192:195], a[204:207], a[48:51], v[192:195]
s_add_u32 m0, s33, 16384
ds_read_b128 a[196:199], v228 offset:33792
v_mfma_f32_16x16x32_bf16 v[196:199], a[200:203], a[36:39], v[196:199]
s_add_u32 s54, s33, 262144
buffer_load_dwordx4 v228, s[20:23], s54 offen offset:0 sc1 lds
v_mfma_f32_16x16x32_bf16 v[196:199], a[204:207], a[52:55], v[196:199]
ds_read_b128 v[0:3], v236 offset:0
v_mfma_f32_16x16x32_bf16 v[200:203], a[200:203], a[40:43], v[200:203]
ds_read_b128 v[4:7], v236 offset:1024
v_mfma_f32_16x16x32_bf16 v[200:203], a[204:207], a[56:59], v[200:203]
ds_read_b128 v[8:11], v236 offset:12288
v_mfma_f32_16x16x32_bf16 v[204:207], a[200:203], a[44:47], v[204:207]
buffer_load_dwordx4 v228, s[20:23], s54 offen offset:1024 sc1 lds
v_mfma_f32_16x16x32_bf16 v[204:207], a[204:207], a[60:63], v[204:207]
ds_read_b128 a[200:203], v228 offset:34816
v_mfma_f32_16x16x32_bf16 v[96:99], a[208:211], a[32:35], v[96:99]
ds_read_b128 a[204:207], v228 offset:35840
v_mfma_f32_16x16x32_bf16 v[96:99], a[212:215], a[48:51], v[96:99]
ds_read_b128 v[12:15], v236 offset:13312
v_mfma_f32_16x16x32_bf16 v[100:103], a[208:211], a[36:39], v[100:103]
buffer_load_dwordx4 v228, s[20:23], s54 offen offset:2048 sc1 lds
v_mfma_f32_16x16x32_bf16 v[100:103], a[212:215], a[52:55], v[100:103]
v_mfma_f32_16x16x32_bf16 v[104:107], a[208:211], a[40:43], v[104:107]
v_mfma_f32_16x16x32_bf16 v[104:107], a[212:215], a[56:59], v[104:107]
v_mfma_f32_16x16x32_bf16 v[108:111], a[208:211], a[44:47], v[108:111]
buffer_load_dwordx4 v228, s[20:23], s54 offen offset:3072 sc1 lds
v_mfma_f32_16x16x32_bf16 v[108:111], a[212:215], a[60:63], v[108:111]
s_add_u32 m0, s48, 111616
ds_read_b128 a[208:211], v228 offset:36864
v_mfma_f32_16x16x32_bf16 v[160:163], a[216:219], a[32:35], v[160:163]
ds_read_b128 a[212:215], v228 offset:37888
v_mfma_f32_16x16x32_bf16 v[160:163], a[220:223], a[48:51], v[160:163]
v_mfma_f32_16x16x32_bf16 v[164:167], a[216:219], a[36:39], v[164:167]
v_mfma_f32_16x16x32_bf16 v[164:167], a[220:223], a[52:55], v[164:167]
v_mfma_f32_16x16x32_bf16 v[168:171], a[216:219], a[40:43], v[168:171]
v_mfma_f32_16x16x32_bf16 v[168:171], a[220:223], a[56:59], v[168:171]
v_mfma_f32_16x16x32_bf16 v[172:175], a[216:219], a[44:47], v[172:175]
ds_read_b128 a[216:219], v228 offset:38912
v_mfma_f32_16x16x32_bf16 v[172:175], a[220:223], a[60:63], v[172:175]
s_waitcnt lgkmcnt(9)
ds_read_b128 a[220:223], v228 offset:39936
v_mfma_f32_16x16x32_bf16 v[16:19], a[192:195], a[64:67], v[16:19]
buffer_load_dwordx4 v231, s[8:11], s45 offen lds
v_mfma_f32_16x16x32_bf16 v[16:19], a[196:199], a[80:83], v[16:19]
s_add_u32 m0, s48, 112640
v_mfma_f32_16x16x32_bf16 v[20:23], a[192:195], a[68:71], v[20:23]
v_mfma_f32_16x16x32_bf16 v[20:23], a[196:199], a[84:87], v[20:23]
v_mfma_f32_16x16x32_bf16 v[24:27], a[192:195], a[72:75], v[24:27]
buffer_load_dwordx4 v231, s[8:11], s46 offen lds
v_mfma_f32_16x16x32_bf16 v[24:27], a[196:199], a[88:91], v[24:27]
s_add_u32 m0, s48, 113664
v_mfma_f32_16x16x32_bf16 v[28:31], a[192:195], a[76:79], v[28:31]
ds_read_b128 a[192:195], v228 offset:40960
v_mfma_f32_16x16x32_bf16 v[28:31], a[196:199], a[92:95], v[28:31]
s_waitcnt lgkmcnt(9)
ds_read_b128 a[196:199], v228 offset:41984
v_mfma_f32_16x16x32_bf16 v[176:179], v[0:3], a[224:227], 0
ds_read_b128 v[0:3], v236 offset:24576
v_mfma_f32_16x16x32_bf16 v[176:179], v[4:7], a[228:231], v[176:179]
s_waitcnt lgkmcnt(8)
ds_read_b128 v[4:7], v236 offset:25600
v_mfma_f32_16x16x32_bf16 v[64:67], a[200:203], a[64:67], v[64:67]
buffer_load_dwordx4 v231, s[8:11], s47 offen lds
v_mfma_f32_16x16x32_bf16 v[64:67], a[204:207], a[80:83], v[64:67]
s_add_u32 m0, s48, 123904
v_mfma_f32_16x16x32_bf16 v[68:71], a[200:203], a[68:71], v[68:71]
v_mfma_f32_16x16x32_bf16 v[68:71], a[204:207], a[84:87], v[68:71]
v_mfma_f32_16x16x32_bf16 v[72:75], a[200:203], a[72:75], v[72:75]
buffer_load_dwordx4 v232, s[8:11], s45 offen lds
v_mfma_f32_16x16x32_bf16 v[72:75], a[204:207], a[88:91], v[72:75]
s_add_u32 m0, s48, 124928
v_mfma_f32_16x16x32_bf16 v[76:79], a[200:203], a[76:79], v[76:79]
ds_read_b128 a[200:203], v228 offset:43008
v_mfma_f32_16x16x32_bf16 v[76:79], a[204:207], a[92:95], v[76:79]
s_waitcnt lgkmcnt(7)
ds_read_b128 a[204:207], v228 offset:44032
v_mfma_f32_16x16x32_bf16 v[208:211], a[208:211], a[64:67], v[208:211]
buffer_load_dwordx4 v232, s[8:11], s46 offen lds
v_mfma_f32_16x16x32_bf16 v[208:211], a[212:215], a[80:83], v[208:211]
s_add_u32 m0, s48, 125952
v_mfma_f32_16x16x32_bf16 v[212:215], a[208:211], a[68:71], v[212:215]
v_mfma_f32_16x16x32_bf16 v[212:215], a[212:215], a[84:87], v[212:215]
v_mfma_f32_16x16x32_bf16 v[216:219], a[208:211], a[72:75], v[216:219]
buffer_load_dwordx4 v232, s[8:11], s47 offen lds
v_mfma_f32_16x16x32_bf16 v[216:219], a[212:215], a[88:91], v[216:219]
s_add_u32 m0, s48, 136192
v_mfma_f32_16x16x32_bf16 v[220:223], a[208:211], a[76:79], v[220:223]
ds_read_b128 a[208:211], v228 offset:45056
v_mfma_f32_16x16x32_bf16 v[220:223], a[212:215], a[92:95], v[220:223]
ds_read_b128 a[212:215], v228 offset:46080
v_mfma_f32_16x16x32_bf16 v[180:183], v[8:11], a[224:227], 0
buffer_load_dwordx4 v233, s[8:11], s45 offen lds
v_mfma_f32_16x16x32_bf16 v[180:183], v[12:15], a[228:231], v[180:183]
s_waitcnt lgkmcnt(8)
s_add_u32 m0, s48, 137216
ds_read_b128 v[8:11], v238 offset:0
v_mfma_f32_16x16x32_bf16 v[128:131], a[216:219], a[64:67], v[128:131]
ds_read_b128 v[12:15], v238 offset:64
v_mfma_f32_16x16x32_bf16 v[128:131], a[220:223], a[80:83], v[128:131]
v_mfma_f32_16x16x32_bf16 v[132:135], a[216:219], a[68:71], v[132:135]
buffer_load_dwordx4 v233, s[8:11], s46 offen lds
v_mfma_f32_16x16x32_bf16 v[132:135], a[220:223], a[84:87], v[132:135]
s_add_u32 m0, s48, 138240
v_mfma_f32_16x16x32_bf16 v[136:139], a[216:219], a[72:75], v[136:139]
v_mfma_f32_16x16x32_bf16 v[136:139], a[220:223], a[88:91], v[136:139]
v_mfma_f32_16x16x32_bf16 v[140:143], a[216:219], a[76:79], v[140:143]
ds_read_b128 a[216:219], v228 offset:47104
v_mfma_f32_16x16x32_bf16 v[140:143], a[220:223], a[92:95], v[140:143]
s_waitcnt lgkmcnt(9)
ds_read_b128 a[220:223], v228 offset:48128
v_mfma_f32_16x16x32_bf16 v[32:35], a[192:195], a[64:67], v[32:35]
buffer_load_dwordx4 v233, s[8:11], s47 offen lds
v_mfma_f32_16x16x32_bf16 v[32:35], a[196:199], a[80:83], v[32:35]
v_mfma_f32_16x16x32_bf16 v[36:39], a[192:195], a[68:71], v[36:39]
v_mfma_f32_16x16x32_bf16 v[36:39], a[196:199], a[84:87], v[36:39]
v_mfma_f32_16x16x32_bf16 v[40:43], a[192:195], a[72:75], v[40:43]
v_mfma_f32_16x16x32_bf16 v[40:43], a[196:199], a[88:91], v[40:43]
v_mfma_f32_16x16x32_bf16 v[44:47], a[192:195], a[76:79], v[44:47]
v_mfma_f32_16x16x32_bf16 v[44:47], a[196:199], a[92:95], v[44:47]
s_waitcnt lgkmcnt(8)
v_mfma_f32_16x16x32_bf16 v[184:187], v[0:3], a[224:227], 0
s_waitcnt vmcnt(13) lgkmcnt(0)
s_barrier
ds_read_b128 a[192:195], v228 offset:0
v_mfma_f32_16x16x32_bf16 v[184:187], v[4:7], a[228:231], v[184:187]
s_add_u32 m0, s33, 32768
ds_read_b128 a[196:199], v228 offset:1024
v_mfma_f32_16x16x32_bf16 v[192:195], a[200:203], a[64:67], v[192:195]
s_add_u32 s55, s33, 278528
ds_read_b128 v[0:3], v236 offset:2048
v_mfma_f32_16x16x32_bf16 v[192:195], a[204:207], a[80:83], v[192:195]
ds_read_b128 v[4:7], v236 offset:3072
v_mfma_f32_16x16x32_bf16 v[196:199], a[200:203], a[68:71], v[196:199]
buffer_load_dwordx4 v228, s[20:23], s55 offen offset:0 sc1 lds
v_mfma_f32_16x16x32_bf16 v[196:199], a[204:207], a[84:87], v[196:199]
v_mfma_f32_16x16x32_bf16 v[200:203], a[200:203], a[72:75], v[200:203]
v_mfma_f32_16x16x32_bf16 v[200:203], a[204:207], a[88:91], v[200:203]
v_mfma_f32_16x16x32_bf16 v[204:207], a[200:203], a[76:79], v[204:207]
buffer_load_dwordx4 v228, s[20:23], s55 offen offset:1024 sc1 lds
v_mfma_f32_16x16x32_bf16 v[204:207], a[204:207], a[92:95], v[204:207]
ds_read_b128 a[200:203], v228 offset:2048
v_mfma_f32_16x16x32_bf16 v[96:99], a[208:211], a[64:67], v[96:99]
ds_read_b128 a[204:207], v228 offset:3072
v_mfma_f32_16x16x32_bf16 v[96:99], a[212:215], a[80:83], v[96:99]
v_mfma_f32_16x16x32_bf16 v[100:103], a[208:211], a[68:71], v[100:103]
buffer_load_dwordx4 v228, s[20:23], s55 offen offset:2048 sc1 lds
v_mfma_f32_16x16x32_bf16 v[100:103], a[212:215], a[84:87], v[100:103]
v_mfma_f32_16x16x32_bf16 v[104:107], a[208:211], a[72:75], v[104:107]
v_mfma_f32_16x16x32_bf16 v[104:107], a[212:215], a[88:91], v[104:107]
v_mfma_f32_16x16x32_bf16 v[108:111], a[208:211], a[76:79], v[108:111]
buffer_load_dwordx4 v228, s[20:23], s55 offen offset:3072 sc1 lds
v_mfma_f32_16x16x32_bf16 v[108:111], a[212:215], a[92:95], v[108:111]
ds_read_b128 a[208:211], v228 offset:4096
v_mfma_f32_16x16x32_bf16 v[188:191], v[8:11], a[224:227], 0
ds_read_b128 a[212:215], v228 offset:5120
v_mfma_f32_16x16x32_bf16 v[188:191], v[12:15], a[228:231], v[188:191]
ds_read_b128 v[8:11], v236 offset:14336
v_mfma_f32_16x16x32_bf16 v[160:163], a[216:219], a[64:67], v[160:163]
ds_read_b128 v[12:15], v236 offset:15360
v_mfma_f32_16x16x32_bf16 v[160:163], a[220:223], a[80:83], v[160:163]
v_mfma_f32_16x16x32_bf16 v[164:167], a[216:219], a[68:71], v[164:167]
v_mfma_f32_16x16x32_bf16 v[164:167], a[220:223], a[84:87], v[164:167]
v_mfma_f32_16x16x32_bf16 v[168:171], a[216:219], a[72:75], v[168:171]
v_mfma_f32_16x16x32_bf16 v[168:171], a[220:223], a[88:91], v[168:171]
v_mfma_f32_16x16x32_bf16 v[172:175], a[216:219], a[76:79], v[172:175]
ds_read_b128 a[216:219], v228 offset:6144
v_mfma_f32_16x16x32_bf16 v[172:175], a[220:223], a[92:95], v[172:175]
s_waitcnt lgkmcnt(9)
ds_read_b128 a[220:223], v228 offset:7168
v_mfma_f32_16x16x32_bf16 v[16:19], a[192:195], a[96:99], v[16:19]
v_mfma_f32_16x16x32_bf16 v[16:19], a[196:199], a[112:115], v[16:19]
v_mfma_f32_16x16x32_bf16 v[20:23], a[192:195], a[100:103], v[20:23]
v_mfma_f32_16x16x32_bf16 v[20:23], a[196:199], a[116:119], v[20:23]
v_mfma_f32_16x16x32_bf16 v[24:27], a[192:195], a[104:107], v[24:27]
v_mfma_f32_16x16x32_bf16 v[24:27], a[196:199], a[120:123], v[24:27]
v_mfma_f32_16x16x32_bf16 v[28:31], a[192:195], a[108:111], v[28:31]
ds_read_b128 a[192:195], v228 offset:8192
v_mfma_f32_16x16x32_bf16 v[28:31], a[196:199], a[124:127], v[28:31]
s_waitcnt lgkmcnt(9)
ds_read_b128 a[196:199], v228 offset:9216
v_mfma_f32_16x16x32_bf16 v[176:179], v[0:3], a[232:235], v[176:179]
ds_read_b128 v[0:3], v236 offset:26624
v_mfma_f32_16x16x32_bf16 v[176:179], v[4:7], a[236:239], v[176:179]
s_waitcnt lgkmcnt(9)
ds_read_b128 v[4:7], v236 offset:27648
v_mfma_f32_16x16x32_bf16 v[64:67], a[200:203], a[96:99], v[64:67]
v_mfma_f32_16x16x32_bf16 v[64:67], a[204:207], a[112:115], v[64:67]
v_mfma_f32_16x16x32_bf16 v[68:71], a[200:203], a[100:103], v[68:71]
v_mfma_f32_16x16x32_bf16 v[68:71], a[204:207], a[116:119], v[68:71]
v_mfma_f32_16x16x32_bf16 v[72:75], a[200:203], a[104:107], v[72:75]
v_mfma_f32_16x16x32_bf16 v[72:75], a[204:207], a[120:123], v[72:75]
v_mfma_f32_16x16x32_bf16 v[76:79], a[200:203], a[108:111], v[76:79]
ds_read_b128 a[200:203], v228 offset:10240
v_mfma_f32_16x16x32_bf16 v[76:79], a[204:207], a[124:127], v[76:79]
s_waitcnt lgkmcnt(9)
ds_read_b128 a[204:207], v228 offset:11264
v_mfma_f32_16x16x32_bf16 v[208:211], a[208:211], a[96:99], v[208:211]
v_mfma_f32_16x16x32_bf16 v[208:211], a[212:215], a[112:115], v[208:211]
v_mfma_f32_16x16x32_bf16 v[212:215], a[208:211], a[100:103], v[212:215]
v_mfma_f32_16x16x32_bf16 v[212:215], a[212:215], a[116:119], v[212:215]
v_mfma_f32_16x16x32_bf16 v[216:219], a[208:211], a[104:107], v[216:219]
v_mfma_f32_16x16x32_bf16 v[216:219], a[212:215], a[120:123], v[216:219]
v_mfma_f32_16x16x32_bf16 v[220:223], a[208:211], a[108:111], v[220:223]
ds_read_b128 a[208:211], v228 offset:12288
v_mfma_f32_16x16x32_bf16 v[220:223], a[212:215], a[124:127], v[220:223]
s_waitcnt lgkmcnt(9)
ds_read_b128 a[212:215], v228 offset:13312
v_mfma_f32_16x16x32_bf16 v[180:183], v[8:11], a[232:235], v[180:183]
ds_read_b128 v[8:11], v238 offset:128
v_mfma_f32_16x16x32_bf16 v[180:183], v[12:15], a[236:239], v[180:183]
s_waitcnt lgkmcnt(9)
ds_read_b128 v[12:15], v238 offset:192
v_mfma_f32_16x16x32_bf16 v[128:131], a[216:219], a[96:99], v[128:131]
v_mfma_f32_16x16x32_bf16 v[128:131], a[220:223], a[112:115], v[128:131]
v_mfma_f32_16x16x32_bf16 v[132:135], a[216:219], a[100:103], v[132:135]
v_mfma_f32_16x16x32_bf16 v[132:135], a[220:223], a[116:119], v[132:135]
v_mfma_f32_16x16x32_bf16 v[136:139], a[216:219], a[104:107], v[136:139]
v_mfma_f32_16x16x32_bf16 v[136:139], a[220:223], a[120:123], v[136:139]
v_mfma_f32_16x16x32_bf16 v[140:143], a[216:219], a[108:111], v[140:143]
ds_read_b128 a[216:219], v228 offset:14336
v_mfma_f32_16x16x32_bf16 v[140:143], a[220:223], a[124:127], v[140:143]
s_waitcnt lgkmcnt(9)
ds_read_b128 a[220:223], v228 offset:15360
v_mfma_f32_16x16x32_bf16 v[32:35], a[192:195], a[96:99], v[32:35]
v_mfma_f32_16x16x32_bf16 v[32:35], a[196:199], a[112:115], v[32:35]
v_mfma_f32_16x16x32_bf16 v[36:39], a[192:195], a[100:103], v[36:39]
v_mfma_f32_16x16x32_bf16 v[36:39], a[196:199], a[116:119], v[36:39]
v_mfma_f32_16x16x32_bf16 v[40:43], a[192:195], a[104:107], v[40:43]
v_mfma_f32_16x16x32_bf16 v[40:43], a[196:199], a[120:123], v[40:43]
v_mfma_f32_16x16x32_bf16 v[44:47], a[192:195], a[108:111], v[44:47]
v_mfma_f32_16x16x32_bf16 v[44:47], a[196:199], a[124:127], v[44:47]
s_waitcnt lgkmcnt(8)
v_mfma_f32_16x16x32_bf16 v[184:187], v[0:3], a[232:235], v[184:187]
s_waitcnt vmcnt(13) lgkmcnt(0)
s_barrier
ds_read_b128 a[192:195], v228 offset:16384
v_mfma_f32_16x16x32_bf16 v[184:187], v[4:7], a[236:239], v[184:187]
s_add_u32 m0, s34, 49152
ds_read_b128 a[196:199], v228 offset:17408
v_mfma_f32_16x16x32_bf16 v[192:195], a[200:203], a[96:99], v[192:195]
s_add_u32 s50, s34, 294912
ds_read_b128 v[0:3], v236 offset:4096
v_mfma_f32_16x16x32_bf16 v[192:195], a[204:207], a[112:115], v[192:195]
ds_read_b128 v[4:7], v236 offset:5120
v_mfma_f32_16x16x32_bf16 v[196:199], a[200:203], a[100:103], v[196:199]
buffer_load_dwordx4 v228, s[20:23], s50 offen offset:0 sc1 lds
v_mfma_f32_16x16x32_bf16 v[196:199], a[204:207], a[116:119], v[196:199]
v_mfma_f32_16x16x32_bf16 v[200:203], a[200:203], a[104:107], v[200:203]
v_mfma_f32_16x16x32_bf16 v[200:203], a[204:207], a[120:123], v[200:203]
v_mfma_f32_16x16x32_bf16 v[204:207], a[200:203], a[108:111], v[204:207]
ds_read_b128 a[200:203], v228 offset:18432
v_mfma_f32_16x16x32_bf16 v[204:207], a[204:207], a[124:127], v[204:207]
ds_read_b128 a[204:207], v228 offset:19456
v_mfma_f32_16x16x32_bf16 v[96:99], a[208:211], a[96:99], v[96:99]
buffer_load_dwordx4 v228, s[20:23], s50 offen offset:1024 sc1 lds
v_mfma_f32_16x16x32_bf16 v[96:99], a[212:215], a[112:115], v[96:99]
v_mfma_f32_16x16x32_bf16 v[100:103], a[208:211], a[100:103], v[100:103]
v_mfma_f32_16x16x32_bf16 v[100:103], a[212:215], a[116:119], v[100:103]
v_mfma_f32_16x16x32_bf16 v[104:107], a[208:211], a[104:107], v[104:107]
buffer_load_dwordx4 v228, s[20:23], s50 offen offset:2048 sc1 lds
v_mfma_f32_16x16x32_bf16 v[104:107], a[212:215], a[120:123], v[104:107]
v_mfma_f32_16x16x32_bf16 v[108:111], a[208:211], a[108:111], v[108:111]
ds_read_b128 a[208:211], v228 offset:20480
v_mfma_f32_16x16x32_bf16 v[108:111], a[212:215], a[124:127], v[108:111]
ds_read_b128 a[212:215], v228 offset:21504
v_mfma_f32_16x16x32_bf16 v[188:191], v[8:11], a[232:235], v[188:191]
ds_read_b128 v[8:11], v236 offset:16384
v_mfma_f32_16x16x32_bf16 v[188:191], v[12:15], a[236:239], v[188:191]
ds_read_b128 v[12:15], v236 offset:17408
v_mfma_f32_16x16x32_bf16 v[160:163], a[216:219], a[96:99], v[160:163]
buffer_load_dwordx4 v228, s[20:23], s50 offen offset:3072 sc1 lds
v_mfma_f32_16x16x32_bf16 v[160:163], a[220:223], a[112:115], v[160:163]
s_add_u32 m0, s34, 53248
s_add_u32 s51, s34, 299008
v_mfma_f32_16x16x32_bf16 v[164:167], a[216:219], a[100:103], v[164:167]
v_mfma_f32_16x16x32_bf16 v[164:167], a[220:223], a[116:119], v[164:167]
v_mfma_f32_16x16x32_bf16 v[168:171], a[216:219], a[104:107], v[168:171]
buffer_load_dwordx4 v228, s[20:23], s51 offen offset:0 sc1 lds
v_mfma_f32_16x16x32_bf16 v[168:171], a[220:223], a[120:123], v[168:171]
v_mfma_f32_16x16x32_bf16 v[172:175], a[216:219], a[108:111], v[172:175]
ds_read_b128 a[216:219], v228 offset:22528
v_mfma_f32_16x16x32_bf16 v[172:175], a[220:223], a[124:127], v[172:175]
s_waitcnt lgkmcnt(9)
ds_read_b128 a[220:223], v228 offset:23552
v_mfma_f32_16x16x32_bf16 v[16:19], a[192:195], a[128:131], v[16:19]
buffer_load_dwordx4 v228, s[20:23], s51 offen offset:1024 sc1 lds
v_mfma_f32_16x16x32_bf16 v[16:19], a[196:199], a[144:147], v[16:19]
v_mfma_f32_16x16x32_bf16 v[20:23], a[192:195], a[132:135], v[20:23]
v_mfma_f32_16x16x32_bf16 v[20:23], a[196:199], a[148:151], v[20:23]
v_mfma_f32_16x16x32_bf16 v[24:27], a[192:195], a[136:139], v[24:27]
v_mfma_f32_16x16x32_bf16 v[24:27], a[196:199], a[152:155], v[24:27]
v_mfma_f32_16x16x32_bf16 v[28:31], a[192:195], a[140:143], v[28:31]
ds_read_b128 a[192:195], v228 offset:24576
v_mfma_f32_16x16x32_bf16 v[28:31], a[196:199], a[156:159], v[28:31]
s_waitcnt lgkmcnt(9)
ds_read_b128 a[196:199], v228 offset:25600
v_mfma_f32_16x16x32_bf16 v[176:179], v[0:3], a[240:243], v[176:179]
ds_read_b128 v[0:3], v236 offset:28672
v_mfma_f32_16x16x32_bf16 v[176:179], v[4:7], a[244:247], v[176:179]
s_waitcnt lgkmcnt(9)
ds_read_b128 v[4:7], v236 offset:29696
v_mfma_f32_16x16x32_bf16 v[64:67], a[200:203], a[128:131], v[64:67]
v_mfma_f32_16x16x32_bf16 v[64:67], a[204:207], a[144:147], v[64:67]
v_mfma_f32_16x16x32_bf16 v[68:71], a[200:203], a[132:135], v[68:71]
v_mfma_f32_16x16x32_bf16 v[68:71], a[204:207], a[148:151], v[68:71]
v_mfma_f32_16x16x32_bf16 v[72:75], a[200:203], a[136:139], v[72:75]
v_mfma_f32_16x16x32_bf16 v[72:75], a[204:207], a[152:155], v[72:75]
v_mfma_f32_16x16x32_bf16 v[76:79], a[200:203], a[140:143], v[76:79]
ds_read_b128 a[200:203], v228 offset:26624
v_mfma_f32_16x16x32_bf16 v[76:79], a[204:207], a[156:159], v[76:79]
s_waitcnt lgkmcnt(9)
ds_read_b128 a[204:207], v228 offset:27648
v_mfma_f32_16x16x32_bf16 v[208:211], a[208:211], a[128:131], v[208:211]
v_mfma_f32_16x16x32_bf16 v[208:211], a[212:215], a[144:147], v[208:211]
v_mfma_f32_16x16x32_bf16 v[212:215], a[208:211], a[132:135], v[212:215]
v_mfma_f32_16x16x32_bf16 v[212:215], a[212:215], a[148:151], v[212:215]
v_mfma_f32_16x16x32_bf16 v[216:219], a[208:211], a[136:139], v[216:219]
v_mfma_f32_16x16x32_bf16 v[216:219], a[212:215], a[152:155], v[216:219]
v_mfma_f32_16x16x32_bf16 v[220:223], a[208:211], a[140:143], v[220:223]
ds_read_b128 a[208:211], v228 offset:28672
v_mfma_f32_16x16x32_bf16 v[220:223], a[212:215], a[156:159], v[220:223]
s_waitcnt lgkmcnt(9)
ds_read_b128 a[212:215], v228 offset:29696
v_mfma_f32_16x16x32_bf16 v[180:183], v[8:11], a[240:243], v[180:183]
ds_read_b128 v[8:11], v238 offset:256
v_mfma_f32_16x16x32_bf16 v[180:183], v[12:15], a[244:247], v[180:183]
s_waitcnt lgkmcnt(9)
ds_read_b128 v[12:15], v238 offset:320
v_mfma_f32_16x16x32_bf16 v[128:131], a[216:219], a[128:131], v[128:131]
v_mfma_f32_16x16x32_bf16 v[128:131], a[220:223], a[144:147], v[128:131]
v_mfma_f32_16x16x32_bf16 v[132:135], a[216:219], a[132:135], v[132:135]
v_mfma_f32_16x16x32_bf16 v[132:135], a[220:223], a[148:151], v[132:135]
v_mfma_f32_16x16x32_bf16 v[136:139], a[216:219], a[136:139], v[136:139]
v_mfma_f32_16x16x32_bf16 v[136:139], a[220:223], a[152:155], v[136:139]
v_mfma_f32_16x16x32_bf16 v[140:143], a[216:219], a[140:143], v[140:143]
ds_read_b128 a[216:219], v228 offset:30720
v_mfma_f32_16x16x32_bf16 v[140:143], a[220:223], a[156:159], v[140:143]
s_waitcnt lgkmcnt(9)
ds_read_b128 a[220:223], v228 offset:31744
v_mfma_f32_16x16x32_bf16 v[32:35], a[192:195], a[128:131], v[32:35]
v_mfma_f32_16x16x32_bf16 v[32:35], a[196:199], a[144:147], v[32:35]
v_mfma_f32_16x16x32_bf16 v[36:39], a[192:195], a[132:135], v[36:39]
v_mfma_f32_16x16x32_bf16 v[36:39], a[196:199], a[148:151], v[36:39]
v_mfma_f32_16x16x32_bf16 v[40:43], a[192:195], a[136:139], v[40:43]
v_mfma_f32_16x16x32_bf16 v[40:43], a[196:199], a[152:155], v[40:43]
v_mfma_f32_16x16x32_bf16 v[44:47], a[192:195], a[140:143], v[44:47]
v_mfma_f32_16x16x32_bf16 v[44:47], a[196:199], a[156:159], v[44:47]
s_waitcnt lgkmcnt(8)
v_mfma_f32_16x16x32_bf16 v[184:187], v[0:3], a[240:243], v[184:187]
s_waitcnt vmcnt(6) lgkmcnt(0)
s_barrier
ds_read_b128 a[192:195], v228 offset:32768
v_mfma_f32_16x16x32_bf16 v[184:187], v[4:7], a[244:247], v[184:187]
s_add_u32 m0, s34, 0
ds_read_b128 a[196:199], v228 offset:33792
v_mfma_f32_16x16x32_bf16 v[192:195], a[200:203], a[128:131], v[192:195]
s_add_u32 s52, s34, 319488
ds_read_b128 v[0:3], v236 offset:6144
v_mfma_f32_16x16x32_bf16 v[192:195], a[204:207], a[144:147], v[192:195]
ds_read_b128 v[4:7], v236 offset:7168
v_mfma_f32_16x16x32_bf16 v[196:199], a[200:203], a[132:135], v[196:199]
buffer_load_dwordx4 v228, s[20:23], s52 offen offset:0 sc1 lds
v_mfma_f32_16x16x32_bf16 v[196:199], a[204:207], a[148:151], v[196:199]
v_mfma_f32_16x16x32_bf16 v[200:203], a[200:203], a[136:139], v[200:203]
v_mfma_f32_16x16x32_bf16 v[200:203], a[204:207], a[152:155], v[200:203]
v_mfma_f32_16x16x32_bf16 v[204:207], a[200:203], a[140:143], v[204:207]
ds_read_b128 a[200:203], v228 offset:34816
v_mfma_f32_16x16x32_bf16 v[204:207], a[204:207], a[156:159], v[204:207]
ds_read_b128 a[204:207], v228 offset:35840
v_mfma_f32_16x16x32_bf16 v[96:99], a[208:211], a[128:131], v[96:99]
buffer_load_dwordx4 v228, s[20:23], s52 offen offset:1024 sc1 lds
v_mfma_f32_16x16x32_bf16 v[96:99], a[212:215], a[144:147], v[96:99]
v_mfma_f32_16x16x32_bf16 v[100:103], a[208:211], a[132:135], v[100:103]
v_mfma_f32_16x16x32_bf16 v[100:103], a[212:215], a[148:151], v[100:103]
v_mfma_f32_16x16x32_bf16 v[104:107], a[208:211], a[136:139], v[104:107]
buffer_load_dwordx4 v228, s[20:23], s52 offen offset:2048 sc1 lds
v_mfma_f32_16x16x32_bf16 v[104:107], a[212:215], a[152:155], v[104:107]
v_mfma_f32_16x16x32_bf16 v[108:111], a[208:211], a[140:143], v[108:111]
ds_read_b128 a[208:211], v228 offset:36864
v_mfma_f32_16x16x32_bf16 v[108:111], a[212:215], a[156:159], v[108:111]
ds_read_b128 a[212:215], v228 offset:37888
v_mfma_f32_16x16x32_bf16 v[188:191], v[8:11], a[240:243], v[188:191]
ds_read_b128 v[8:11], v236 offset:18432
v_mfma_f32_16x16x32_bf16 v[188:191], v[12:15], a[244:247], v[188:191]
ds_read_b128 v[12:15], v236 offset:19456
v_mfma_f32_16x16x32_bf16 v[160:163], a[216:219], a[128:131], v[160:163]
buffer_load_dwordx4 v228, s[20:23], s52 offen offset:3072 sc1 lds
v_mfma_f32_16x16x32_bf16 v[160:163], a[220:223], a[144:147], v[160:163]
s_add_u32 m0, s34, 4096
s_add_u32 s53, s34, 323584
v_mfma_f32_16x16x32_bf16 v[164:167], a[216:219], a[132:135], v[164:167]
v_mfma_f32_16x16x32_bf16 v[164:167], a[220:223], a[148:151], v[164:167]
v_mfma_f32_16x16x32_bf16 v[168:171], a[216:219], a[136:139], v[168:171]
buffer_load_dwordx4 v228, s[20:23], s53 offen offset:0 sc1 lds
v_mfma_f32_16x16x32_bf16 v[168:171], a[220:223], a[152:155], v[168:171]
v_mfma_f32_16x16x32_bf16 v[172:175], a[216:219], a[140:143], v[172:175]
ds_read_b128 a[216:219], v228 offset:38912
v_mfma_f32_16x16x32_bf16 v[172:175], a[220:223], a[156:159], v[172:175]
s_waitcnt lgkmcnt(9)
ds_read_b128 a[220:223], v228 offset:39936
v_mfma_f32_16x16x32_bf16 v[16:19], a[192:195], a[160:163], v[16:19]
buffer_load_dwordx4 v228, s[20:23], s53 offen offset:1024 sc1 lds
v_mfma_f32_16x16x32_bf16 v[16:19], a[196:199], a[176:179], v[16:19]
v_mfma_f32_16x16x32_bf16 v[20:23], a[192:195], a[164:167], v[20:23]
v_mfma_f32_16x16x32_bf16 v[20:23], a[196:199], a[180:183], v[20:23]
v_mfma_f32_16x16x32_bf16 v[24:27], a[192:195], a[168:171], v[24:27]
v_mfma_f32_16x16x32_bf16 v[24:27], a[196:199], a[184:187], v[24:27]
v_mfma_f32_16x16x32_bf16 v[28:31], a[192:195], a[172:175], v[28:31]
ds_read_b128 a[192:195], v228 offset:40960
v_mfma_f32_16x16x32_bf16 v[28:31], a[196:199], a[188:191], v[28:31]
s_waitcnt lgkmcnt(9)
ds_read_b128 a[196:199], v228 offset:41984
v_cvt_pk_bf16_f32 v16, v16, v17
v_mfma_f32_16x16x32_bf16 v[176:179], v[0:3], a[248:251], v[176:179]
ds_read_b128 v[0:3], v236 offset:30720
v_cvt_pk_bf16_f32 v20, v20, v21
v_mfma_f32_16x16x32_bf16 v[176:179], v[4:7], a[252:255], v[176:179]
s_waitcnt lgkmcnt(9)
ds_read_b128 v[4:7], v236 offset:31744
v_cvt_pk_bf16_f32 v17, v18, v19
v_mfma_f32_16x16x32_bf16 v[64:67], a[200:203], a[160:163], v[64:67]
v_cvt_pk_bf16_f32 v28, v28, v29
v_cvt_pk_bf16_f32 v24, v24, v25
v_mfma_f32_16x16x32_bf16 v[64:67], a[204:207], a[176:179], v[64:67]
v_cvt_pk_bf16_f32 v29, v30, v31
v_cvt_pk_bf16_f32 v21, v22, v23
v_mfma_f32_16x16x32_bf16 v[68:71], a[200:203], a[164:167], v[68:71]
s_cmp_ge_u32 s2, 176
s_cbranch_scc1 L_full
v_cvt_pk_bf16_f32 v25, v26, v27
ds_read_b64_tr_b16 a[12:13], v239 offset:0
v_mfma_f32_16x16x32_bf16 v[68:71], a[204:207], a[180:183], v[68:71]
ds_read_b64_tr_b16 a[14:15], v239 offset:12288
v_mfma_f32_16x16x32_bf16 v[72:75], a[200:203], a[168:171], v[72:75]
v_cvt_pk_bf16_f32 v18, v64, v65
v_cvt_pk_bf16_f32 v19, v66, v67
v_mfma_f32_16x16x32_bf16 v[72:75], a[204:207], a[184:187], v[72:75]
ds_read_b128 v[64:67], v236 offset:32768
v_mfma_f32_16x16x32_bf16 v[76:79], a[200:203], a[172:175], v[76:79]
ds_read_b128 a[200:203], v228 offset:43008
v_cvt_pk_bf16_f32 v22, v68, v69
v_mfma_f32_16x16x32_bf16 v[76:79], a[204:207], a[188:191], v[76:79]
s_waitcnt lgkmcnt(12)
ds_read_b128 a[204:207], v228 offset:44032
v_cvt_pk_bf16_f32 v23, v70, v71
v_mfma_f32_16x16x32_bf16 v[208:211], a[208:211], a[160:163], v[208:211]
v_cvt_pk_bf16_f32 v26, v72, v73
v_cvt_pk_bf16_f32 v27, v74, v75
v_mfma_f32_16x16x32_bf16 v[208:211], a[212:215], a[176:179], v[208:211]
ds_read_b128 v[68:71], v236 offset:33792
v_mfma_f32_16x16x32_bf16 v[212:215], a[208:211], a[164:167], v[212:215]
v_cvt_pk_bf16_f32 v30, v76, v77
v_cvt_pk_bf16_f32 v31, v78, v79
v_mfma_f32_16x16x32_bf16 v[212:215], a[212:215], a[180:183], v[212:215]
ds_read_b128 v[72:75], v238 offset:512
v_mfma_f32_16x16x32_bf16 v[216:219], a[208:211], a[168:171], v[216:219]
ds_read_b128 v[76:79], v238 offset:576
v_cvt_pk_bf16_f32 v208, v208, v209
v_mfma_f32_16x16x32_bf16 v[216:219], a[212:215], a[184:187], v[216:219]
v_cvt_pk_bf16_f32 v209, v210, v211
ds_read_b64_tr_b16 a[28:29], v239 offset:24576
v_mfma_f32_16x16x32_bf16 v[220:223], a[208:211], a[172:175], v[220:223]
ds_read_b128 a[208:211], v228 offset:45056
v_cvt_pk_bf16_f32 v212, v212, v213
v_mfma_f32_16x16x32_bf16 v[220:223], a[212:215], a[188:191], v[220:223]
s_waitcnt lgkmcnt(15)
ds_read_b128 a[212:215], v228 offset:46080
v_cvt_pk_bf16_f32 v213, v214, v215
v_mfma_f32_16x16x32_bf16 v[180:183], v[8:11], a[248:251], v[180:183]
ds_read_b128 v[8:11], v238 offset:384
v_cvt_pk_bf16_f32 v216, v216, v217
v_mfma_f32_16x16x32_bf16 v[180:183], v[12:15], a[252:255], v[180:183]
s_waitcnt lgkmcnt(15)
ds_read_b128 v[12:15], v238 offset:448
v_cvt_pk_bf16_f32 v217, v218, v219
v_mfma_f32_16x16x32_bf16 v[128:131], a[216:219], a[160:163], v[128:131]
v_cvt_pk_bf16_f32 v220, v220, v221
v_cvt_pk_bf16_f32 v221, v222, v223
v_mfma_f32_16x16x32_bf16 v[128:131], a[220:223], a[176:179], v[128:131]
ds_read_b64_tr_b16 a[30:31], v241 offset:0
v_mfma_f32_16x16x32_bf16 v[132:135], a[216:219], a[164:167], v[132:135]
ds_read_b64_tr_b16 a[44:45], v239 offset:8
v_mfma_f32_16x16x32_bf16 v[132:135], a[220:223], a[180:183], v[132:135]
ds_read_b64_tr_b16 a[46:47], v239 offset:12296
v_mfma_f32_16x16x32_bf16 v[136:139], a[216:219], a[168:171], v[136:139]
ds_read_b64_tr_b16 a[60:61], v239 offset:24584
v_mfma_f32_16x16x32_bf16 v[136:139], a[220:223], a[184:187], v[136:139]
v_cvt_pk_bf16_f32 v210, v128, v129
v_cvt_pk_bf16_f32 v211, v130, v131
v_mfma_f32_16x16x32_bf16 v[140:143], a[216:219], a[172:175], v[140:143]
ds_read_b128 a[216:219], v228 offset:47104
v_cvt_pk_bf16_f32 v214, v132, v133
v_mfma_f32_16x16x32_bf16 v[140:143], a[220:223], a[188:191], v[140:143]
s_waitcnt lgkmcnt(15)
ds_read_b128 a[220:223], v228 offset:48128
v_cvt_pk_bf16_f32 v215, v134, v135
v_mfma_f32_16x16x32_bf16 v[32:35], a[192:195], a[160:163], v[32:35]
v_cvt_pk_bf16_f32 v218, v136, v137
v_cvt_pk_bf16_f32 v219, v138, v139
v_mfma_f32_16x16x32_bf16 v[32:35], a[196:199], a[176:179], v[32:35]
ds_read_b64_tr_b16 a[62:63], v241 offset:8
v_mfma_f32_16x16x32_bf16 v[36:39], a[192:195], a[164:167], v[36:39]
v_cvt_pk_bf16_f32 v222, v140, v141
v_cvt_pk_bf16_f32 v223, v142, v143
v_mfma_f32_16x16x32_bf16 v[36:39], a[196:199], a[180:183], v[36:39]
ds_read_b64_tr_b16 a[76:77], v239 offset:1024
v_mfma_f32_16x16x32_bf16 v[40:43], a[192:195], a[168:171], v[40:43]
ds_read_b64_tr_b16 a[78:79], v239 offset:13312
v_cvt_pk_bf16_f32 v32, v32, v33
v_mfma_f32_16x16x32_bf16 v[40:43], a[196:199], a[184:187], v[40:43]
v_cvt_pk_bf16_f32 v33, v34, v35
ds_read_b64_tr_b16 a[92:93], v239 offset:25600
v_mfma_f32_16x16x32_bf16 v[44:47], a[192:195], a[172:175], v[44:47]
v_cvt_pk_bf16_f32 v36, v36, v37
v_cvt_pk_bf16_f32 v37, v38, v39
v_mfma_f32_16x16x32_bf16 v[44:47], a[196:199], a[188:191], v[44:47]
ds_read_b64_tr_b16 a[94:95], v241 offset:64
v_mfma_f32_16x16x32_bf16 v[184:187], v[0:3], a[248:251], v[184:187]
s_waitcnt vmcnt(6) lgkmcnt(5)
s_barrier
v_cvt_pk_bf16_f32 v40, v40, v41
v_mfma_f32_16x16x32_bf16 v[184:187], v[4:7], a[252:255], v[184:187]
s_add_u32 m0, s34, 24576
v_cvt_pk_bf16_f32 v41, v42, v43
ds_read_b128 a[192:195], v229 offset:0
v_mfma_f32_16x16x32_bf16 v[192:195], a[200:203], a[160:163], v[192:195]
s_add_u32 s54, s34, 344064
v_cvt_pk_bf16_f32 v44, v44, v45
v_cvt_pk_bf16_f32 v45, v46, v47
v_mfma_f32_16x16x32_bf16 v[192:195], a[204:207], a[176:179], v[192:195]
ds_read_b128 a[196:199], v229 offset:1024
v_mov_b32 v7, 0
v_mfma_f32_16x16x32_bf16 v[196:199], a[200:203], a[164:167], v[196:199]
ds_read_b64_tr_b16 a[108:109], v239 offset:1032
v_mfma_f32_16x16x32_bf16 v[196:199], a[204:207], a[180:183], v[196:199]
ds_read_b64_tr_b16 a[110:111], v239 offset:13320
v_mfma_f32_16x16x32_bf16 v[200:203], a[200:203], a[168:171], v[200:203]
ds_read_b64_tr_b16 a[124:125], v239 offset:25608
v_cvt_pk_bf16_f32 v34, v192, v193
v_mfma_f32_16x16x32_bf16 v[200:203], a[204:207], a[184:187], v[200:203]
v_cvt_pk_bf16_f32 v35, v194, v195
ds_read_b128 v[192:195], v236 offset:10240
v_mfma_f32_16x16x32_bf16 v[204:207], a[200:203], a[172:175], v[204:207]
v_cvt_pk_bf16_f32 v38, v196, v197
v_cvt_pk_bf16_f32 v39, v198, v199
v_mfma_f32_16x16x32_bf16 v[204:207], a[204:207], a[188:191], v[204:207]
ds_read_b128 v[196:199], v236 offset:11264
v_mfma_f32_16x16x32_bf16 v[96:99], a[208:211], a[160:163], v[96:99]
v_cvt_pk_bf16_f32 v42, v200, v201
v_cvt_pk_bf16_f32 v43, v202, v203
v_mfma_f32_16x16x32_bf16 v[96:99], a[212:215], a[176:179], v[96:99]
ds_read_b128 v[200:203], v236 offset:22528
v_mfma_f32_16x16x32_bf16 v[100:103], a[208:211], a[164:167], v[100:103]
ds_read_b128 a[200:203], v229 offset:2048
v_cvt_pk_bf16_f32 v46, v204, v205
v_mfma_f32_16x16x32_bf16 v[100:103], a[212:215], a[180:183], v[100:103]
v_cvt_pk_bf16_f32 v47, v206, v207
ds_read_b128 v[204:207], v236 offset:23552
v_mfma_f32_16x16x32_bf16 v[104:107], a[208:211], a[168:171], v[104:107]
v_cvt_pk_bf16_f32 v96, v96, v97
v_cvt_pk_bf16_f32 v97, v98, v99
v_mfma_f32_16x16x32_bf16 v[104:107], a[212:215], a[184:187], v[104:107]
ds_read_b128 a[204:207], v229 offset:3072
v_mfma_f32_16x16x32_bf16 v[108:111], a[208:211], a[172:175], v[108:111]
v_cvt_pk_bf16_f32 v100, v100, v101
v_cvt_pk_bf16_f32 v101, v102, v103
v_mfma_f32_16x16x32_bf16 v[108:111], a[212:215], a[188:191], v[108:111]
ds_read_b128 a[208:211], v229 offset:4096
v_mfma_f32_16x16x32_bf16 v[188:191], v[8:11], a[248:251], v[188:191]
ds_read_b128 a[212:215], v229 offset:5120
v_cvt_pk_bf16_f32 v104, v104, v105
v_mfma_f32_16x16x32_bf16 v[188:191], v[12:15], a[252:255], v[188:191]
v_cvt_pk_bf16_f32 v105, v106, v107
ds_read_b64_tr_b16 a[126:127], v241 offset:72
v_mfma_f32_16x16x32_bf16 v[160:163], a[216:219], a[160:163], v[160:163]
v_cvt_pk_bf16_f32 v108, v108, v109
v_cvt_pk_bf16_f32 v109, v110, v111
v_mfma_f32_16x16x32_bf16 v[160:163], a[220:223], a[176:179], v[160:163]
ds_read_b64_tr_b16 a[224:225], v239 offset:3072
v_mov_b32 v15, 0
v_mfma_f32_16x16x32_bf16 v[164:167], a[216:219], a[164:167], v[164:167]
ds_read_b64_tr_b16 a[226:227], v239 offset:15360
v_mfma_f32_16x16x32_bf16 v[164:167], a[220:223], a[180:183], v[164:167]
ds_read_b64_tr_b16 a[228:229], v239 offset:27648
v_mfma_f32_16x16x32_bf16 v[168:171], a[216:219], a[168:171], v[168:171]
ds_read_b64_tr_b16 a[230:231], v241 offset:192
v_cvt_pk_bf16_f32 v98, v160, v161
v_mfma_f32_16x16x32_bf16 v[168:171], a[220:223], a[184:187], v[168:171]
v_cvt_pk_bf16_f32 v99, v162, v163
ds_read_b128 v[160:163], v236 offset:8192
v_mfma_f32_16x16x32_bf16 v[172:175], a[216:219], a[172:175], v[172:175]
v_cvt_pk_bf16_f32 v102, v164, v165
v_cvt_pk_bf16_f32 v103, v166, v167
v_mfma_f32_16x16x32_bf16 v[172:175], a[220:223], a[188:191], v[172:175]
ds_read_b128 v[164:167], v236 offset:9216
v_mfma_f32_16x16x32_bf16 v[156:159], a[128:131], v[28:31], v[156:159]
v_cvt_pk_bf16_f32 v106, v168, v169
v_cvt_pk_bf16_f32 v107, v170, v171
v_mfma_f32_16x16x32_bf16 v[156:159], a[144:147], v[220:223], v[156:159]
ds_read_b128 v[168:171], v236 offset:20480
v_mfma_f32_16x16x32_bf16 v[60:63], a[132:135], v[28:31], v[60:63]
ds_read_b128 a[216:219], v229 offset:6144
v_cvt_pk_bf16_f32 v110, v172, v173
v_mfma_f32_16x16x32_bf16 v[60:63], a[148:151], v[220:223], v[60:63]
v_cvt_pk_bf16_f32 v111, v174, v175
ds_read_b128 v[172:175], v236 offset:21504
v_mfma_f32_16x16x32_bf16 v[92:95], a[136:139], v[28:31], v[92:95]
ds_read_b128 a[220:223], v229 offset:7168
v_mfma_f32_16x16x32_bf16 v[92:95], a[152:155], v[220:223], v[92:95]
s_waitcnt lgkmcnt(4)
ds_read_b64_tr_b16 a[232:233], v239 offset:3080
v_mfma_f32_16x16x32_bf16 v[176:179], v[160:163], v[28:31], v[176:179]
ds_read_b128 v[160:163], v236 offset:34816
v_mfma_f32_16x16x32_bf16 v[176:179], v[164:167], v[220:223], v[176:179]
s_waitcnt lgkmcnt(3)
ds_read_b128 v[164:167], v236 offset:35840
v_mfma_f32_16x16x32_bf16 v[180:183], v[168:171], v[28:31], v[180:183]
ds_read_b128 v[168:171], v238 offset:640
v_mfma_f32_16x16x32_bf16 v[180:183], v[172:175], v[220:223], v[180:183]
ds_read_b128 v[172:175], v238 offset:704
v_mfma_f32_16x16x32_bf16 v[184:187], v[64:67], v[28:31], v[184:187]
ds_read_b64_tr_b16 a[234:235], v239 offset:15368
v_mfma_f32_16x16x32_bf16 v[184:187], v[68:71], v[220:223], v[184:187]
ds_read_b64_tr_b16 a[236:237], v239 offset:27656
v_mov_b32 v71, 0
v_mfma_f32_16x16x32_bf16 v[188:191], v[72:75], v[28:31], v[188:191]
ds_read_b64_tr_b16 a[238:239], v241 offset:200
v_mfma_f32_16x16x32_bf16 v[188:191], v[76:79], v[220:223], v[188:191]
ds_read_b64_tr_b16 a[240:241], v239 offset:4096
v_mov_b32 v79, v245
v_mfma_f32_16x16x32_bf16 v[156:159], a[160:163], v[44:47], v[156:159]
ds_read_b64_tr_b16 a[242:243], v239 offset:16384
v_mfma_f32_16x16x32_bf16 v[156:159], a[176:179], v[108:111], v[156:159]
ds_read_b64_tr_b16 a[244:245], v239 offset:28672
v_mfma_f32_16x16x32_bf16 v[60:63], a[164:167], v[44:47], v[60:63]
ds_read_b64_tr_b16 a[246:247], v241 offset:256
v_mfma_f32_16x16x32_bf16 v[60:63], a[180:183], v[108:111], v[60:63]
ds_read_b64_tr_b16 a[248:249], v239 offset:4104
v_mfma_f32_16x16x32_bf16 v[92:95], a[168:171], v[44:47], v[92:95]
ds_read_b64_tr_b16 a[250:251], v239 offset:16392
v_mfma_f32_16x16x32_bf16 v[92:95], a[184:187], v[108:111], v[92:95]
ds_read_b64_tr_b16 a[252:253], v239 offset:28680
v_mfma_f32_16x16x32_bf16 v[176:179], v[192:195], v[44:47], v[176:179]
ds_read_b64_tr_b16 a[254:255], v241 offset:264
v_mfma_f32_16x16x32_bf16 v[176:179], v[196:199], v[108:111], v[176:179]
v_mov_b32 v199, 0
v_mfma_f32_16x16x32_bf16 v[180:183], v[200:203], v[44:47], v[180:183]
v_mfma_f32_16x16x32_bf16 v[180:183], v[204:207], v[108:111], v[180:183]
s_waitcnt lgkmcnt(13)
v_mfma_f32_16x16x32_bf16 v[184:187], v[160:163], v[44:47], v[184:187]
v_mfma_f32_16x16x32_bf16 v[184:187], v[164:167], v[108:111], v[184:187]
s_waitcnt lgkmcnt(11)
v_mfma_f32_16x16x32_bf16 v[188:191], v[168:171], v[44:47], v[188:191]
v_mfma_f32_16x16x32_bf16 v[188:191], v[172:175], v[108:111], v[188:191]
v_mfma_f32_16x16x32_bf16 v[144:147], a[128:131], v[16:19], v[144:147]
v_cndmask_b32 v156, v176, v156, s[36:37]
v_cndmask_b32 v157, v177, v157, s[36:37]
v_mfma_f32_16x16x32_bf16 v[144:147], a[144:147], v[208:211], v[144:147]
v_cndmask_b32 v158, v178, v158, s[36:37]
v_cndmask_b32 v159, v179, v159, s[36:37]
v_mfma_f32_16x16x32_bf16 v[148:151], a[128:131], v[20:23], v[148:151]
v_cndmask_b32 v60, v180, v60, s[36:37]
v_cndmask_b32 v124, v188, v189, s[36:37]
v_mfma_f32_16x16x32_bf16 v[148:151], a[144:147], v[212:215], v[148:151]
v_cndmask_b32 v61, v181, v61, s[36:37]
v_cndmask_b32 v62, v182, v62, s[36:37]
v_mfma_f32_16x16x32_bf16 v[152:155], a[128:131], v[24:27], v[152:155]
v_cndmask_b32 v63, v183, v63, s[36:37]
v_cndmask_b32 v92, v184, v92, s[36:37]
v_mfma_f32_16x16x32_bf16 v[152:155], a[144:147], v[216:219], v[152:155]
v_cndmask_b32 v93, v185, v93, s[36:37]
v_cndmask_b32 v94, v186, v94, s[36:37]
v_mfma_f32_16x16x32_bf16 v[48:51], a[132:135], v[16:19], v[48:51]
v_cndmask_b32 v95, v187, v95, s[36:37]
v_cndmask_b32 v248, v243, v124, s[38:39]
v_mfma_f32_16x16x32_bf16 v[48:51], a[148:151], v[208:211], v[48:51]
v_max3_f32 v249, v156, v157, v158
v_max3_f32 v251, v159, v60, v61
v_mfma_f32_16x16x32_bf16 v[52:55], a[132:135], v[20:23], v[52:55]
v_max3_f32 v252, v62, v63, v92
v_max3_f32 v253, v93, v94, v95
v_mfma_f32_16x16x32_bf16 v[52:55], a[148:151], v[212:215], v[52:55]
v_max3_f32 v249, v249, v251, v248
v_max3_f32 v249, v249, v252, v253
v_mfma_f32_16x16x32_bf16 v[56:59], a[132:135], v[24:27], v[56:59]
v_mov_b32 v250, v249
v_mfma_f32_16x16x32_bf16 v[56:59], a[148:151], v[216:219], v[56:59]
s_nop 0
v_permlane32_swap_b32 v250, v249
v_mfma_f32_16x16x32_bf16 v[80:83], a[136:139], v[16:19], v[80:83]
v_max_f32 v249, v250, v249
v_mov_b32 v250, v249
v_mfma_f32_16x16x32_bf16 v[80:83], a[152:155], v[208:211], v[80:83]
s_nop 0
v_permlane16_swap_b32 v250, v249
v_mfma_f32_16x16x32_bf16 v[84:87], a[136:139], v[20:23], v[84:87]
v_max_f32 v249, v250, v249
v_mul_f32 v254, s35, v249
v_mfma_f32_16x16x32_bf16 v[84:87], a[152:155], v[212:215], v[84:87]
v_fma_f32 v156, v156, s35, -v254
v_fma_f32 v157, v157, s35, -v254
v_mfma_f32_16x16x32_bf16 v[88:91], a[136:139], v[24:27], v[88:91]
v_fma_f32 v158, v158, s35, -v254
v_fma_f32 v159, v159, s35, -v254
v_mfma_f32_16x16x32_bf16 v[88:91], a[152:155], v[216:219], v[88:91]
v_fma_f32 v60, v60, s35, -v254
v_fma_f32 v61, v61, s35, -v254
v_mfma_f32_16x16x32_bf16 v[112:115], a[140:143], v[16:19], v[112:115]
v_fma_f32 v62, v62, s35, -v254
v_fma_f32 v63, v63, s35, -v254
v_mfma_f32_16x16x32_bf16 v[112:115], a[156:159], v[208:211], v[112:115]
v_exp_f32 v156, v156
v_mfma_f32_16x16x32_bf16 v[116:119], a[140:143], v[20:23], v[116:119]
v_exp_f32 v157, v157
v_mfma_f32_16x16x32_bf16 v[116:119], a[156:159], v[212:215], v[116:119]
v_fma_f32 v92, v92, s35, -v254
v_fma_f32 v93, v93, s35, -v254
v_mfma_f32_16x16x32_bf16 v[120:123], a[140:143], v[24:27], v[120:123]
v_exp_f32 v158, v158
v_mfma_f32_16x16x32_bf16 v[120:123], a[156:159], v[216:219], v[120:123]
v_exp_f32 v159, v159
v_mfma_f32_16x16x32_bf16 v[144:147], a[160:163], v[32:35], v[144:147]
v_exp_f32 v60, v60
v_mfma_f32_16x16x32_bf16 v[144:147], a[176:179], v[96:99], v[144:147]
v_exp_f32 v61, v61
v_mfma_f32_16x16x32_bf16 v[148:151], a[160:163], v[36:39], v[148:151]
v_fma_f32 v94, v94, s35, -v254
v_fma_f32 v95, v95, s35, -v254
v_mfma_f32_16x16x32_bf16 v[148:151], a[176:179], v[100:103], v[148:151]
v_exp_f32 v62, v62
v_mfma_f32_16x16x32_bf16 v[152:155], a[160:163], v[40:43], v[152:155]
v_exp_f32 v63, v63
v_mfma_f32_16x16x32_bf16 v[152:155], a[176:179], v[104:107], v[152:155]
v_exp_f32 v92, v92
v_mfma_f32_16x16x32_bf16 v[48:51], a[164:167], v[32:35], v[48:51]
v_fma_f32 v248, v248, s35, -v254
v_add_f32 v249, v156, v157
v_mfma_f32_16x16x32_bf16 v[48:51], a[180:183], v[96:99], v[48:51]
v_exp_f32 v93, v93
v_mfma_f32_16x16x32_bf16 v[52:55], a[164:167], v[36:39], v[52:55]
v_exp_f32 v94, v94
v_mfma_f32_16x16x32_bf16 v[52:55], a[180:183], v[100:103], v[52:55]
v_add_f32 v251, v158, v159
v_add_f32 v252, v60, v61
v_mfma_f32_16x16x32_bf16 v[56:59], a[164:167], v[40:43], v[56:59]
v_exp_f32 v95, v95
v_mfma_f32_16x16x32_bf16 v[56:59], a[180:183], v[104:107], v[56:59]
v_exp_f32 v248, v248
v_mfma_f32_16x16x32_bf16 v[80:83], a[168:171], v[32:35], v[80:83]
v_add_f32 v253, v62, v63
v_add_f32 v249, v249, v92
v_mfma_f32_16x16x32_bf16 v[80:83], a[184:187], v[96:99], v[80:83]
v_add_f32 v251, v251, v93
v_add_f32 v252, v252, v94
v_mfma_f32_16x16x32_bf16 v[84:87], a[168:171], v[36:39], v[84:87]
v_add_f32 v253, v253, v95
v_add_f32 v249, v249, v248
v_mfma_f32_16x16x32_bf16 v[84:87], a[184:187], v[100:103], v[84:87]
v_add_f32 v251, v251, v252
v_add_f32 v249, v249, v253
v_mfma_f32_16x16x32_bf16 v[88:91], a[168:171], v[40:43], v[88:91]
v_add_f32 v249, v249, v251
v_mov_b32 v250, v249
v_mfma_f32_16x16x32_bf16 v[88:91], a[184:187], v[104:107], v[88:91]
s_nop 0
v_permlane32_swap_b32 v250, v249
v_mfma_f32_16x16x32_bf16 v[112:115], a[172:175], v[32:35], v[112:115]
v_add_f32 v249, v250, v249
v_mov_b32 v250, v249
v_mfma_f32_16x16x32_bf16 v[112:115], a[188:191], v[96:99], v[112:115]
s_nop 0
v_permlane16_swap_b32 v250, v249
v_mfma_f32_16x16x32_bf16 v[116:119], a[172:175], v[36:39], v[116:119]
v_add_f32 v249, v250, v249
ds_read_b64_tr_b16 a[140:141], v239 offset:2048
v_mfma_f32_16x16x32_bf16 v[116:119], a[188:191], v[100:103], v[116:119]
v_rcp_f32 v254, v249
v_mfma_f32_16x16x32_bf16 v[120:123], a[172:175], v[40:43], v[120:123]
v_mul_f32 v156, v156, v254
v_mul_f32 v157, v157, v254
v_mfma_f32_16x16x32_bf16 v[120:123], a[188:191], v[104:107], v[120:123]
v_mul_f32 v158, v158, v254
v_mul_f32 v159, v159, v254
v_mfma_f32_16x16x32_bf16 v[96:99], a[0:3], a[192:195], 0
v_mul_f32 v60, v60, v254
v_mul_f32 v61, v61, v254
v_mfma_f32_16x16x32_bf16 v[96:99], a[16:19], a[196:199], v[96:99]
v_mul_f32 v62, v62, v254
v_mul_f32 v63, v63, v254
v_mfma_f32_16x16x32_bf16 v[100:103], a[4:7], a[192:195], 0
v_mul_f32 v92, v92, v254
ds_read_b64_tr_b16 a[142:143], v239 offset:14336
v_mul_f32 v93, v93, v254
v_mfma_f32_16x16x32_bf16 v[100:103], a[20:23], a[196:199], v[100:103]
ds_read_b64_tr_b16 a[156:157], v239 offset:26624
v_mul_f32 v94, v94, v254
v_mfma_f32_16x16x32_bf16 v[104:107], a[8:11], a[192:195], 0
ds_read_b128 a[192:195], v229 offset:8192
ds_read_b64_tr_b16 a[158:159], v241 offset:128
v_mul_f32 v95, v95, v254
v_mfma_f32_16x16x32_bf16 v[104:107], a[24:27], a[196:199], v[104:107]
ds_read_b128 a[196:199], v229 offset:9216
v_mul_f32 v248, v248, v254
v_mfma_f32_16x16x32_bf16 v[96:99], a[32:35], a[200:203], v[96:99]
ds_read_b64_tr_b16 a[172:173], v239 offset:2056
v_cvt_pk_bf16_f32 v200, v156, v157
v_mfma_f32_16x16x32_bf16 v[96:99], a[48:51], a[204:207], v[96:99]
ds_read_b64_tr_b16 a[174:175], v239 offset:14344
ds_read_b64_tr_b16 a[188:189], v239 offset:26632
v_cvt_pk_bf16_f32 v201, v158, v159
v_mfma_f32_16x16x32_bf16 v[100:103], a[36:39], a[200:203], v[100:103]
ds_read_b64_tr_b16 a[190:191], v241 offset:136
v_cvt_pk_bf16_f32 v202, v60, v61
v_mfma_f32_16x16x32_bf16 v[100:103], a[52:55], a[204:207], v[100:103]
v_cvt_pk_bf16_f32 v203, v62, v63
v_cvt_pk_bf16_f32 v204, v92, v93
v_cvt_pk_bf16_f32 v205, v94, v95
v_mfma_f32_16x16x32_bf16 v[104:107], a[40:43], a[200:203], v[104:107]
ds_read_b128 a[200:203], v229 offset:10240
v_cvt_pk_bf16_f32 v206, v248, 0
v_mfma_f32_16x16x32_bf16 v[104:107], a[56:59], a[204:207], v[104:107]
ds_read_b128 a[204:207], v229 offset:11264
v_cndmask_b32 v192, 0, v200, s[40:41]
v_mfma_f32_16x16x32_bf16 v[96:99], a[64:67], a[208:211], v[96:99]
v_cndmask_b32 v193, 0, v201, s[40:41]
v_cndmask_b32 v194, 0, v202, s[40:41]
v_cndmask_b32 v195, 0, v203, s[40:41]
v_mfma_f32_16x16x32_bf16 v[96:99], a[80:83], a[212:215], v[96:99]
v_cndmask_b32 v196, 0, v204, s[40:41]
v_cndmask_b32 v197, 0, v205, s[40:41]
v_mfma_f32_16x16x32_bf16 v[100:103], a[68:71], a[208:211], v[100:103]
v_cndmask_b32 v198, v246, v206, s[40:41]
v_cndmask_b32 v128, v243, v112, s[38:39]
v_max3_f32 v132, v144, v145, v146
v_mfma_f32_16x16x32_bf16 v[100:103], a[84:87], a[212:215], v[100:103]
v_max3_f32 v136, v147, v48, v49
v_max3_f32 v137, v50, v51, v80
v_mfma_f32_16x16x32_bf16 v[104:107], a[72:75], a[208:211], v[104:107]
ds_read_b128 a[208:211], v229 offset:12288
v_max3_f32 v142, v81, v82, v83
v_mfma_f32_16x16x32_bf16 v[104:107], a[88:91], a[212:215], v[104:107]
ds_read_b128 a[212:215], v229 offset:13312
v_max3_f32 v132, v132, v136, v128
v_cndmask_b32 v129, v243, v116, s[38:39]
v_mfma_f32_16x16x32_bf16 v[96:99], a[96:99], a[216:219], v[96:99]
v_max3_f32 v133, v148, v149, v150
v_max3_f32 v138, v151, v52, v53
v_mfma_f32_16x16x32_bf16 v[96:99], a[112:115], a[220:223], v[96:99]
v_max3_f32 v132, v132, v137, v142
v_cndmask_b32 v130, v243, v120, s[38:39]
v_max3_f32 v134, v152, v153, v154
v_mfma_f32_16x16x32_bf16 v[100:103], a[100:103], a[216:219], v[100:103]
v_max3_f32 v140, v155, v56, v57
v_max3_f32 v139, v54, v55, v84
v_mfma_f32_16x16x32_bf16 v[100:103], a[116:119], a[220:223], v[100:103]
v_max3_f32 v143, v85, v86, v87
v_max3_f32 v133, v133, v138, v129
v_mfma_f32_16x16x32_bf16 v[104:107], a[104:107], a[216:219], v[104:107]
ds_read_b128 a[216:219], v229 offset:14336
v_max3_f32 v141, v58, v59, v88
v_max3_f32 v142, v89, v90, v91
v_mfma_f32_16x16x32_bf16 v[104:107], a[120:123], a[220:223], v[104:107]
s_waitcnt lgkmcnt(9)
ds_read_b128 a[220:223], v229 offset:15360
v_max3_f32 v134, v134, v140, v130
v_mfma_f32_16x16x32_bf16 v[96:99], a[128:131], a[192:195], v[96:99]
v_max3_f32 v133, v133, v139, v143
v_max3_f32 v134, v134, v141, v142
v_mov_b32 v135, v134
v_mfma_f32_16x16x32_bf16 v[96:99], a[144:147], a[196:199], v[96:99]
v_permlane32_swap_b32 v132, v133
v_mfma_f32_16x16x32_bf16 v[100:103], a[132:135], a[192:195], v[100:103]
v_permlane32_swap_b32 v135, v134
v_mfma_f32_16x16x32_bf16 v[100:103], a[148:151], a[196:199], v[100:103]
v_max_f32 v132, v132, v133
v_max_f32 v134, v135, v134
v_cndmask_b32 v72, 0, v200, s[36:37]
v_mfma_f32_16x16x32_bf16 v[104:107], a[136:139], a[192:195], v[104:107]
ds_read_b128 a[192:195], v229 offset:16384
v_cndmask_b32 v73, 0, v201, s[36:37]
v_mfma_f32_16x16x32_bf16 v[104:107], a[152:155], a[196:199], v[104:107]
s_waitcnt lgkmcnt(5)
ds_read_b128 a[196:199], v229 offset:17408
v_permlane16_swap_b32 v132, v134
v_mfma_f32_16x16x32_bf16 v[96:99], a[160:163], a[200:203], v[96:99]
v_max_f32 v134, v132, v134
v_mul_f32 v134, s35, v134
v_mfma_f32_16x16x32_bf16 v[96:99], a[176:179], a[204:207], v[96:99]
buffer_load_dwordx4 v228, s[20:23], s54 offen offset:0 sc1 lds
v_mfma_f32_16x16x32_bf16 v[100:103], a[164:167], a[200:203], v[100:103]
v_mov_b32 v133, v134
s_nop 1
v_permlane16_swap_b32 v133, v134
v_mfma_f32_16x16x32_bf16 v[100:103], a[180:183], a[204:207], v[100:103]
v_mov_b32 v132, v133
v_fma_f32 v152, v152, s35, -v134
v_mfma_f32_16x16x32_bf16 v[104:107], a[168:171], a[200:203], v[104:107]
ds_read_b128 a[200:203], v229 offset:18432
v_permlane32_swap_b32 v132, v133
v_mfma_f32_16x16x32_bf16 v[104:107], a[184:187], a[204:207], v[104:107]
ds_read_b128 a[204:207], v229 offset:19456
v_cvt_pk_bf16_f32 v112, v96, v97
v_mfma_f32_16x16x32_bf16 v[176:179], a[12:15], v[192:195], 0
ds_read_b64_tr_b16 a[12:13], v239 offset:5120
v_cvt_pk_bf16_f32 v113, v98, v99
v_mfma_f32_16x16x32_bf16 v[176:179], a[28:31], v[196:199], v[176:179]
ds_read_b64_tr_b16 a[14:15], v239 offset:17408
ds_read_b64_tr_b16 a[28:29], v239 offset:29696
v_cvt_pk_bf16_f32 v114, v100, v101
v_mfma_f32_16x16x32_bf16 v[180:183], a[44:47], v[192:195], 0
ds_read_b64_tr_b16 a[30:31], v241 offset:320
v_cvt_pk_bf16_f32 v115, v102, v103
v_mfma_f32_16x16x32_bf16 v[180:183], a[60:63], v[196:199], v[180:183]
s_waitcnt lgkmcnt(10)
ds_read_b64_tr_b16 a[44:45], v239 offset:5128
ds_read_b64_tr_b16 a[46:47], v239 offset:17416
v_cvt_pk_bf16_f32 v16, v176, v177
v_mfma_f32_16x16x32_bf16 v[160:163], a[0:3], a[208:211], 0
v_cvt_pk_bf16_f32 v17, v178, v179
ds_read_b64_tr_b16 a[60:61], v239 offset:29704
v_mfma_f32_16x16x32_bf16 v[160:163], a[16:19], a[212:215], v[160:163]
ds_read_b64_tr_b16 a[62:63], v241 offset:328
v_cvt_pk_bf16_f32 v116, v104, v105
v_mfma_f32_16x16x32_bf16 v[164:167], a[4:7], a[208:211], 0
v_cvt_pk_bf16_f32 v18, v180, v181
v_cvt_pk_bf16_f32 v19, v182, v183
v_cvt_pk_bf16_f32 v117, v106, v107
v_mfma_f32_16x16x32_bf16 v[164:167], a[20:23], a[212:215], v[164:167]
buffer_load_dwordx4 v228, s[20:23], s54 offen offset:1024 sc1 lds
v_mfma_f32_16x16x32_bf16 v[168:171], a[8:11], a[208:211], 0
ds_read_b128 a[208:211], v229 offset:20480
v_fma_f32 v144, v144, s35, -v132
v_fma_f32 v145, v145, s35, -v132
v_mfma_f32_16x16x32_bf16 v[168:171], a[24:27], a[212:215], v[168:171]
ds_read_b128 a[212:215], v229 offset:21504
v_fma_f32 v146, v146, s35, -v132
v_mfma_f32_16x16x32_bf16 v[184:187], a[76:79], v[192:195], 0
ds_read_b64_tr_b16 a[76:77], v239 offset:6144
v_fma_f32 v147, v147, s35, -v132
v_mfma_f32_16x16x32_bf16 v[184:187], a[92:95], v[196:199], v[184:187]
ds_read_b64_tr_b16 a[78:79], v239 offset:18432
ds_read_b64_tr_b16 a[92:93], v239 offset:30720
v_fma_f32 v48, v48, s35, -v132
v_mfma_f32_16x16x32_bf16 v[188:191], a[108:111], v[192:195], 0
ds_read_b64_tr_b16 a[94:95], v241 offset:384
v_fma_f32 v49, v49, s35, -v132
v_mfma_f32_16x16x32_bf16 v[188:191], a[124:127], v[196:199], v[188:191]
s_waitcnt lgkmcnt(15)
ds_read_b64_tr_b16 a[108:109], v239 offset:6152
ds_read_b64_tr_b16 a[110:111], v239 offset:18440
v_cvt_pk_bf16_f32 v20, v184, v185
v_mfma_f32_16x16x32_bf16 v[160:163], a[32:35], a[216:219], v[160:163]
ds_read_b64_tr_b16 a[124:125], v239 offset:30728
v_cvt_pk_bf16_f32 v21, v186, v187
v_mfma_f32_16x16x32_bf16 v[160:163], a[48:51], a[220:223], v[160:163]
ds_read_b64_tr_b16 a[126:127], v241 offset:392
v_fma_f32 v148, v148, s35, -v133
v_mfma_f32_16x16x32_bf16 v[164:167], a[36:39], a[216:219], v[164:167]
v_cvt_pk_bf16_f32 v22, v188, v189
v_cvt_pk_bf16_f32 v23, v190, v191
v_fma_f32 v149, v149, s35, -v133
v_mfma_f32_16x16x32_bf16 v[164:167], a[52:55], a[220:223], v[164:167]
buffer_load_dwordx4 v228, s[20:23], s54 offen offset:2048 sc1 lds
v_mfma_f32_16x16x32_bf16 v[168:171], a[40:43], a[216:219], v[168:171]
ds_read_b128 a[216:219], v229 offset:22528
v_fma_f32 v150, v150, s35, -v133
v_fma_f32 v151, v151, s35, -v133
v_mfma_f32_16x16x32_bf16 v[168:171], a[56:59], a[220:223], v[168:171]
ds_read_b128 a[220:223], v229 offset:23552
v_fma_f32 v52, v52, s35, -v133
v_mfma_f32_16x16x32_bf16 v[176:179], a[140:143], v[192:195], 0
ds_read_b64_tr_b16 a[140:141], v239 offset:7168
v_fma_f32 v53, v53, s35, -v133
v_mfma_f32_16x16x32_bf16 v[176:179], a[156:159], v[196:199], v[176:179]
ds_read_b64_tr_b16 a[142:143], v239 offset:19456
ds_read_b64_tr_b16 a[156:157], v239 offset:31744
v_fma_f32 v153, v153, s35, -v134
v_mfma_f32_16x16x32_bf16 v[180:183], a[172:175], v[192:195], 0
ds_read_b64_tr_b16 a[158:159], v241 offset:448
v_fma_f32 v50, v50, s35, -v132
v_mfma_f32_16x16x32_bf16 v[180:183], a[188:191], v[196:199], v[180:183]
ds_read_b64_tr_b16 a[172:173], v239 offset:7176
ds_read_b64_tr_b16 a[174:175], v239 offset:19464
v_cvt_pk_bf16_f32 v24, v176, v177
v_mfma_f32_16x16x32_bf16 v[160:163], a[64:67], a[192:195], v[160:163]
s_waitcnt vmcnt(3)
s_barrier
ds_read_b64_tr_b16 a[188:189], v239 offset:31752
v_mfma_f32_16x16x32_bf16 v[160:163], a[80:83], a[196:199], v[160:163]
ds_read_b64_tr_b16 a[190:191], v241 offset:456
v_cvt_pk_bf16_f32 v25, v178, v179
v_mfma_f32_16x16x32_bf16 v[164:167], a[68:71], a[192:195], v[164:167]
v_cvt_pk_bf16_f32 v26, v180, v181
v_cvt_pk_bf16_f32 v27, v182, v183
v_fma_f32 v51, v51, s35, -v132
v_mfma_f32_16x16x32_bf16 v[164:167], a[84:87], a[196:199], v[164:167]
buffer_load_dwordx4 v228, s[20:23], s54 offen offset:3072 sc1 lds
v_mfma_f32_16x16x32_bf16 v[168:171], a[72:75], a[192:195], v[168:171]
s_add_u32 m0, s34, 28672
ds_read_b128 a[192:195], v228 offset:0
v_fma_f32 v80, v80, s35, -v132
v_fma_f32 v81, v81, s35, -v132
v_mfma_f32_16x16x32_bf16 v[168:171], a[88:91], a[196:199], v[168:171]
s_add_u32 s55, s34, 348160
ds_read_b128 a[196:199], v228 offset:1024
v_fma_f32 v82, v82, s35, -v132
v_mfma_f32_16x16x32_bf16 v[184:187], a[224:227], v[192:195], 0
ds_read_b64_tr_b16 a[224:225], v239 offset:8192
v_fma_f32 v83, v83, s35, -v132
v_mfma_f32_16x16x32_bf16 v[184:187], a[228:231], v[196:199], v[184:187]
ds_read_b64_tr_b16 a[226:227], v239 offset:20480
ds_read_b64_tr_b16 a[228:229], v239 offset:32768
v_fma_f32 v128, v128, s35, -v132
v_mfma_f32_16x16x32_bf16 v[188:191], a[232:235], v[192:195], 0
ds_read_b64_tr_b16 a[230:231], v241 offset:512
v_fma_f32 v154, v154, s35, -v134
v_mfma_f32_16x16x32_bf16 v[188:191], a[236:239], v[196:199], v[188:191]
s_waitcnt lgkmcnt(15)
ds_read_b64_tr_b16 a[232:233], v239 offset:8200
ds_read_b64_tr_b16 a[234:235], v239 offset:20488
v_cvt_pk_bf16_f32 v28, v184, v185
v_mfma_f32_16x16x32_bf16 v[160:163], a[96:99], a[200:203], v[160:163]
ds_read_b64_tr_b16 a[236:237], v239 offset:32776
v_cvt_pk_bf16_f32 v29, v186, v187
v_mfma_f32_16x16x32_bf16 v[160:163], a[112:115], a[204:207], v[160:163]
ds_read_b64_tr_b16 a[238:239], v241 offset:520
v_fma_f32 v155, v155, s35, -v134
v_mfma_f32_16x16x32_bf16 v[164:167], a[100:103], a[200:203], v[164:167]
v_cvt_pk_bf16_f32 v30, v188, v189
v_cvt_pk_bf16_f32 v31, v190, v191
v_fma_f32 v56, v56, s35, -v134
v_mfma_f32_16x16x32_bf16 v[164:167], a[116:119], a[204:207], v[164:167]
buffer_load_dwordx4 v228, s[20:23], s55 offen offset:0 sc1 lds
v_mfma_f32_16x16x32_bf16 v[168:171], a[104:107], a[200:203], v[168:171]
ds_read_b128 a[200:203], v228 offset:2048
v_fma_f32 v57, v57, s35, -v134
v_fma_f32 v54, v54, s35, -v133
v_mfma_f32_16x16x32_bf16 v[168:171], a[120:123], a[204:207], v[168:171]
ds_read_b128 a[204:207], v228 offset:3072
v_fma_f32 v55, v55, s35, -v133
v_mfma_f32_16x16x32_bf16 v[176:179], a[240:243], v[192:195], 0
ds_read_b64_tr_b16 a[240:241], v239 offset:9216
v_fma_f32 v84, v84, s35, -v133
v_mfma_f32_16x16x32_bf16 v[176:179], a[244:247], v[196:199], v[176:179]
ds_read_b64_tr_b16 a[242:243], v239 offset:21504
ds_read_b64_tr_b16 a[244:245], v239 offset:33792
v_fma_f32 v85, v85, s35, -v133
v_mfma_f32_16x16x32_bf16 v[180:183], a[248:251], v[192:195], 0
ds_read_b64_tr_b16 a[246:247], v241 offset:576
v_fma_f32 v86, v86, s35, -v133
v_mfma_f32_16x16x32_bf16 v[180:183], a[252:255], v[196:199], v[180:183]
ds_read_b64_tr_b16 a[248:249], v239 offset:9224
ds_read_b64_tr_b16 a[250:251], v239 offset:21512
v_cvt_pk_bf16_f32 v208, v176, v177
v_mfma_f32_16x16x32_bf16 v[160:163], a[128:131], a[208:211], v[160:163]
ds_read_b64_tr_b16 a[252:253], v239 offset:33800
v_cvt_pk_bf16_f32 v209, v178, v179
v_mfma_f32_16x16x32_bf16 v[160:163], a[144:147], a[212:215], v[160:163]
ds_read_b64_tr_b16 a[254:255], v241 offset:584
v_fma_f32 v87, v87, s35, -v133
v_mfma_f32_16x16x32_bf16 v[164:167], a[132:135], a[208:211], v[164:167]
v_cvt_pk_bf16_f32 v210, v180, v181
v_cvt_pk_bf16_f32 v211, v182, v183
v_fma_f32 v129, v129, s35, -v133
v_mfma_f32_16x16x32_bf16 v[164:167], a[148:151], a[212:215], v[164:167]
buffer_load_dwordx4 v228, s[20:23], s55 offen offset:1024 sc1 lds
v_mfma_f32_16x16x32_bf16 v[168:171], a[136:139], a[208:211], v[168:171]
ds_read_b128 a[208:211], v228 offset:4096
v_fma_f32 v58, v58, s35, -v134
v_fma_f32 v59, v59, s35, -v134
v_mfma_f32_16x16x32_bf16 v[168:171], a[152:155], a[212:215], v[168:171]
ds_read_b128 a[212:215], v228 offset:5120
v_fma_f32 v88, v88, s35, -v134
v_mfma_f32_16x16x32_bf16 v[184:187], a[12:15], v[192:195], 0
ds_read_b64_tr_b16 a[12:13], v239 offset:10240
v_fma_f32 v89, v89, s35, -v134
v_mfma_f32_16x16x32_bf16 v[184:187], a[28:31], v[196:199], v[184:187]
ds_read_b64_tr_b16 a[14:15], v239 offset:22528
ds_read_b64_tr_b16 a[28:29], v239 offset:34816
v_fma_f32 v90, v90, s35, -v134
v_mfma_f32_16x16x32_bf16 v[188:191], a[44:47], v[192:195], 0
ds_read_b64_tr_b16 a[30:31], v241 offset:640
v_fma_f32 v91, v91, s35, -v134
v_mfma_f32_16x16x32_bf16 v[188:191], a[60:63], v[196:199], v[188:191]
s_waitcnt lgkmcnt(15)
ds_read_b64_tr_b16 a[44:45], v239 offset:10248
ds_read_b64_tr_b16 a[46:47], v239 offset:22536
v_cvt_pk_bf16_f32 v212, v184, v185
v_mfma_f32_16x16x32_bf16 v[160:163], a[160:163], a[216:219], v[160:163]
ds_read_b64_tr_b16 a[60:61], v239 offset:34824
v_cvt_pk_bf16_f32 v213, v186, v187
v_mfma_f32_16x16x32_bf16 v[160:163], a[176:179], a[220:223], v[160:163]
ds_read_b64_tr_b16 a[62:63], v241 offset:648
v_fma_f32 v130, v130, s35, -v134
v_mfma_f32_16x16x32_bf16 v[164:167], a[164:167], a[216:219], v[164:167]
v_cvt_pk_bf16_f32 v214, v188, v189
v_cvt_pk_bf16_f32 v215, v190, v191
v_cndmask_b32 v74, 0, v202, s[36:37]
v_mfma_f32_16x16x32_bf16 v[164:167], a[180:183], a[220:223], v[164:167]
v_exp_f32 v144, v144
v_mfma_f32_16x16x32_bf16 v[168:171], a[168:171], a[216:219], v[168:171]
ds_read_b128 a[216:219], v228 offset:6144
v_cvt_pk_bf16_f32 v120, v160, v161
v_cvt_pk_bf16_f32 v121, v162, v163
v_mfma_f32_16x16x32_bf16 v[168:171], a[184:187], a[220:223], v[168:171]
ds_read_b128 a[220:223], v228 offset:7168
v_cndmask_b32 v75, 0, v203, s[36:37]
v_mfma_f32_16x16x32_bf16 v[176:179], a[76:79], v[192:195], 0
ds_read_b64_tr_b16 a[76:77], v239 offset:11264
v_cvt_pk_bf16_f32 v122, v164, v165
v_mfma_f32_16x16x32_bf16 v[176:179], a[92:95], v[196:199], v[176:179]
ds_read_b64_tr_b16 a[78:79], v239 offset:23552
ds_read_b64_tr_b16 a[92:93], v239 offset:35840
v_cvt_pk_bf16_f32 v123, v166, v167
v_mfma_f32_16x16x32_bf16 v[180:183], a[108:111], v[192:195], 0
ds_read_b64_tr_b16 a[94:95], v241 offset:704
v_cvt_pk_bf16_f32 v124, v168, v169
v_mfma_f32_16x16x32_bf16 v[180:183], a[124:127], v[196:199], v[180:183]
ds_read_b64_tr_b16 a[108:109], v239 offset:11272
ds_read_b64_tr_b16 a[110:111], v239 offset:23560
v_cvt_pk_bf16_f32 v216, v176, v177
v_mfma_f32_16x16x32_bf16 v[96:99], a[0:3], a[192:195], 0
ds_read_b64_tr_b16 a[124:125], v239 offset:35848
v_cvt_pk_bf16_f32 v217, v178, v179
v_mfma_f32_16x16x32_bf16 v[96:99], a[16:19], a[196:199], v[96:99]
ds_read_b64_tr_b16 a[126:127], v241 offset:712
v_cvt_pk_bf16_f32 v125, v170, v171
v_mfma_f32_16x16x32_bf16 v[100:103], a[4:7], a[192:195], 0
v_cvt_pk_bf16_f32 v218, v180, v181
v_cvt_pk_bf16_f32 v219, v182, v183
v_cndmask_b32 v76, 0, v204, s[36:37]
v_mfma_f32_16x16x32_bf16 v[100:103], a[20:23], a[196:199], v[100:103]
v_exp_f32 v145, v145
v_mfma_f32_16x16x32_bf16 v[104:107], a[8:11], a[192:195], 0
ds_read_b128 a[192:195], v228 offset:8192
v_add_f32 v132, v144, v145
v_cndmask_b32 v77, 0, v205, s[36:37]
v_mfma_f32_16x16x32_bf16 v[104:107], a[24:27], a[196:199], v[104:107]
ds_read_b128 a[196:199], v228 offset:9216
v_cndmask_b32 v78, v244, v206, s[36:37]
v_mfma_f32_16x16x32_bf16 v[184:187], a[140:143], v[192:195], 0
v_exp_f32 v146, v146
v_mfma_f32_16x16x32_bf16 v[184:187], a[156:159], v[196:199], v[184:187]
v_exp_f32 v147, v147
s_nop 0
v_add_f32 v136, v146, v147
v_mfma_f32_16x16x32_bf16 v[188:191], a[172:175], v[192:195], 0
v_exp_f32 v48, v48
v_mfma_f32_16x16x32_bf16 v[188:191], a[188:191], v[196:199], v[188:191]
s_waitcnt lgkmcnt(2)
s_barrier
s_add_u32 m0, s34, 73728
v_exp_f32 v49, v49
v_mfma_f32_16x16x32_bf16 v[96:99], a[32:35], a[200:203], v[96:99]
s_add_u32 s50, s34, 368640
buffer_load_dwordx4 v228, s[20:23], s50 offen offset:0 sc1 lds
v_mfma_f32_16x16x32_bf16 v[96:99], a[48:51], a[204:207], v[96:99]
v_cvt_pk_bf16_f32 v220, v184, v185
v_cvt_pk_bf16_f32 v221, v186, v187
v_mfma_f32_16x16x32_bf16 v[100:103], a[36:39], a[200:203], v[100:103]
v_cvt_pk_bf16_f32 v222, v188, v189
v_cvt_pk_bf16_f32 v223, v190, v191
ds_read_b128 a[140:143], v229 offset:0
v_mfma_f32_16x16x32_bf16 v[100:103], a[52:55], a[204:207], v[100:103]
v_exp_f32 v148, v148
v_mfma_f32_16x16x32_bf16 v[104:107], a[40:43], a[200:203], v[104:107]
buffer_load_dwordx4 v228, s[20:23], s50 offen offset:1024 sc1 lds
v_mfma_f32_16x16x32_bf16 v[104:107], a[56:59], a[204:207], v[104:107]
ds_read_b128 a[200:203], v228 offset:10240
v_add_f32 v137, v48, v49
v_mfma_f32_16x16x32_bf16 v[176:179], a[224:227], v[192:195], 0
ds_read_b128 a[204:207], v228 offset:11264
v_mfma_f32_16x16x32_bf16 v[176:179], a[228:231], v[196:199], v[176:179]
v_exp_f32 v149, v149
s_nop 0
v_add_f32 v133, v148, v149
v_mfma_f32_16x16x32_bf16 v[180:183], a[232:235], v[192:195], 0
buffer_load_dwordx4 v228, s[20:23], s50 offen offset:2048 sc1 lds
v_mfma_f32_16x16x32_bf16 v[180:183], a[236:239], v[196:199], v[180:183]
v_exp_f32 v150, v150
v_mfma_f32_16x16x32_bf16 v[96:99], a[64:67], a[208:211], v[96:99]
v_exp_f32 v151, v151
v_mfma_f32_16x16x32_bf16 v[96:99], a[80:83], a[212:215], v[96:99]
v_cvt_pk_bf16_f32 v32, v176, v177
v_cvt_pk_bf16_f32 v33, v178, v179
v_mfma_f32_16x16x32_bf16 v[100:103], a[68:71], a[208:211], v[100:103]
buffer_load_dwordx4 v228, s[20:23], s50 offen offset:3072 sc1 lds
v_mfma_f32_16x16x32_bf16 v[100:103], a[84:87], a[212:215], v[100:103]
s_add_u32 m0, s34, 77824
s_add_u32 s51, s34, 372736
v_cvt_pk_bf16_f32 v34, v180, v181
v_mfma_f32_16x16x32_bf16 v[104:107], a[72:75], a[208:211], v[104:107]
s_mov_b32 s50, 24576
v_cvt_pk_bf16_f32 v35, v182, v183
ds_read_b128 a[208:211], v228 offset:12288
v_add_f32 v138, v150, v151
v_mfma_f32_16x16x32_bf16 v[104:107], a[88:91], a[212:215], v[104:107]
v_exp_f32 v52, v52
v_mfma_f32_16x16x32_bf16 v[184:187], a[240:243], v[192:195], 0
buffer_load_dwordx4 v228, s[20:23], s51 offen offset:0 sc1 lds
v_mfma_f32_16x16x32_bf16 v[184:187], a[244:247], v[196:199], v[184:187]
ds_read_b128 a[212:215], v228 offset:13312
ds_read_b128 a[172:175], v229 offset:2048
v_mfma_f32_16x16x32_bf16 v[188:191], a[248:251], v[192:195], 0
v_exp_f32 v53, v53
v_mfma_f32_16x16x32_bf16 v[188:191], a[252:255], v[196:199], v[188:191]
v_exp_f32 v152, v152
v_add_f32 v139, v52, v53
v_mfma_f32_16x16x32_bf16 v[96:99], a[96:99], a[216:219], v[96:99]
buffer_load_dwordx4 v228, s[20:23], s51 offen offset:1024 sc1 lds
v_mfma_f32_16x16x32_bf16 v[96:99], a[112:115], a[220:223], v[96:99]
s_add_u32 m0, s34, 98304
v_exp_f32 v153, v153
v_mfma_f32_16x16x32_bf16 v[100:103], a[100:103], a[216:219], v[100:103]
s_add_u32 s52, s34, 393216
v_cvt_pk_bf16_f32 v36, v184, v185
v_cvt_pk_bf16_f32 v37, v186, v187
v_cvt_pk_bf16_f32 v38, v188, v189
v_mfma_f32_16x16x32_bf16 v[100:103], a[116:119], a[220:223], v[100:103]
s_mov_b32 s51, 73728
v_exp_f32 v50, v50
v_mfma_f32_16x16x32_bf16 v[104:107], a[104:107], a[216:219], v[104:107]
v_cvt_pk_bf16_f32 v39, v190, v191
ds_read_b128 a[156:159], v229 offset:1024
v_add_f32 v134, v152, v153
v_mfma_f32_16x16x32_bf16 v[104:107], a[120:123], a[220:223], v[104:107]
ds_read_b128 a[188:191], v229 offset:3072
v_add_f32 v132, v132, v50
v_mfma_f32_16x16x32_bf16 v[176:179], a[12:15], v[192:195], 0
ds_read_b128 a[228:231], v229 offset:5120
v_mfma_f32_16x16x32_bf16 v[176:179], a[28:31], v[196:199], v[176:179]
v_exp_f32 v51, v51
s_nop 0
v_add_f32 v136, v136, v51
v_mfma_f32_16x16x32_bf16 v[180:183], a[44:47], v[192:195], 0
ds_read_b128 a[224:227], v229 offset:4096
v_mfma_f32_16x16x32_bf16 v[180:183], a[60:63], v[196:199], v[180:183]
s_waitcnt lgkmcnt(10)
v_exp_f32 v80, v80
s_nop 0
v_add_f32 v137, v137, v80
v_mfma_f32_16x16x32_bf16 v[96:99], a[128:131], a[192:195], v[96:99]
ds_read_b128 a[232:235], v229 offset:6144
v_cvt_pk_bf16_f32 v40, v176, v177
v_mfma_f32_16x16x32_bf16 v[96:99], a[144:147], a[196:199], v[96:99]
ds_read_b128 a[240:243], v229 offset:8192
v_cvt_pk_bf16_f32 v41, v178, v179
v_mfma_f32_16x16x32_bf16 v[100:103], a[132:135], a[192:195], v[100:103]
ds_read_b128 a[236:239], v229 offset:7168
ds_read_b128 a[244:247], v229 offset:9216
v_cvt_pk_bf16_f32 v42, v180, v181
v_mfma_f32_16x16x32_bf16 v[100:103], a[148:151], a[196:199], v[100:103]
v_exp_f32 v154, v154
v_mfma_f32_16x16x32_bf16 v[104:107], a[136:139], a[192:195], v[104:107]
v_exp_f32 v155, v155
v_cvt_pk_bf16_f32 v43, v182, v183
v_mfma_f32_16x16x32_bf16 v[104:107], a[152:155], a[196:199], v[104:107]
ds_read_b128 a[252:255], v229 offset:11264
v_add_f32 v140, v154, v155
v_mfma_f32_16x16x32_bf16 v[184:187], a[76:79], v[192:195], 0
v_exp_f32 v56, v56
v_mfma_f32_16x16x32_bf16 v[184:187], a[92:95], v[196:199], v[184:187]
v_exp_f32 v57, v57
s_nop 0
v_add_f32 v141, v56, v57
v_mfma_f32_16x16x32_bf16 v[188:191], a[108:111], v[192:195], 0
ds_read_b128 a[248:251], v229 offset:10240
v_add_u32_dpp v176, v224, v247 row_newbcast:0 row_mask:0xf bank_mask:0xf
v_mfma_f32_16x16x32_bf16 v[188:191], a[124:127], v[196:199], v[188:191]
s_waitcnt lgkmcnt(13)
v_exp_f32 v54, v54
s_nop 0
v_add_f32 v133, v133, v54
v_mfma_f32_16x16x32_bf16 v[96:99], a[160:163], a[200:203], v[96:99]
ds_read_b128 a[216:219], v228 offset:14336
v_cvt_pk_bf16_f32 v44, v184, v185
v_mfma_f32_16x16x32_bf16 v[96:99], a[176:179], a[204:207], v[96:99]
ds_read_b128 a[220:223], v228 offset:15360
v_cvt_pk_bf16_f32 v45, v186, v187
v_mfma_f32_16x16x32_bf16 v[100:103], a[164:167], a[200:203], v[100:103]
v_exp_f32 v55, v55
v_cvt_pk_bf16_f32 v46, v188, v189
v_mfma_f32_16x16x32_bf16 v[100:103], a[180:183], a[204:207], v[100:103]
v_exp_f32 v84, v84
v_mfma_f32_16x16x32_bf16 v[104:107], a[168:171], a[200:203], v[104:107]
v_exp_f32 v58, v58
v_cvt_pk_bf16_f32 v47, v190, v191
v_mfma_f32_16x16x32_bf16 v[104:107], a[184:187], a[204:207], v[104:107]
s_waitcnt lgkmcnt(13)
v_exp_f32 v81, v81
v_mfma_f32_16x16x32_bf16 v[160:163], a[0:3], a[208:211], 0
ds_read_b128 a[12:15], v229 offset:12288
v_add_f32 v138, v138, v55
v_mfma_f32_16x16x32_bf16 v[160:163], a[16:19], a[212:215], v[160:163]
v_exp_f32 v82, v82
v_add_f32 v139, v139, v84
v_mfma_f32_16x16x32_bf16 v[164:167], a[4:7], a[208:211], 0
v_exp_f32 v83, v83
v_mfma_f32_16x16x32_bf16 v[164:167], a[20:23], a[212:215], v[164:167]
ds_read_b128 a[44:47], v229 offset:14336
ds_read_b128 a[28:31], v229 offset:13312
v_add_f32 v134, v134, v58
v_mfma_f32_16x16x32_bf16 v[168:171], a[8:11], a[208:211], 0
v_exp_f32 v59, v59
v_mfma_f32_16x16x32_bf16 v[168:171], a[24:27], a[212:215], v[168:171]
s_waitcnt lgkmcnt(15)
ds_read_b128 a[60:63], v229 offset:15360
v_add_f32 v132, v132, v81
v_mfma_f32_16x16x32_bf16 v[108:111], v[16:19], a[140:143], 0
s_waitcnt lgkmcnt(15)
ds_read_b128 a[92:95], v229 offset:17408
ds_read_b128 a[76:79], v229 offset:16384
v_add_f32 v136, v136, v82
v_mfma_f32_16x16x32_bf16 v[108:111], v[20:23], a[156:159], v[108:111]
v_exp_f32 v88, v88
v_mfma_f32_16x16x32_bf16 v[108:111], v[24:27], a[172:175], v[108:111]
s_waitcnt lgkmcnt(15)
v_exp_f32 v85, v85
v_add_f32 v137, v137, v83
v_mfma_f32_16x16x32_bf16 v[108:111], v[28:31], a[188:191], v[108:111]
s_waitcnt lgkmcnt(14)
ds_read_b128 a[108:111], v229 offset:18432
v_add_f32 v140, v140, v59
v_mfma_f32_16x16x32_bf16 v[108:111], v[208:211], a[224:227], v[108:111]
ds_read_b128 a[140:143], v229 offset:20480
v_add_f32 v141, v141, v88
v_mfma_f32_16x16x32_bf16 v[108:111], v[212:215], a[228:231], v[108:111]
s_waitcnt lgkmcnt(14)
v_exp_f32 v86, v86
v_add_f32 v133, v133, v85
v_mfma_f32_16x16x32_bf16 v[108:111], v[216:219], a[232:235], v[108:111]
s_waitcnt lgkmcnt(13)
v_exp_f32 v87, v87
v_mfma_f32_16x16x32_bf16 v[108:111], v[220:223], a[236:239], v[108:111]
v_exp_f32 v89, v89
v_add_f32 v138, v138, v86
v_mfma_f32_16x16x32_bf16 v[108:111], v[32:35], a[240:243], v[108:111]
s_waitcnt lgkmcnt(11)
ds_read_b128 a[124:127], v229 offset:19456
v_add_f32 v139, v139, v87
v_mfma_f32_16x16x32_bf16 v[108:111], v[36:39], a[244:247], v[108:111]
s_waitcnt lgkmcnt(11)
v_exp_f32 v128, v128
v_mfma_f32_16x16x32_bf16 v[108:111], v[40:43], a[248:251], v[108:111]
ds_read_b128 a[156:159], v229 offset:21504
ds_read_b128 a[188:191], v229 offset:23552
v_add_f32 v134, v134, v89
v_mfma_f32_16x16x32_bf16 v[108:111], v[44:47], a[252:255], v[108:111]
s_waitcnt lgkmcnt(11)
v_exp_f32 v90, v90
v_mfma_f32_16x16x32_bf16 v[160:163], a[32:35], a[216:219], v[160:163]
v_exp_f32 v91, v91
v_add_f32 v132, v132, v128
v_mfma_f32_16x16x32_bf16 v[160:163], a[48:51], a[220:223], v[160:163]
ds_read_b128 a[172:175], v229 offset:22528
v_add_f32 v136, v136, v137
v_mfma_f32_16x16x32_bf16 v[164:167], a[36:39], a[216:219], v[164:167]
v_exp_f32 v129, v129
v_mfma_f32_16x16x32_bf16 v[164:167], a[52:55], a[220:223], v[164:167]
v_exp_f32 v130, v130
v_add_f32 v140, v140, v90
v_mfma_f32_16x16x32_bf16 v[168:171], a[40:43], a[216:219], v[168:171]
ds_read_b128 a[192:195], v228 offset:16384
v_add_f32 v141, v141, v91
v_mfma_f32_16x16x32_bf16 v[168:171], a[56:59], a[220:223], v[168:171]
s_waitcnt lgkmcnt(11)
ds_read_b128 a[196:199], v228 offset:17408
v_add_f32 v133, v133, v129
v_add_f32 v138, v138, v139
v_mfma_f32_16x16x32_bf16 v[172:175], v[16:19], a[12:15], 0
s_waitcnt lgkmcnt(11)
ds_read_b128 a[224:227], v228 offset:0
v_add_f32 v134, v134, v130
v_mfma_f32_16x16x32_bf16 v[172:175], v[20:23], a[28:31], v[172:175]
ds_read_b128 a[232:235], v228 offset:2048
v_add_f32 v132, v132, v136
v_mfma_f32_16x16x32_bf16 v[172:175], v[24:27], a[44:47], v[172:175]
s_waitcnt lgkmcnt(11)
v_add_f32 v140, v140, v141
ds_read_b128 a[228:231], v228 offset:1024
v_add_f32 v133, v133, v138
v_mfma_f32_16x16x32_bf16 v[172:175], v[28:31], a[60:63], v[172:175]
s_waitcnt lgkmcnt(11)
ds_read_b128 a[236:239], v228 offset:3072
v_add_f32 v134, v134, v140
v_mfma_f32_16x16x32_bf16 v[172:175], v[208:211], a[76:79], v[172:175]
ds_read_b128 a[244:247], v228 offset:5120
v_permlane32_swap_b32 v132, v133
v_mfma_f32_16x16x32_bf16 v[172:175], v[212:215], a[92:95], v[172:175]
s_waitcnt lgkmcnt(11)
ds_read_b128 a[240:243], v228 offset:4096
v_mov_b32 v135, v134
v_mfma_f32_16x16x32_bf16 v[172:175], v[216:219], a[108:111], v[172:175]
s_waitcnt lgkmcnt(11)
ds_read_b128 a[248:251], v228 offset:6144
v_add_f32 v132, v132, v133
v_mfma_f32_16x16x32_bf16 v[172:175], v[220:223], a[124:127], v[172:175]
v_permlane32_swap_b32 v135, v134
ds_read_b128 a[12:15], v228 offset:8192
v_mfma_f32_16x16x32_bf16 v[172:175], v[32:35], a[140:143], v[172:175]
s_waitcnt lgkmcnt(11)
ds_read_b128 a[252:255], v228 offset:7168
v_add_f32 v134, v135, v134
v_mfma_f32_16x16x32_bf16 v[172:175], v[36:39], a[156:159], v[172:175]
s_waitcnt lgkmcnt(11)
ds_read_b128 a[28:31], v228 offset:9216
v_permlane16_swap_b32 v132, v134
v_mfma_f32_16x16x32_bf16 v[172:175], v[40:43], a[172:175], v[172:175]
ds_read_b128 a[60:63], v228 offset:11264
v_add_f32 v134, v132, v134
v_mfma_f32_16x16x32_bf16 v[172:175], v[44:47], a[188:191], v[172:175]
s_waitcnt lgkmcnt(11)
ds_read_b128 a[44:47], v228 offset:10240
v_cvt_pk_bf16_f32 v118, v108, v109
v_mfma_f32_16x16x32_bf16 v[160:163], a[64:67], a[192:195], v[160:163]
ds_read_b128 a[200:203], v228 offset:18432
ds_read_b128 a[204:207], v228 offset:19456
v_cvt_pk_bf16_f32 v119, v110, v111
v_mfma_f32_16x16x32_bf16 v[160:163], a[80:83], a[196:199], v[160:163]
ds_read_b128 a[76:79], v228 offset:12288
v_cvt_pk_bf16_f32 v248, v96, v97
v_mfma_f32_16x16x32_bf16 v[164:167], a[68:71], a[192:195], v[164:167]
v_rcp_f32 v134, v134
s_nop 0
v_mov_b32 v133, v134
v_mfma_f32_16x16x32_bf16 v[164:167], a[84:87], a[196:199], v[164:167]
ds_read_b128 a[108:111], v228 offset:14336
v_cvt_pk_bf16_f32 v126, v172, v173
v_mfma_f32_16x16x32_bf16 v[168:171], a[72:75], a[192:195], v[168:171]
ds_read_b128 a[92:95], v228 offset:13312
v_cvt_pk_bf16_f32 v127, v174, v175
v_mfma_f32_16x16x32_bf16 v[168:171], a[88:91], a[196:199], v[168:171]
s_waitcnt lgkmcnt(15)
v_permlane16_swap_b32 v133, v134
ds_read_b128 a[124:127], v228 offset:15360
v_mfma_f32_16x16x32_bf16 v[108:111], v[16:19], a[224:227], 0
s_waitcnt lgkmcnt(15)
ds_read_b128 a[156:159], v228 offset:17408
v_mov_b32 v132, v133
v_mfma_f32_16x16x32_bf16 v[108:111], v[20:23], a[228:231], v[108:111]
ds_read_b128 a[140:143], v228 offset:16384
v_permlane32_swap_b32 v132, v133
v_mfma_f32_16x16x32_bf16 v[108:111], v[24:27], a[232:235], v[108:111]
s_waitcnt lgkmcnt(15)
ds_read_b128 a[172:175], v228 offset:18432
v_mul_f32 v144, v144, v132
v_mfma_f32_16x16x32_bf16 v[108:111], v[28:31], a[236:239], v[108:111]
s_waitcnt lgkmcnt(15)
buffer_load_dwordx4 v228, s[20:23], s52 offen offset:0 sc1 lds
v_mfma_f32_16x16x32_bf16 v[108:111], v[208:211], a[240:243], v[108:111]
ds_read_b128 a[224:227], v228 offset:20480
ds_read_b128 a[188:191], v228 offset:19456
v_mul_f32 v145, v145, v132
v_mfma_f32_16x16x32_bf16 v[108:111], v[212:215], a[244:247], v[108:111]
s_waitcnt lgkmcnt(15)
ds_read_b128 a[228:231], v228 offset:21504
v_mul_f32 v146, v146, v132
v_mfma_f32_16x16x32_bf16 v[108:111], v[216:219], a[248:251], v[108:111]
s_waitcnt lgkmcnt(15)
ds_read_b128 a[236:239], v228 offset:23552
ds_read_b128 a[232:235], v228 offset:22528
v_mul_f32 v147, v147, v132
v_mfma_f32_16x16x32_bf16 v[108:111], v[220:223], a[252:255], v[108:111]
buffer_load_dwordx4 v228, s[20:23], s52 offen offset:1024 sc1 lds
v_mfma_f32_16x16x32_bf16 v[108:111], v[32:35], a[12:15], v[108:111]
s_waitcnt lgkmcnt(15)
ds_read_b128 a[208:211], v228 offset:20480
v_mul_f32 v48, v48, v132
v_mfma_f32_16x16x32_bf16 v[108:111], v[36:39], a[28:31], v[108:111]
s_waitcnt lgkmcnt(15)
ds_read_b128 a[212:215], v228 offset:21504
v_mul_f32 v49, v49, v132
v_mul_f32 v50, v50, v132
v_mfma_f32_16x16x32_bf16 v[108:111], v[40:43], a[44:47], v[108:111]
v_mul_f32 v51, v51, v132
v_mul_f32 v80, v80, v132
v_mfma_f32_16x16x32_bf16 v[108:111], v[44:47], a[60:63], v[108:111]
s_waitcnt lgkmcnt(14)
buffer_load_dwordx4 v228, s[20:23], s52 offen offset:2048 sc1 lds
v_mfma_f32_16x16x32_bf16 v[160:163], a[96:99], a[200:203], v[160:163]
v_mul_f32 v81, v81, v132
v_mul_f32 v82, v82, v132
v_mfma_f32_16x16x32_bf16 v[160:163], a[112:115], a[204:207], v[160:163]
v_mul_f32 v83, v83, v132
v_mul_f32 v128, v128, v132
v_mfma_f32_16x16x32_bf16 v[164:167], a[100:103], a[200:203], v[164:167]
v_mul_f32 v148, v148, v133
v_mul_f32 v149, v149, v133
v_mul_f32 v150, v150, v133
v_mfma_f32_16x16x32_bf16 v[164:167], a[116:119], a[204:207], v[164:167]
buffer_load_dwordx4 v228, s[20:23], s52 offen offset:3072 sc1 lds
v_mfma_f32_16x16x32_bf16 v[168:171], a[104:107], a[200:203], v[168:171]
s_add_u32 m0, s34, 102400
s_add_u32 s53, s34, 397312
v_mul_f32 v151, v151, v133
v_mul_f32 v52, v52, v133
v_mfma_f32_16x16x32_bf16 v[168:171], a[120:123], a[204:207], v[168:171]
s_waitcnt lgkmcnt(12)
s_mov_b32 s52, 98304
v_mul_f32 v53, v53, v133
v_mul_f32 v54, v54, v133
v_mfma_f32_16x16x32_bf16 v[172:175], v[16:19], a[76:79], 0
s_waitcnt lgkmcnt(11)
v_mul_f32 v55, v55, v133
v_mul_f32 v84, v84, v133
v_mfma_f32_16x16x32_bf16 v[172:175], v[20:23], a[92:95], v[172:175]
buffer_load_dwordx4 v228, s[20:23], s53 offen offset:0 sc1 lds
v_mfma_f32_16x16x32_bf16 v[172:175], v[24:27], a[108:111], v[172:175]
s_waitcnt lgkmcnt(9)
v_mul_f32 v85, v85, v133
v_mul_f32 v86, v86, v133
v_mfma_f32_16x16x32_bf16 v[172:175], v[28:31], a[124:127], v[172:175]
s_waitcnt lgkmcnt(8)
v_cvt_pk_bf16_f32 v0, v144, v145
v_mul_f32 v87, v87, v133
v_mul_f32 v129, v129, v133
v_mfma_f32_16x16x32_bf16 v[172:175], v[208:211], a[140:143], v[172:175]
v_cvt_pk_bf16_f32 v1, v146, v147
v_cvt_pk_bf16_f32 v2, v48, v49
v_mfma_f32_16x16x32_bf16 v[172:175], v[212:215], a[156:159], v[172:175]
s_waitcnt lgkmcnt(6)
v_cvt_pk_bf16_f32 v3, v50, v51
v_mul_f32 v152, v152, v134
v_mfma_f32_16x16x32_bf16 v[172:175], v[216:219], a[172:175], v[172:175]
s_waitcnt lgkmcnt(5)
v_mul_f32 v153, v153, v134
v_mul_f32 v154, v154, v134
ds_read_b128 a[216:219], v228 offset:22528
v_mfma_f32_16x16x32_bf16 v[172:175], v[220:223], a[188:191], v[172:175]
v_mul_f32 v155, v155, v134
ds_read_b128 a[220:223], v228 offset:23552
v_mfma_f32_16x16x32_bf16 v[172:175], v[32:35], a[224:227], v[172:175]
s_waitcnt lgkmcnt(5)
v_cvt_pk_bf16_f32 v4, v80, v81
v_cvt_pk_bf16_f32 v5, v82, v83
v_cvt_pk_bf16_f32 v6, v128, 0
v_mfma_f32_16x16x32_bf16 v[172:175], v[36:39], a[228:231], v[172:175]
s_waitcnt lgkmcnt(4)
v_mul_f32 v56, v56, v134
v_mul_f32 v57, v57, v134
v_mfma_f32_16x16x32_bf16 v[172:175], v[40:43], a[232:235], v[172:175]
v_mul_f32 v58, v58, v134
v_cvt_pk_bf16_f32 v8, v148, v149
v_mfma_f32_16x16x32_bf16 v[172:175], v[44:47], a[236:239], v[172:175]
s_waitcnt lgkmcnt(2)
v_cvt_pk_bf16_f32 v9, v150, v151
v_mul_f32 v59, v59, v134
v_cvt_pk_bf16_f32 v10, v52, v53
v_mfma_f32_16x16x32_bf16 v[160:163], a[128:131], a[208:211], v[160:163]
v_cvt_pk_bf16_f32 v11, v54, v55
v_mul_f32 v88, v88, v134
v_mfma_f32_16x16x32_bf16 v[160:163], a[144:147], a[212:215], v[160:163]
v_mul_f32 v89, v89, v134
v_mul_f32 v90, v90, v134
v_mul_f32 v91, v91, v134
v_mfma_f32_16x16x32_bf16 v[164:167], a[132:135], a[208:211], v[164:167]
buffer_load_dwordx4 v228, s[20:23], s53 offen offset:1024 sc1 lds
v_mfma_f32_16x16x32_bf16 v[164:167], a[148:151], a[212:215], v[164:167]
s_add_u32 m0, s34, 122880
v_cvt_pk_bf16_f32 v12, v84, v85
v_cvt_pk_bf16_f32 v13, v86, v87
v_mfma_f32_16x16x32_bf16 v[168:171], a[136:139], a[208:211], v[168:171]
s_add_u32 s54, s34, 417792
v_cvt_pk_bf16_f32 v14, v129, 0
v_mul_f32 v130, v130, v134
v_cvt_pk_bf16_f32 v64, v152, v153
v_mfma_f32_16x16x32_bf16 v[168:171], a[152:155], a[212:215], v[168:171]
s_waitcnt vmcnt(6) lgkmcnt(0)
s_barrier
v_cvt_pk_bf16_f32 v65, v154, v155
v_mfma_f32_16x16x32_bf16 v[144:147], v[0:3], v[112:115], 0
s_mov_b32 s53, 122880
v_cvt_pk_bf16_f32 v66, v56, v57
v_cvt_pk_bf16_f32 v67, v58, v59
v_mfma_f32_16x16x32_bf16 v[144:147], v[4:7], v[116:119], v[144:147]
v_cvt_pk_bf16_f32 v68, v88, v89
v_cvt_pk_bf16_f32 v69, v90, v91
v_mfma_f32_16x16x32_bf16 v[148:151], v[8:11], v[112:115], 0
v_cvt_pk_bf16_f32 v70, v130, 0
v_cvt_pk_bf16_f32 v249, v98, v99
v_mfma_f32_16x16x32_bf16 v[148:151], v[12:15], v[116:119], v[148:151]
buffer_load_dwordx4 v228, s[20:23], s54 offen offset:0 sc1 lds
v_mfma_f32_16x16x32_bf16 v[152:155], v[64:67], v[112:115], 0
v_cvt_pk_bf16_f32 v250, v100, v101
v_cvt_pk_bf16_f32 v251, v102, v103
v_mfma_f32_16x16x32_bf16 v[152:155], v[68:71], v[116:119], v[152:155]
ds_read_b128 a[192:195], v228 offset:24576
v_cvt_pk_bf16_f32 v252, v104, v105
v_mfma_f32_16x16x32_bf16 v[156:159], v[72:75], v[112:115], 0
ds_read_b128 a[196:199], v228 offset:25600
v_cvt_pk_bf16_f32 v253, v106, v107
v_mfma_f32_16x16x32_bf16 v[156:159], v[76:79], v[116:119], v[156:159]
buffer_load_dwordx4 v228, s[20:23], s54 offen offset:1024 sc1 lds
v_mfma_f32_16x16x32_bf16 v[160:163], a[160:163], a[216:219], v[160:163]
v_cvt_pk_bf16_f32 v254, v108, v109
v_cvt_pk_bf16_f32 v255, v110, v111
v_mfma_f32_16x16x32_bf16 v[160:163], a[176:179], a[220:223], v[160:163]
ds_read_b128 a[200:203], v228 offset:26624
v_add_u32_dpp v177, v224, v247 row_newbcast:4 row_mask:0xf bank_mask:0xf
v_mfma_f32_16x16x32_bf16 v[164:167], a[164:167], a[216:219], v[164:167]
ds_read_b128 a[204:207], v228 offset:27648
v_add_u32_dpp v178, v224, v247 row_newbcast:8 row_mask:0xf bank_mask:0xf
v_mfma_f32_16x16x32_bf16 v[164:167], a[180:183], a[220:223], v[164:167]
buffer_load_dwordx4 v228, s[20:23], s54 offen offset:2048 sc1 lds
v_mfma_f32_16x16x32_bf16 v[168:171], a[168:171], a[216:219], v[168:171]
ds_read_b128 a[208:211], v228 offset:28672
v_add_u32_dpp v179, v224, v247 row_newbcast:12 row_mask:0xf bank_mask:0xf
v_mfma_f32_16x16x32_bf16 v[168:171], a[184:187], a[220:223], v[168:171]
ds_read_b128 a[212:215], v228 offset:29696
v_add_u32_dpp v180, v225, v247 row_newbcast:0 row_mask:0xf bank_mask:0xf
v_mfma_f32_16x16x32_bf16 v[48:51], v[0:3], v[120:123], 0
v_add_u32_dpp v181, v225, v247 row_newbcast:4 row_mask:0xf bank_mask:0xf
v_add_u32_dpp v182, v225, v247 row_newbcast:8 row_mask:0xf bank_mask:0xf
v_mfma_f32_16x16x32_bf16 v[48:51], v[4:7], v[124:127], v[48:51]
buffer_load_dwordx4 v228, s[20:23], s54 offen offset:3072 sc1 lds
v_mfma_f32_16x16x32_bf16 v[52:55], v[8:11], v[120:123], 0
s_add_u32 m0, s34, 126976
s_add_u32 s55, s34, 421888
v_add_u32_dpp v183, v225, v247 row_newbcast:12 row_mask:0xf bank_mask:0xf
v_mfma_f32_16x16x32_bf16 v[52:55], v[12:15], v[124:127], v[52:55]
s_mov_b32 s54, 49152
v_add_u32_dpp v184, v226, v247 row_newbcast:0 row_mask:0xf bank_mask:0xf
v_add_u32_dpp v185, v226, v247 row_newbcast:4 row_mask:0xf bank_mask:0xf
v_mfma_f32_16x16x32_bf16 v[56:59], v[64:67], v[120:123], 0
v_cvt_pk_bf16_f32 v80, v144, v48
v_cvt_pk_bf16_f32 v82, v145, v49
v_mfma_f32_16x16x32_bf16 v[56:59], v[68:71], v[124:127], v[56:59]
buffer_load_dwordx4 v228, s[20:23], s55 offen offset:0 sc1 lds
v_mfma_f32_16x16x32_bf16 v[60:63], v[72:75], v[120:123], 0
v_cvt_pk_bf16_f32 v84, v146, v50
v_cvt_pk_bf16_f32 v86, v147, v51
v_mfma_f32_16x16x32_bf16 v[60:63], v[76:79], v[124:127], v[60:63]
v_cvt_pk_bf16_f32 v88, v148, v52
v_cvt_pk_bf16_f32 v90, v149, v53
v_mfma_f32_16x16x32_bf16 v[144:147], v[0:3], v[248:251], 0
v_cvt_pk_bf16_f32 v92, v150, v54
v_cvt_pk_bf16_f32 v94, v151, v55
v_mfma_f32_16x16x32_bf16 v[144:147], v[4:7], v[252:255], v[144:147]
buffer_load_dwordx4 v228, s[20:23], s55 offen offset:1024 sc1 lds
v_mfma_f32_16x16x32_bf16 v[148:151], v[8:11], v[248:251], 0
s_mov_b32 s55, 0
v_cvt_pk_bf16_f32 v192, v152, v56
v_cvt_pk_bf16_f32 v194, v153, v57
v_mfma_f32_16x16x32_bf16 v[148:151], v[12:15], v[252:255], v[148:151]
v_cvt_pk_bf16_f32 v196, v154, v58
v_cvt_pk_bf16_f32 v198, v155, v59
v_mfma_f32_16x16x32_bf16 v[152:155], v[64:67], v[248:251], 0
v_cvt_pk_bf16_f32 v200, v156, v60
v_cvt_pk_bf16_f32 v202, v157, v61
v_mfma_f32_16x16x32_bf16 v[152:155], v[68:71], v[252:255], v[152:155]
v_cvt_pk_bf16_f32 v204, v158, v62
v_cvt_pk_bf16_f32 v206, v159, v63
v_mfma_f32_16x16x32_bf16 v[156:159], v[72:75], v[248:251], 0
v_add_u32_dpp v186, v226, v247 row_newbcast:8 row_mask:0xf bank_mask:0xf
v_add_u32_dpp v187, v226, v247 row_newbcast:12 row_mask:0xf bank_mask:0xf
v_mfma_f32_16x16x32_bf16 v[156:159], v[76:79], v[252:255], v[156:159]
s_waitcnt lgkmcnt(4)
v_add_u32_dpp v188, v227, v247 row_newbcast:0 row_mask:0xf bank_mask:0xf
v_add_u32_dpp v189, v227, v247 row_newbcast:4 row_mask:0xf bank_mask:0xf
v_add_u32_dpp v190, v227, v247 row_newbcast:8 row_mask:0xf bank_mask:0xf
v_add_u32_dpp v191, v227, v247 row_newbcast:12 row_mask:0xf bank_mask:0xf
L_merge:
L_loop:
s_waitcnt lgkmcnt(4)
v_mfma_f32_16x16x32_bf16 v[96:99], a[0:3], a[192:195], 0
s_add_u32 m0, s54, s34
ds_read_b128 a[216:219], v230 offset:6144
v_mfma_f32_16x16x32_bf16 v[96:99], a[16:19], a[196:199], v[96:99]
s_mov_b32 s64, s50
buffer_load_dwordx4 v228, s[20:23], s63 offen offset:0 sc1 lds
v_mfma_f32_16x16x32_bf16 v[100:103], a[4:7], a[192:195], 0
s_mov_b32 s62, s51
ds_read_b128 a[220:223], v230 offset:7168
v_mfma_f32_16x16x32_bf16 v[100:103], a[20:23], a[196:199], v[100:103]
s_mov_b32 s50, s52
v_cvt_pk_bf16_f32 v120, v160, v161
v_cvt_pk_bf16_f32 v121, v162, v163
v_mfma_f32_16x16x32_bf16 v[104:107], a[8:11], a[192:195], 0
v_cvt_pk_bf16_f32 v122, v164, v165
v_cvt_pk_bf16_f32 v123, v166, v167
v_mfma_f32_16x16x32_bf16 v[104:107], a[24:27], a[196:199], v[104:107]
v_cvt_pk_bf16_f32 v124, v168, v169
v_cvt_pk_bf16_f32 v125, v170, v171
v_mfma_f32_16x16x32_bf16 v[108:111], v[16:19], a[192:195], 0
v_cvt_pk_bf16_f32 v126, v172, v173
v_cvt_pk_bf16_f32 v127, v174, v175
v_mfma_f32_16x16x32_bf16 v[108:111], v[20:23], a[196:199], v[108:111]
s_waitcnt lgkmcnt(4)
buffer_load_dwordx4 v228, s[20:23], s63 offen offset:1024 sc1 lds
v_mfma_f32_16x16x32_bf16 v[96:99], a[32:35], a[200:203], v[96:99]
ds_read_b128 a[192:195], v230 offset:8192
v_mfma_f32_16x16x32_bf16 v[96:99], a[48:51], a[204:207], v[96:99]
ds_read_b128 a[196:199], v230 offset:9216
v_mfma_f32_16x16x32_bf16 v[100:103], a[36:39], a[200:203], v[100:103]
v_mfma_f32_16x16x32_bf16 v[100:103], a[52:55], a[204:207], v[100:103]
v_mfma_f32_16x16x32_bf16 v[104:107], a[40:43], a[200:203], v[104:107]
v_mfma_f32_16x16x32_bf16 v[104:107], a[56:59], a[204:207], v[104:107]
buffer_load_dwordx4 v228, s[20:23], s63 offen offset:2048 sc1 lds
v_mfma_f32_16x16x32_bf16 v[108:111], v[24:27], a[200:203], v[108:111]
ds_read_b128 a[200:203], v230 offset:10240
v_mfma_f32_16x16x32_bf16 v[108:111], v[28:31], a[204:207], v[108:111]
ds_read_b128 a[204:207], v230 offset:11264
v_mfma_f32_16x16x32_bf16 v[48:51], v[0:3], v[120:123], 0
v_mfma_f32_16x16x32_bf16 v[48:51], v[4:7], v[124:127], v[48:51]
v_mfma_f32_16x16x32_bf16 v[52:55], v[8:11], v[120:123], 0
v_mfma_f32_16x16x32_bf16 v[52:55], v[12:15], v[124:127], v[52:55]
buffer_load_dwordx4 v228, s[20:23], s63 offen offset:3072 sc1 lds
v_mfma_f32_16x16x32_bf16 v[56:59], v[64:67], v[120:123], 0
s_add_u32 m0, m0, 4096
s_add_u32 s65, s63, 4096
v_mfma_f32_16x16x32_bf16 v[56:59], v[68:71], v[124:127], v[56:59]
s_add_u32 s63, s63, 24576
v_cvt_pk_bf16_f32 v81, v144, v48
v_cvt_pk_bf16_f32 v83, v145, v49
v_mfma_f32_16x16x32_bf16 v[60:63], v[72:75], v[120:123], 0
v_cvt_pk_bf16_f32 v85, v146, v50
v_cvt_pk_bf16_f32 v87, v147, v51
v_mfma_f32_16x16x32_bf16 v[60:63], v[76:79], v[124:127], v[60:63]
s_waitcnt lgkmcnt(6)
v_cvt_pk_bf16_f32 v89, v148, v52
v_cvt_pk_bf16_f32 v91, v149, v53
v_mfma_f32_16x16x32_bf16 v[96:99], a[64:67], a[208:211], v[96:99]
v_cvt_pk_bf16_f32 v93, v150, v54
v_cvt_pk_bf16_f32 v95, v151, v55
v_mfma_f32_16x16x32_bf16 v[96:99], a[80:83], a[212:215], v[96:99]
v_cvt_pk_bf16_f32 v193, v152, v56
v_cvt_pk_bf16_f32 v195, v153, v57
v_mfma_f32_16x16x32_bf16 v[100:103], a[68:71], a[208:211], v[100:103]
v_cvt_pk_bf16_f32 v197, v154, v58
v_cvt_pk_bf16_f32 v199, v155, v59
v_mfma_f32_16x16x32_bf16 v[100:103], a[84:87], a[212:215], v[100:103]
v_cvt_pk_bf16_f32 v201, v156, v60
v_cvt_pk_bf16_f32 v203, v157, v61
v_mfma_f32_16x16x32_bf16 v[104:107], a[72:75], a[208:211], v[104:107]
v_cvt_pk_bf16_f32 v205, v158, v62
v_cvt_pk_bf16_f32 v207, v159, v63
v_mfma_f32_16x16x32_bf16 v[104:107], a[88:91], a[212:215], v[104:107]
buffer_store_dwordx2 v[80:81], v176, s[16:19], s61 offen sc1 nt
v_mfma_f32_16x16x32_bf16 v[108:111], v[208:211], a[208:211], v[108:111]
ds_read_b128 a[208:211], v230 offset:12288
v_mfma_f32_16x16x32_bf16 v[108:111], v[212:215], a[212:215], v[108:111]
s_waitcnt lgkmcnt(5)
ds_read_b128 a[212:215], v230 offset:13312
v_mfma_f32_16x16x32_bf16 v[96:99], a[96:99], a[216:219], v[96:99]
v_mfma_f32_16x16x32_bf16 v[96:99], a[112:115], a[220:223], v[96:99]
v_mfma_f32_16x16x32_bf16 v[100:103], a[100:103], a[216:219], v[100:103]
v_mfma_f32_16x16x32_bf16 v[100:103], a[116:119], a[220:223], v[100:103]
buffer_store_dwordx2 v[82:83], v177, s[16:19], s61 offen sc1 nt
v_mfma_f32_16x16x32_bf16 v[104:107], a[104:107], a[216:219], v[104:107]
v_mfma_f32_16x16x32_bf16 v[104:107], a[120:123], a[220:223], v[104:107]
v_mfma_f32_16x16x32_bf16 v[108:111], v[216:219], a[216:219], v[108:111]
ds_read_b128 a[216:219], v230 offset:14336
v_mfma_f32_16x16x32_bf16 v[108:111], v[220:223], a[220:223], v[108:111]
s_waitcnt lgkmcnt(5)
ds_read_b128 a[220:223], v230 offset:15360
v_mfma_f32_16x16x32_bf16 v[96:99], a[128:131], a[192:195], v[96:99]
v_mfma_f32_16x16x32_bf16 v[96:99], a[144:147], a[196:199], v[96:99]
buffer_store_dwordx2 v[84:85], v178, s[16:19], s61 offen sc1 nt
v_mfma_f32_16x16x32_bf16 v[100:103], a[132:135], a[192:195], v[100:103]
v_mfma_f32_16x16x32_bf16 v[100:103], a[148:151], a[196:199], v[100:103]
v_mfma_f32_16x16x32_bf16 v[104:107], a[136:139], a[192:195], v[104:107]
v_mfma_f32_16x16x32_bf16 v[104:107], a[152:155], a[196:199], v[104:107]
v_mfma_f32_16x16x32_bf16 v[108:111], v[32:35], a[192:195], v[108:111]
ds_read_b128 a[192:195], v230 offset:16384
v_mfma_f32_16x16x32_bf16 v[108:111], v[36:39], a[196:199], v[108:111]
s_waitcnt lgkmcnt(5)
ds_read_b128 a[196:199], v230 offset:17408
v_mfma_f32_16x16x32_bf16 v[96:99], a[160:163], a[200:203], v[96:99]
buffer_store_dwordx2 v[86:87], v179, s[16:19], s61 offen sc1 nt
v_mfma_f32_16x16x32_bf16 v[96:99], a[176:179], a[204:207], v[96:99]
v_mfma_f32_16x16x32_bf16 v[100:103], a[164:167], a[200:203], v[100:103]
v_mfma_f32_16x16x32_bf16 v[100:103], a[180:183], a[204:207], v[100:103]
v_mfma_f32_16x16x32_bf16 v[104:107], a[168:171], a[200:203], v[104:107]
v_mfma_f32_16x16x32_bf16 v[104:107], a[184:187], a[204:207], v[104:107]
v_mfma_f32_16x16x32_bf16 v[108:111], v[40:43], a[200:203], v[108:111]
ds_read_b128 a[200:203], v230 offset:18432
v_mfma_f32_16x16x32_bf16 v[108:111], v[44:47], a[204:207], v[108:111]
s_waitcnt lgkmcnt(5)
ds_read_b128 a[204:207], v230 offset:19456
v_cvt_pk_bf16_f32 v112, v96, v97
v_mfma_f32_16x16x32_bf16 v[160:163], a[0:3], a[208:211], 0
v_cvt_pk_bf16_f32 v113, v98, v99
v_cvt_pk_bf16_f32 v114, v100, v101
v_mfma_f32_16x16x32_bf16 v[160:163], a[16:19], a[212:215], v[160:163]
v_cvt_pk_bf16_f32 v115, v102, v103
v_cvt_pk_bf16_f32 v116, v104, v105
v_mfma_f32_16x16x32_bf16 v[164:167], a[4:7], a[208:211], 0
v_cvt_pk_bf16_f32 v117, v106, v107
v_cvt_pk_bf16_f32 v118, v108, v109
v_mfma_f32_16x16x32_bf16 v[164:167], a[20:23], a[212:215], v[164:167]
v_cvt_pk_bf16_f32 v119, v110, v111
v_mfma_f32_16x16x32_bf16 v[168:171], a[8:11], a[208:211], 0
buffer_store_dwordx2 v[88:89], v180, s[16:19], s61 offen sc1 nt
v_mfma_f32_16x16x32_bf16 v[168:171], a[24:27], a[212:215], v[168:171]
v_mfma_f32_16x16x32_bf16 v[172:175], v[16:19], a[208:211], 0
ds_read_b128 a[208:211], v230 offset:20480
v_mfma_f32_16x16x32_bf16 v[172:175], v[20:23], a[212:215], v[172:175]
s_waitcnt lgkmcnt(5)
ds_read_b128 a[212:215], v230 offset:21504
v_mfma_f32_16x16x32_bf16 v[160:163], a[32:35], a[216:219], v[160:163]
v_mfma_f32_16x16x32_bf16 v[160:163], a[48:51], a[220:223], v[160:163]
v_mfma_f32_16x16x32_bf16 v[164:167], a[36:39], a[216:219], v[164:167]
buffer_store_dwordx2 v[90:91], v181, s[16:19], s61 offen sc1 nt
v_mfma_f32_16x16x32_bf16 v[164:167], a[52:55], a[220:223], v[164:167]
v_mfma_f32_16x16x32_bf16 v[168:171], a[40:43], a[216:219], v[168:171]
v_mfma_f32_16x16x32_bf16 v[168:171], a[56:59], a[220:223], v[168:171]
v_mfma_f32_16x16x32_bf16 v[172:175], v[24:27], a[216:219], v[172:175]
ds_read_b128 a[216:219], v230 offset:22528
v_mfma_f32_16x16x32_bf16 v[172:175], v[28:31], a[220:223], v[172:175]
ds_read_b128 a[220:223], v230 offset:23552
v_add_u32 v230, s51, v228
v_mfma_f32_16x16x32_bf16 v[144:147], v[0:3], v[112:115], 0
s_mov_b32 s51, s53
buffer_store_dwordx2 v[92:93], v182, s[16:19], s61 offen sc1 nt
v_mfma_f32_16x16x32_bf16 v[144:147], v[4:7], v[116:119], v[144:147]
s_mov_b32 s53, s55
v_mfma_f32_16x16x32_bf16 v[148:151], v[8:11], v[112:115], 0
v_mfma_f32_16x16x32_bf16 v[148:151], v[12:15], v[116:119], v[148:151]
v_mfma_f32_16x16x32_bf16 v[152:155], v[64:67], v[112:115], 0
v_mfma_f32_16x16x32_bf16 v[152:155], v[68:71], v[116:119], v[152:155]
v_mfma_f32_16x16x32_bf16 v[156:159], v[72:75], v[112:115], 0
buffer_store_dwordx2 v[94:95], v183, s[16:19], s61 offen sc1 nt
v_mfma_f32_16x16x32_bf16 v[156:159], v[76:79], v[116:119], v[156:159]
s_waitcnt lgkmcnt(6)
v_mfma_f32_16x16x32_bf16 v[160:163], a[64:67], a[192:195], v[160:163]
v_mfma_f32_16x16x32_bf16 v[160:163], a[80:83], a[196:199], v[160:163]
v_mfma_f32_16x16x32_bf16 v[164:167], a[68:71], a[192:195], v[164:167]
v_mfma_f32_16x16x32_bf16 v[164:167], a[84:87], a[196:199], v[164:167]
v_mfma_f32_16x16x32_bf16 v[168:171], a[72:75], a[192:195], v[168:171]
buffer_store_dwordx2 v[192:193], v184, s[16:19], s61 offen sc1 nt
v_mfma_f32_16x16x32_bf16 v[168:171], a[88:91], a[196:199], v[168:171]
v_mfma_f32_16x16x32_bf16 v[172:175], v[208:211], a[192:195], v[172:175]
ds_read_b128 a[192:195], v230 offset:0
v_mfma_f32_16x16x32_bf16 v[172:175], v[212:215], a[196:199], v[172:175]
s_waitcnt lgkmcnt(5)
ds_read_b128 a[196:199], v230 offset:1024
v_mfma_f32_16x16x32_bf16 v[160:163], a[96:99], a[200:203], v[160:163]
v_mfma_f32_16x16x32_bf16 v[160:163], a[112:115], a[204:207], v[160:163]
v_mfma_f32_16x16x32_bf16 v[164:167], a[100:103], a[200:203], v[164:167]
buffer_store_dwordx2 v[194:195], v185, s[16:19], s61 offen sc1 nt
v_mfma_f32_16x16x32_bf16 v[164:167], a[116:119], a[204:207], v[164:167]
v_mfma_f32_16x16x32_bf16 v[168:171], a[104:107], a[200:203], v[168:171]
v_mfma_f32_16x16x32_bf16 v[168:171], a[120:123], a[204:207], v[168:171]
v_mfma_f32_16x16x32_bf16 v[172:175], v[216:219], a[200:203], v[172:175]
ds_read_b128 a[200:203], v230 offset:2048
v_mfma_f32_16x16x32_bf16 v[172:175], v[220:223], a[204:207], v[172:175]
s_waitcnt lgkmcnt(5)
ds_read_b128 a[204:207], v230 offset:3072
v_mfma_f32_16x16x32_bf16 v[160:163], a[128:131], a[208:211], v[160:163]
buffer_store_dwordx2 v[196:197], v186, s[16:19], s61 offen sc1 nt
v_mfma_f32_16x16x32_bf16 v[160:163], a[144:147], a[212:215], v[160:163]
v_mfma_f32_16x16x32_bf16 v[164:167], a[132:135], a[208:211], v[164:167]
v_mfma_f32_16x16x32_bf16 v[164:167], a[148:151], a[212:215], v[164:167]
v_mfma_f32_16x16x32_bf16 v[168:171], a[136:139], a[208:211], v[168:171]
v_mfma_f32_16x16x32_bf16 v[168:171], a[152:155], a[212:215], v[168:171]
v_mfma_f32_16x16x32_bf16 v[172:175], v[32:35], a[208:211], v[172:175]
ds_read_b128 a[208:211], v230 offset:4096
v_mfma_f32_16x16x32_bf16 v[172:175], v[36:39], a[212:215], v[172:175]
s_waitcnt lgkmcnt(5)
ds_read_b128 a[212:215], v230 offset:5120
v_mfma_f32_16x16x32_bf16 v[160:163], a[160:163], a[216:219], v[160:163]
buffer_store_dwordx2 v[198:199], v187, s[16:19], s61 offen sc1 nt
v_mfma_f32_16x16x32_bf16 v[160:163], a[176:179], a[220:223], v[160:163]
v_mfma_f32_16x16x32_bf16 v[164:167], a[164:167], a[216:219], v[164:167]
v_mfma_f32_16x16x32_bf16 v[164:167], a[180:183], a[220:223], v[164:167]
v_mfma_f32_16x16x32_bf16 v[168:171], a[168:171], a[216:219], v[168:171]
v_mfma_f32_16x16x32_bf16 v[168:171], a[184:187], a[220:223], v[168:171]
v_mfma_f32_16x16x32_bf16 v[172:175], v[40:43], a[216:219], v[172:175]
ds_read_b128 a[216:219], v230 offset:6144
v_mfma_f32_16x16x32_bf16 v[172:175], v[44:47], a[220:223], v[172:175]
s_waitcnt lgkmcnt(5)
ds_read_b128 a[220:223], v230 offset:7168
v_mfma_f32_16x16x32_bf16 v[96:99], a[0:3], a[192:195], 0
buffer_store_dwordx2 v[200:201], v188, s[16:19], s61 offen sc1 nt
v_mfma_f32_16x16x32_bf16 v[96:99], a[16:19], a[196:199], v[96:99]
v_mfma_f32_16x16x32_bf16 v[100:103], a[4:7], a[192:195], 0
v_mfma_f32_16x16x32_bf16 v[100:103], a[20:23], a[196:199], v[100:103]
v_cvt_pk_bf16_f32 v120, v160, v161
v_cvt_pk_bf16_f32 v121, v162, v163
v_mfma_f32_16x16x32_bf16 v[104:107], a[8:11], a[192:195], 0
v_cvt_pk_bf16_f32 v122, v164, v165
v_cvt_pk_bf16_f32 v123, v166, v167
v_mfma_f32_16x16x32_bf16 v[104:107], a[24:27], a[196:199], v[104:107]
v_cvt_pk_bf16_f32 v124, v168, v169
v_cvt_pk_bf16_f32 v125, v170, v171
v_mfma_f32_16x16x32_bf16 v[108:111], v[16:19], a[192:195], 0
v_cvt_pk_bf16_f32 v126, v172, v173
v_cvt_pk_bf16_f32 v127, v174, v175
v_mfma_f32_16x16x32_bf16 v[108:111], v[20:23], a[196:199], v[108:111]
s_waitcnt lgkmcnt(4)
ds_read_b128 a[192:195], v230 offset:8192
v_mfma_f32_16x16x32_bf16 v[96:99], a[32:35], a[200:203], v[96:99]
ds_read_b128 a[196:199], v230 offset:9216
v_mfma_f32_16x16x32_bf16 v[96:99], a[48:51], a[204:207], v[96:99]
buffer_store_dwordx2 v[202:203], v189, s[16:19], s61 offen sc1 nt
v_mfma_f32_16x16x32_bf16 v[100:103], a[36:39], a[200:203], v[100:103]
v_mfma_f32_16x16x32_bf16 v[100:103], a[52:55], a[204:207], v[100:103]
v_mfma_f32_16x16x32_bf16 v[104:107], a[40:43], a[200:203], v[104:107]
v_mfma_f32_16x16x32_bf16 v[104:107], a[56:59], a[204:207], v[104:107]
v_mfma_f32_16x16x32_bf16 v[108:111], v[24:27], a[200:203], v[108:111]
ds_read_b128 a[200:203], v230 offset:10240
v_mfma_f32_16x16x32_bf16 v[108:111], v[28:31], a[204:207], v[108:111]
ds_read_b128 a[204:207], v230 offset:11264
v_mfma_f32_16x16x32_bf16 v[48:51], v[0:3], v[120:123], 0
buffer_store_dwordx2 v[204:205], v190, s[16:19], s61 offen sc1 nt
v_mfma_f32_16x16x32_bf16 v[48:51], v[4:7], v[124:127], v[48:51]
v_mfma_f32_16x16x32_bf16 v[52:55], v[8:11], v[120:123], 0
v_mfma_f32_16x16x32_bf16 v[52:55], v[12:15], v[124:127], v[52:55]
v_mfma_f32_16x16x32_bf16 v[56:59], v[64:67], v[120:123], 0
v_mfma_f32_16x16x32_bf16 v[56:59], v[68:71], v[124:127], v[56:59]
v_mfma_f32_16x16x32_bf16 v[60:63], v[72:75], v[120:123], 0
buffer_store_dwordx2 v[206:207], v191, s[16:19], s61 offen sc1 nt
v_mfma_f32_16x16x32_bf16 v[60:63], v[76:79], v[124:127], v[60:63]
s_waitcnt lgkmcnt(6)
s_add_u32 s61, s61, 128
v_cvt_pk_bf16_f32 v80, v144, v48
v_cvt_pk_bf16_f32 v82, v145, v49
v_mfma_f32_16x16x32_bf16 v[96:99], a[64:67], a[208:211], v[96:99]
s_sub_u32 s60, s60, 1
v_cvt_pk_bf16_f32 v84, v146, v50
v_cvt_pk_bf16_f32 v86, v147, v51
v_mfma_f32_16x16x32_bf16 v[96:99], a[80:83], a[212:215], v[96:99]
v_cvt_pk_bf16_f32 v88, v148, v52
v_cvt_pk_bf16_f32 v90, v149, v53
v_mfma_f32_16x16x32_bf16 v[100:103], a[68:71], a[208:211], v[100:103]
v_cvt_pk_bf16_f32 v92, v150, v54
v_cvt_pk_bf16_f32 v94, v151, v55
v_mfma_f32_16x16x32_bf16 v[100:103], a[84:87], a[212:215], v[100:103]
v_cvt_pk_bf16_f32 v192, v152, v56
v_cvt_pk_bf16_f32 v194, v153, v57
v_mfma_f32_16x16x32_bf16 v[104:107], a[72:75], a[208:211], v[104:107]
v_cvt_pk_bf16_f32 v196, v154, v58
v_cvt_pk_bf16_f32 v198, v155, v59
v_mfma_f32_16x16x32_bf16 v[104:107], a[88:91], a[212:215], v[104:107]
v_cvt_pk_bf16_f32 v200, v156, v60
v_cvt_pk_bf16_f32 v202, v157, v61
v_mfma_f32_16x16x32_bf16 v[108:111], v[208:211], a[208:211], v[108:111]
ds_read_b128 a[208:211], v230 offset:12288
v_cvt_pk_bf16_f32 v204, v158, v62
v_mfma_f32_16x16x32_bf16 v[108:111], v[212:215], a[212:215], v[108:111]
s_waitcnt lgkmcnt(5)
ds_read_b128 a[212:215], v230 offset:13312
v_cvt_pk_bf16_f32 v206, v159, v63
v_mfma_f32_16x16x32_bf16 v[96:99], a[96:99], a[216:219], v[96:99]
v_mfma_f32_16x16x32_bf16 v[96:99], a[112:115], a[220:223], v[96:99]
v_mfma_f32_16x16x32_bf16 v[100:103], a[100:103], a[216:219], v[100:103]
v_mfma_f32_16x16x32_bf16 v[100:103], a[116:119], a[220:223], v[100:103]
v_mfma_f32_16x16x32_bf16 v[104:107], a[104:107], a[216:219], v[104:107]
buffer_load_dwordx4 v228, s[20:23], s65 offen offset:0 sc1 lds
v_mfma_f32_16x16x32_bf16 v[104:107], a[120:123], a[220:223], v[104:107]
v_mfma_f32_16x16x32_bf16 v[108:111], v[216:219], a[216:219], v[108:111]
ds_read_b128 a[216:219], v230 offset:14336
v_mfma_f32_16x16x32_bf16 v[108:111], v[220:223], a[220:223], v[108:111]
s_waitcnt lgkmcnt(5)
ds_read_b128 a[220:223], v230 offset:15360
v_mfma_f32_16x16x32_bf16 v[96:99], a[128:131], a[192:195], v[96:99]
v_mfma_f32_16x16x32_bf16 v[96:99], a[144:147], a[196:199], v[96:99]
v_mfma_f32_16x16x32_bf16 v[100:103], a[132:135], a[192:195], v[100:103]
v_mfma_f32_16x16x32_bf16 v[100:103], a[148:151], a[196:199], v[100:103]
v_mfma_f32_16x16x32_bf16 v[104:107], a[136:139], a[192:195], v[104:107]
buffer_load_dwordx4 v228, s[20:23], s65 offen offset:1024 sc1 lds
v_mfma_f32_16x16x32_bf16 v[104:107], a[152:155], a[196:199], v[104:107]
s_add_u32 m0, s55, s34
s_mov_b32 s55, s62
v_mfma_f32_16x16x32_bf16 v[108:111], v[32:35], a[192:195], v[108:111]
ds_read_b128 a[192:195], v230 offset:16384
v_mfma_f32_16x16x32_bf16 v[108:111], v[36:39], a[196:199], v[108:111]
s_waitcnt lgkmcnt(5)
ds_read_b128 a[196:199], v230 offset:17408
v_mfma_f32_16x16x32_bf16 v[96:99], a[160:163], a[200:203], v[96:99]
v_mfma_f32_16x16x32_bf16 v[96:99], a[176:179], a[204:207], v[96:99]
v_mfma_f32_16x16x32_bf16 v[100:103], a[164:167], a[200:203], v[100:103]
v_mfma_f32_16x16x32_bf16 v[100:103], a[180:183], a[204:207], v[100:103]
v_mfma_f32_16x16x32_bf16 v[104:107], a[168:171], a[200:203], v[104:107]
buffer_load_dwordx4 v228, s[20:23], s63 offen offset:0 sc1 lds
v_mfma_f32_16x16x32_bf16 v[104:107], a[184:187], a[204:207], v[104:107]
v_mfma_f32_16x16x32_bf16 v[108:111], v[40:43], a[200:203], v[108:111]
ds_read_b128 a[200:203], v230 offset:18432
v_mfma_f32_16x16x32_bf16 v[108:111], v[44:47], a[204:207], v[108:111]
s_waitcnt lgkmcnt(5)
v_cvt_pk_bf16_f32 v112, v96, v97
v_cvt_pk_bf16_f32 v113, v98, v99
v_mfma_f32_16x16x32_bf16 v[160:163], a[0:3], a[208:211], 0
v_cvt_pk_bf16_f32 v114, v100, v101
v_cvt_pk_bf16_f32 v115, v102, v103
v_mfma_f32_16x16x32_bf16 v[160:163], a[16:19], a[212:215], v[160:163]
v_cvt_pk_bf16_f32 v116, v104, v105
v_cvt_pk_bf16_f32 v117, v106, v107
v_mfma_f32_16x16x32_bf16 v[164:167], a[4:7], a[208:211], 0
v_cvt_pk_bf16_f32 v118, v108, v109
v_cvt_pk_bf16_f32 v119, v110, v111
v_mfma_f32_16x16x32_bf16 v[164:167], a[20:23], a[212:215], v[164:167]
ds_read_b128 a[204:207], v230 offset:19456
v_mfma_f32_16x16x32_bf16 v[168:171], a[8:11], a[208:211], 0
buffer_load_dwordx4 v228, s[20:23], s63 offen offset:1024 sc1 lds
v_mfma_f32_16x16x32_bf16 v[168:171], a[24:27], a[212:215], v[168:171]
v_mfma_f32_16x16x32_bf16 v[172:175], v[16:19], a[208:211], 0
ds_read_b128 a[208:211], v230 offset:20480
v_mfma_f32_16x16x32_bf16 v[172:175], v[20:23], a[212:215], v[172:175]
s_waitcnt lgkmcnt(5)
ds_read_b128 a[212:215], v230 offset:21504
v_mfma_f32_16x16x32_bf16 v[160:163], a[32:35], a[216:219], v[160:163]
v_mfma_f32_16x16x32_bf16 v[160:163], a[48:51], a[220:223], v[160:163]
v_mfma_f32_16x16x32_bf16 v[164:167], a[36:39], a[216:219], v[164:167]
v_mfma_f32_16x16x32_bf16 v[164:167], a[52:55], a[220:223], v[164:167]
v_mfma_f32_16x16x32_bf16 v[168:171], a[40:43], a[216:219], v[168:171]
buffer_load_dwordx4 v228, s[20:23], s63 offen offset:2048 sc1 lds
v_mfma_f32_16x16x32_bf16 v[168:171], a[56:59], a[220:223], v[168:171]
v_mfma_f32_16x16x32_bf16 v[172:175], v[24:27], a[216:219], v[172:175]
ds_read_b128 a[216:219], v230 offset:22528
v_mfma_f32_16x16x32_bf16 v[172:175], v[28:31], a[220:223], v[172:175]
ds_read_b128 a[220:223], v230 offset:23552
v_mfma_f32_16x16x32_bf16 v[144:147], v[0:3], v[112:115], 0
v_mfma_f32_16x16x32_bf16 v[144:147], v[4:7], v[116:119], v[144:147]
v_mfma_f32_16x16x32_bf16 v[148:151], v[8:11], v[112:115], 0
v_mfma_f32_16x16x32_bf16 v[148:151], v[12:15], v[116:119], v[148:151]
v_mfma_f32_16x16x32_bf16 v[152:155], v[64:67], v[112:115], 0
buffer_load_dwordx4 v228, s[20:23], s63 offen offset:3072 sc1 lds
v_mfma_f32_16x16x32_bf16 v[152:155], v[68:71], v[116:119], v[152:155]
s_add_u32 m0, m0, 4096
s_add_u32 s65, s63, 4096
v_mfma_f32_16x16x32_bf16 v[156:159], v[72:75], v[112:115], 0
s_add_u32 s63, s63, 24576
v_mfma_f32_16x16x32_bf16 v[156:159], v[76:79], v[116:119], v[156:159]
s_waitcnt lgkmcnt(6)
v_mfma_f32_16x16x32_bf16 v[160:163], a[64:67], a[192:195], v[160:163]
s_waitcnt vmcnt(26) lgkmcnt(0)
s_barrier
v_add_u32 v230, s52, v228
v_mfma_f32_16x16x32_bf16 v[160:163], a[80:83], a[196:199], v[160:163]
s_mov_b32 s52, s54
s_mov_b32 s54, s64
v_mfma_f32_16x16x32_bf16 v[164:167], a[68:71], a[192:195], v[164:167]
v_mfma_f32_16x16x32_bf16 v[164:167], a[84:87], a[196:199], v[164:167]
v_mfma_f32_16x16x32_bf16 v[168:171], a[72:75], a[192:195], v[168:171]
buffer_load_dwordx4 v228, s[20:23], s65 offen offset:0 sc1 lds
v_mfma_f32_16x16x32_bf16 v[168:171], a[88:91], a[196:199], v[168:171]
v_mfma_f32_16x16x32_bf16 v[172:175], v[208:211], a[192:195], v[172:175]
ds_read_b128 a[192:195], v230 offset:0
v_mfma_f32_16x16x32_bf16 v[172:175], v[212:215], a[196:199], v[172:175]
ds_read_b128 a[196:199], v230 offset:1024
v_mfma_f32_16x16x32_bf16 v[160:163], a[96:99], a[200:203], v[160:163]
v_mfma_f32_16x16x32_bf16 v[160:163], a[112:115], a[204:207], v[160:163]
v_mfma_f32_16x16x32_bf16 v[164:167], a[100:103], a[200:203], v[164:167]
v_mfma_f32_16x16x32_bf16 v[164:167], a[116:119], a[204:207], v[164:167]
v_mfma_f32_16x16x32_bf16 v[168:171], a[104:107], a[200:203], v[168:171]
buffer_load_dwordx4 v228, s[20:23], s65 offen offset:1024 sc1 lds
v_mfma_f32_16x16x32_bf16 v[168:171], a[120:123], a[204:207], v[168:171]
v_mfma_f32_16x16x32_bf16 v[172:175], v[216:219], a[200:203], v[172:175]
ds_read_b128 a[200:203], v230 offset:2048
v_mfma_f32_16x16x32_bf16 v[172:175], v[220:223], a[204:207], v[172:175]
ds_read_b128 a[204:207], v230 offset:3072
v_mfma_f32_16x16x32_bf16 v[160:163], a[128:131], a[208:211], v[160:163]
v_mfma_f32_16x16x32_bf16 v[160:163], a[144:147], a[212:215], v[160:163]
v_mfma_f32_16x16x32_bf16 v[164:167], a[132:135], a[208:211], v[164:167]
v_mfma_f32_16x16x32_bf16 v[164:167], a[148:151], a[212:215], v[164:167]
v_mfma_f32_16x16x32_bf16 v[168:171], a[136:139], a[208:211], v[168:171]
v_mfma_f32_16x16x32_bf16 v[168:171], a[152:155], a[212:215], v[168:171]
v_mfma_f32_16x16x32_bf16 v[172:175], v[32:35], a[208:211], v[172:175]
ds_read_b128 a[208:211], v230 offset:4096
v_mfma_f32_16x16x32_bf16 v[172:175], v[36:39], a[212:215], v[172:175]
ds_read_b128 a[212:215], v230 offset:5120
v_mfma_f32_16x16x32_bf16 v[160:163], a[160:163], a[216:219], v[160:163]
v_mfma_f32_16x16x32_bf16 v[160:163], a[176:179], a[220:223], v[160:163]
v_mfma_f32_16x16x32_bf16 v[164:167], a[164:167], a[216:219], v[164:167]
v_mfma_f32_16x16x32_bf16 v[164:167], a[180:183], a[220:223], v[164:167]
v_mfma_f32_16x16x32_bf16 v[168:171], a[168:171], a[216:219], v[168:171]
v_mfma_f32_16x16x32_bf16 v[168:171], a[184:187], a[220:223], v[168:171]
v_mfma_f32_16x16x32_bf16 v[172:175], v[40:43], a[216:219], v[172:175]
v_mfma_f32_16x16x32_bf16 v[172:175], v[44:47], a[220:223], v[172:175]
s_cmp_lg_u32 s60, 0
s_cbranch_scc1 L_loop
s_waitcnt lgkmcnt(4)
v_mfma_f32_16x16x32_bf16 v[96:99], a[0:3], a[192:195], 0
ds_read_b128 a[216:219], v230 offset:6144
v_lshrrev_b32 v247, 1, v247
v_mfma_f32_16x16x32_bf16 v[96:99], a[16:19], a[196:199], v[96:99]
ds_read_b128 a[220:223], v230 offset:7168
v_mfma_f32_16x16x32_bf16 v[100:103], a[4:7], a[192:195], 0
v_mfma_f32_16x16x32_bf16 v[100:103], a[20:23], a[196:199], v[100:103]
v_cvt_pk_bf16_f32 v120, v160, v161
v_cvt_pk_bf16_f32 v121, v162, v163
v_mfma_f32_16x16x32_bf16 v[104:107], a[8:11], a[192:195], 0
v_cvt_pk_bf16_f32 v122, v164, v165
v_cvt_pk_bf16_f32 v123, v166, v167
v_mfma_f32_16x16x32_bf16 v[104:107], a[24:27], a[196:199], v[104:107]
v_cvt_pk_bf16_f32 v124, v168, v169
v_cvt_pk_bf16_f32 v125, v170, v171
v_mfma_f32_16x16x32_bf16 v[108:111], v[16:19], a[192:195], 0
v_cvt_pk_bf16_f32 v126, v172, v173
v_cvt_pk_bf16_f32 v127, v174, v175
v_mfma_f32_16x16x32_bf16 v[108:111], v[20:23], a[196:199], v[108:111]
s_waitcnt lgkmcnt(4)
ds_read_b128 a[192:195], v230 offset:8192
v_mfma_f32_16x16x32_bf16 v[96:99], a[32:35], a[200:203], v[96:99]
ds_read_b128 a[196:199], v230 offset:9216
v_mfma_f32_16x16x32_bf16 v[96:99], a[48:51], a[204:207], v[96:99]
v_mfma_f32_16x16x32_bf16 v[100:103], a[36:39], a[200:203], v[100:103]
v_mfma_f32_16x16x32_bf16 v[100:103], a[52:55], a[204:207], v[100:103]
v_mfma_f32_16x16x32_bf16 v[104:107], a[40:43], a[200:203], v[104:107]
v_mfma_f32_16x16x32_bf16 v[104:107], a[56:59], a[204:207], v[104:107]
v_mfma_f32_16x16x32_bf16 v[108:111], v[24:27], a[200:203], v[108:111]
ds_read_b128 a[200:203], v230 offset:10240
v_mfma_f32_16x16x32_bf16 v[108:111], v[28:31], a[204:207], v[108:111]
ds_read_b128 a[204:207], v230 offset:11264
v_mfma_f32_16x16x32_bf16 v[48:51], v[0:3], v[120:123], 0
v_mfma_f32_16x16x32_bf16 v[48:51], v[4:7], v[124:127], v[48:51]
v_mfma_f32_16x16x32_bf16 v[52:55], v[8:11], v[120:123], 0
v_mfma_f32_16x16x32_bf16 v[52:55], v[12:15], v[124:127], v[52:55]
v_mfma_f32_16x16x32_bf16 v[56:59], v[64:67], v[120:123], 0
v_mfma_f32_16x16x32_bf16 v[56:59], v[68:71], v[124:127], v[56:59]
v_mfma_f32_16x16x32_bf16 v[60:63], v[72:75], v[120:123], 0
v_mfma_f32_16x16x32_bf16 v[60:63], v[76:79], v[124:127], v[60:63]
s_waitcnt lgkmcnt(6)
v_mfma_f32_16x16x32_bf16 v[96:99], a[64:67], a[208:211], v[96:99]
v_mfma_f32_16x16x32_bf16 v[96:99], a[80:83], a[212:215], v[96:99]
v_cvt_pk_bf16_f32 v81, v144, v48
v_cvt_pk_bf16_f32 v83, v145, v49
v_mfma_f32_16x16x32_bf16 v[100:103], a[68:71], a[208:211], v[100:103]
v_cvt_pk_bf16_f32 v85, v146, v50
v_cvt_pk_bf16_f32 v87, v147, v51
v_mfma_f32_16x16x32_bf16 v[100:103], a[84:87], a[212:215], v[100:103]
v_cvt_pk_bf16_f32 v89, v148, v52
v_cvt_pk_bf16_f32 v91, v149, v53
v_mfma_f32_16x16x32_bf16 v[104:107], a[72:75], a[208:211], v[104:107]
v_cvt_pk_bf16_f32 v93, v150, v54
v_cvt_pk_bf16_f32 v95, v151, v55
v_mfma_f32_16x16x32_bf16 v[104:107], a[88:91], a[212:215], v[104:107]
v_cvt_pk_bf16_f32 v193, v152, v56
v_cvt_pk_bf16_f32 v195, v153, v57
v_mfma_f32_16x16x32_bf16 v[108:111], v[208:211], a[208:211], v[108:111]
ds_read_b128 a[208:211], v230 offset:12288
v_cvt_pk_bf16_f32 v197, v154, v58
v_mfma_f32_16x16x32_bf16 v[108:111], v[212:215], a[212:215], v[108:111]
s_waitcnt lgkmcnt(5)
ds_read_b128 a[212:215], v230 offset:13312
v_cvt_pk_bf16_f32 v199, v155, v59
v_mfma_f32_16x16x32_bf16 v[96:99], a[96:99], a[216:219], v[96:99]
v_cvt_pk_bf16_f32 v201, v156, v60
v_cvt_pk_bf16_f32 v203, v157, v61
v_mfma_f32_16x16x32_bf16 v[96:99], a[112:115], a[220:223], v[96:99]
v_cvt_pk_bf16_f32 v205, v158, v62
v_cvt_pk_bf16_f32 v207, v159, v63
v_mfma_f32_16x16x32_bf16 v[100:103], a[100:103], a[216:219], v[100:103]
buffer_store_dwordx2 v[80:81], v176, s[16:19], s61 offen sc1 nt
v_mfma_f32_16x16x32_bf16 v[100:103], a[116:119], a[220:223], v[100:103]
s_nop 0
v_sub_u32 v176, v176, v247
v_mfma_f32_16x16x32_bf16 v[104:107], a[104:107], a[216:219], v[104:107]
v_mfma_f32_16x16x32_bf16 v[104:107], a[120:123], a[220:223], v[104:107]
v_mfma_f32_16x16x32_bf16 v[108:111], v[216:219], a[216:219], v[108:111]
ds_read_b128 a[216:219], v230 offset:14336
v_mfma_f32_16x16x32_bf16 v[108:111], v[220:223], a[220:223], v[108:111]
s_waitcnt lgkmcnt(5)
ds_read_b128 a[220:223], v230 offset:15360
v_mfma_f32_16x16x32_bf16 v[96:99], a[128:131], a[192:195], v[96:99]
buffer_store_dwordx2 v[82:83], v177, s[16:19], s61 offen sc1 nt
v_mfma_f32_16x16x32_bf16 v[96:99], a[144:147], a[196:199], v[96:99]
s_nop 0
v_sub_u32 v177, v177, v247
v_mfma_f32_16x16x32_bf16 v[100:103], a[132:135], a[192:195], v[100:103]
v_mfma_f32_16x16x32_bf16 v[100:103], a[148:151], a[196:199], v[100:103]
v_mfma_f32_16x16x32_bf16 v[104:107], a[136:139], a[192:195], v[104:107]
v_mfma_f32_16x16x32_bf16 v[104:107], a[152:155], a[196:199], v[104:107]
buffer_store_dwordx2 v[84:85], v178, s[16:19], s61 offen sc1 nt
v_mfma_f32_16x16x32_bf16 v[108:111], v[32:35], a[192:195], v[108:111]
ds_read_b128 a[192:195], v230 offset:16384
v_sub_u32 v178, v178, v247
v_mfma_f32_16x16x32_bf16 v[108:111], v[36:39], a[196:199], v[108:111]
s_waitcnt lgkmcnt(5)
ds_read_b128 a[196:199], v230 offset:17408
v_mfma_f32_16x16x32_bf16 v[96:99], a[160:163], a[200:203], v[96:99]
v_mfma_f32_16x16x32_bf16 v[96:99], a[176:179], a[204:207], v[96:99]
v_mfma_f32_16x16x32_bf16 v[100:103], a[164:167], a[200:203], v[100:103]
buffer_store_dwordx2 v[86:87], v179, s[16:19], s61 offen sc1 nt
v_mfma_f32_16x16x32_bf16 v[100:103], a[180:183], a[204:207], v[100:103]
s_nop 0
v_sub_u32 v179, v179, v247
v_mfma_f32_16x16x32_bf16 v[104:107], a[168:171], a[200:203], v[104:107]
v_mfma_f32_16x16x32_bf16 v[104:107], a[184:187], a[204:207], v[104:107]
v_mfma_f32_16x16x32_bf16 v[108:111], v[40:43], a[200:203], v[108:111]
ds_read_b128 a[200:203], v230 offset:18432
v_cvt_pk_bf16_f32 v112, v96, v97
v_mfma_f32_16x16x32_bf16 v[108:111], v[44:47], a[204:207], v[108:111]
s_waitcnt lgkmcnt(5)
v_cvt_pk_bf16_f32 v113, v98, v99
v_cvt_pk_bf16_f32 v114, v100, v101
v_mfma_f32_16x16x32_bf16 v[160:163], a[0:3], a[208:211], 0
v_cvt_pk_bf16_f32 v115, v102, v103
v_cvt_pk_bf16_f32 v116, v104, v105
v_mfma_f32_16x16x32_bf16 v[160:163], a[16:19], a[212:215], v[160:163]
v_cvt_pk_bf16_f32 v117, v106, v107
ds_read_b128 a[204:207], v230 offset:19456
v_mfma_f32_16x16x32_bf16 v[164:167], a[4:7], a[208:211], 0
v_cvt_pk_bf16_f32 v118, v108, v109
v_cvt_pk_bf16_f32 v119, v110, v111
v_mfma_f32_16x16x32_bf16 v[164:167], a[20:23], a[212:215], v[164:167]
buffer_store_dwordx2 v[88:89], v180, s[16:19], s61 offen sc1 nt
v_mfma_f32_16x16x32_bf16 v[168:171], a[8:11], a[208:211], 0
s_nop 0
v_sub_u32 v180, v180, v247
v_mfma_f32_16x16x32_bf16 v[168:171], a[24:27], a[212:215], v[168:171]
v_mfma_f32_16x16x32_bf16 v[172:175], v[16:19], a[208:211], 0
ds_read_b128 a[208:211], v230 offset:20480
v_mfma_f32_16x16x32_bf16 v[172:175], v[20:23], a[212:215], v[172:175]
s_waitcnt lgkmcnt(5)
ds_read_b128 a[212:215], v230 offset:21504
v_mfma_f32_16x16x32_bf16 v[160:163], a[32:35], a[216:219], v[160:163]
buffer_store_dwordx2 v[90:91], v181, s[16:19], s61 offen sc1 nt
v_mfma_f32_16x16x32_bf16 v[160:163], a[48:51], a[220:223], v[160:163]
s_nop 0
v_sub_u32 v181, v181, v247
v_mfma_f32_16x16x32_bf16 v[164:167], a[36:39], a[216:219], v[164:167]
v_mfma_f32_16x16x32_bf16 v[164:167], a[52:55], a[220:223], v[164:167]
v_mfma_f32_16x16x32_bf16 v[168:171], a[40:43], a[216:219], v[168:171]
v_mfma_f32_16x16x32_bf16 v[168:171], a[56:59], a[220:223], v[168:171]
buffer_store_dwordx2 v[92:93], v182, s[16:19], s61 offen sc1 nt
v_mfma_f32_16x16x32_bf16 v[172:175], v[24:27], a[216:219], v[172:175]
ds_read_b128 a[216:219], v230 offset:22528
v_sub_u32 v182, v182, v247
v_mfma_f32_16x16x32_bf16 v[172:175], v[28:31], a[220:223], v[172:175]
ds_read_b128 a[220:223], v230 offset:23552
v_add_u32 v230, s51, v228
v_mfma_f32_16x16x32_bf16 v[144:147], v[0:3], v[112:115], 0
v_mfma_f32_16x16x32_bf16 v[144:147], v[4:7], v[116:119], v[144:147]
v_mfma_f32_16x16x32_bf16 v[148:151], v[8:11], v[112:115], 0
buffer_store_dwordx2 v[94:95], v183, s[16:19], s61 offen sc1 nt
v_mfma_f32_16x16x32_bf16 v[148:151], v[12:15], v[116:119], v[148:151]
s_nop 0
v_sub_u32 v183, v183, v247
v_mfma_f32_16x16x32_bf16 v[152:155], v[64:67], v[112:115], 0
v_mfma_f32_16x16x32_bf16 v[152:155], v[68:71], v[116:119], v[152:155]
v_mfma_f32_16x16x32_bf16 v[156:159], v[72:75], v[112:115], 0
v_mfma_f32_16x16x32_bf16 v[156:159], v[76:79], v[116:119], v[156:159]
s_waitcnt lgkmcnt(6)
buffer_store_dwordx2 v[192:193], v184, s[16:19], s61 offen sc1 nt
v_mfma_f32_16x16x32_bf16 v[160:163], a[64:67], a[192:195], v[160:163]
s_nop 0
v_sub_u32 v184, v184, v247
v_mfma_f32_16x16x32_bf16 v[160:163], a[80:83], a[196:199], v[160:163]
v_mfma_f32_16x16x32_bf16 v[164:167], a[68:71], a[192:195], v[164:167]
v_mfma_f32_16x16x32_bf16 v[164:167], a[84:87], a[196:199], v[164:167]
v_mfma_f32_16x16x32_bf16 v[168:171], a[72:75], a[192:195], v[168:171]
buffer_store_dwordx2 v[194:195], v185, s[16:19], s61 offen sc1 nt
v_mfma_f32_16x16x32_bf16 v[168:171], a[88:91], a[196:199], v[168:171]
s_nop 0
v_sub_u32 v185, v185, v247
v_mfma_f32_16x16x32_bf16 v[172:175], v[208:211], a[192:195], v[172:175]
ds_read_b128 a[192:195], v230 offset:0
v_mfma_f32_16x16x32_bf16 v[172:175], v[212:215], a[196:199], v[172:175]
s_waitcnt lgkmcnt(5)
ds_read_b128 a[196:199], v230 offset:1024
v_mfma_f32_16x16x32_bf16 v[160:163], a[96:99], a[200:203], v[160:163]
v_mfma_f32_16x16x32_bf16 v[160:163], a[112:115], a[204:207], v[160:163]
buffer_store_dwordx2 v[196:197], v186, s[16:19], s61 offen sc1 nt
v_mfma_f32_16x16x32_bf16 v[164:167], a[100:103], a[200:203], v[164:167]
s_nop 0
v_sub_u32 v186, v186, v247
v_mfma_f32_16x16x32_bf16 v[164:167], a[116:119], a[204:207], v[164:167]
v_mfma_f32_16x16x32_bf16 v[168:171], a[104:107], a[200:203], v[168:171]
v_mfma_f32_16x16x32_bf16 v[168:171], a[120:123], a[204:207], v[168:171]
v_mfma_f32_16x16x32_bf16 v[172:175], v[216:219], a[200:203], v[172:175]
ds_read_b128 a[200:203], v230 offset:2048
v_mfma_f32_16x16x32_bf16 v[172:175], v[220:223], a[204:207], v[172:175]
s_waitcnt lgkmcnt(5)
ds_read_b128 a[204:207], v230 offset:3072
v_mfma_f32_16x16x32_bf16 v[160:163], a[128:131], a[208:211], v[160:163]
buffer_store_dwordx2 v[198:199], v187, s[16:19], s61 offen sc1 nt
v_mfma_f32_16x16x32_bf16 v[160:163], a[144:147], a[212:215], v[160:163]
s_nop 0
v_sub_u32 v187, v187, v247
v_mfma_f32_16x16x32_bf16 v[164:167], a[132:135], a[208:211], v[164:167]
v_mfma_f32_16x16x32_bf16 v[164:167], a[148:151], a[212:215], v[164:167]
v_mfma_f32_16x16x32_bf16 v[168:171], a[136:139], a[208:211], v[168:171]
v_mfma_f32_16x16x32_bf16 v[168:171], a[152:155], a[212:215], v[168:171]
buffer_store_dwordx2 v[200:201], v188, s[16:19], s61 offen sc1 nt
v_mfma_f32_16x16x32_bf16 v[172:175], v[32:35], a[208:211], v[172:175]
ds_read_b128 a[208:211], v230 offset:4096
v_sub_u32 v188, v188, v247
v_mfma_f32_16x16x32_bf16 v[172:175], v[36:39], a[212:215], v[172:175]
s_waitcnt lgkmcnt(5)
ds_read_b128 a[212:215], v230 offset:5120
v_mfma_f32_16x16x32_bf16 v[160:163], a[160:163], a[216:219], v[160:163]
v_mfma_f32_16x16x32_bf16 v[160:163], a[176:179], a[220:223], v[160:163]
v_mfma_f32_16x16x32_bf16 v[164:167], a[164:167], a[216:219], v[164:167]
buffer_store_dwordx2 v[202:203], v189, s[16:19], s61 offen sc1 nt
v_mfma_f32_16x16x32_bf16 v[164:167], a[180:183], a[220:223], v[164:167]
s_nop 0
v_sub_u32 v189, v189, v247
v_mfma_f32_16x16x32_bf16 v[168:171], a[168:171], a[216:219], v[168:171]
v_mfma_f32_16x16x32_bf16 v[168:171], a[184:187], a[220:223], v[168:171]
v_mfma_f32_16x16x32_bf16 v[172:175], v[40:43], a[216:219], v[172:175]
ds_read_b128 a[216:219], v230 offset:6144
v_mfma_f32_16x16x32_bf16 v[172:175], v[44:47], a[220:223], v[172:175]
s_waitcnt lgkmcnt(5)
ds_read_b128 a[220:223], v230 offset:7168
v_mfma_f32_16x16x32_bf16 v[96:99], a[0:3], a[192:195], 0
buffer_store_dwordx2 v[204:205], v190, s[16:19], s61 offen sc1 nt
v_mfma_f32_16x16x32_bf16 v[96:99], a[16:19], a[196:199], v[96:99]
s_nop 0
v_sub_u32 v190, v190, v247
v_mfma_f32_16x16x32_bf16 v[100:103], a[4:7], a[192:195], 0
v_mfma_f32_16x16x32_bf16 v[100:103], a[20:23], a[196:199], v[100:103]
v_cvt_pk_bf16_f32 v120, v160, v161
v_cvt_pk_bf16_f32 v121, v162, v163
v_mfma_f32_16x16x32_bf16 v[104:107], a[8:11], a[192:195], 0
v_cvt_pk_bf16_f32 v122, v164, v165
v_cvt_pk_bf16_f32 v123, v166, v167
v_mfma_f32_16x16x32_bf16 v[104:107], a[24:27], a[196:199], v[104:107]
v_cvt_pk_bf16_f32 v124, v168, v169
v_cvt_pk_bf16_f32 v125, v170, v171
v_mfma_f32_16x16x32_bf16 v[108:111], v[16:19], a[192:195], 0
v_cvt_pk_bf16_f32 v126, v172, v173
v_cvt_pk_bf16_f32 v127, v174, v175
v_mfma_f32_16x16x32_bf16 v[108:111], v[20:23], a[196:199], v[108:111]
s_waitcnt lgkmcnt(4)
ds_read_b128 a[192:195], v230 offset:8192
v_mfma_f32_16x16x32_bf16 v[96:99], a[32:35], a[200:203], v[96:99]
ds_read_b128 a[196:199], v230 offset:9216
v_mfma_f32_16x16x32_bf16 v[96:99], a[48:51], a[204:207], v[96:99]
buffer_store_dwordx2 v[206:207], v191, s[16:19], s61 offen sc1 nt
v_mfma_f32_16x16x32_bf16 v[100:103], a[36:39], a[200:203], v[100:103]
s_add_u32 s61, s61, 128
v_sub_u32 v191, v191, v247
v_mfma_f32_16x16x32_bf16 v[100:103], a[52:55], a[204:207], v[100:103]
v_mfma_f32_16x16x32_bf16 v[104:107], a[40:43], a[200:203], v[104:107]
v_mfma_f32_16x16x32_bf16 v[104:107], a[56:59], a[204:207], v[104:107]
v_mfma_f32_16x16x32_bf16 v[108:111], v[24:27], a[200:203], v[108:111]
ds_read_b128 a[200:203], v230 offset:10240
v_mfma_f32_16x16x32_bf16 v[108:111], v[28:31], a[204:207], v[108:111]
ds_read_b128 a[204:207], v230 offset:11264
v_mfma_f32_16x16x32_bf16 v[48:51], v[0:3], v[120:123], 0
v_mfma_f32_16x16x32_bf16 v[48:51], v[4:7], v[124:127], v[48:51]
v_mfma_f32_16x16x32_bf16 v[52:55], v[8:11], v[120:123], 0
v_mfma_f32_16x16x32_bf16 v[52:55], v[12:15], v[124:127], v[52:55]
v_mfma_f32_16x16x32_bf16 v[56:59], v[64:67], v[120:123], 0
v_mfma_f32_16x16x32_bf16 v[56:59], v[68:71], v[124:127], v[56:59]
v_mfma_f32_16x16x32_bf16 v[60:63], v[72:75], v[120:123], 0
v_mfma_f32_16x16x32_bf16 v[60:63], v[76:79], v[124:127], v[60:63]
s_waitcnt lgkmcnt(6)
v_mfma_f32_16x16x32_bf16 v[96:99], a[64:67], a[208:211], v[96:99]
v_mfma_f32_16x16x32_bf16 v[96:99], a[80:83], a[212:215], v[96:99]
v_cvt_pk_bf16_f32 v80, v144, v48
v_cvt_pk_bf16_f32 v82, v145, v49
v_mfma_f32_16x16x32_bf16 v[100:103], a[68:71], a[208:211], v[100:103]
v_cvt_pk_bf16_f32 v84, v146, v50
v_cvt_pk_bf16_f32 v86, v147, v51
v_mfma_f32_16x16x32_bf16 v[100:103], a[84:87], a[212:215], v[100:103]
v_cvt_pk_bf16_f32 v88, v148, v52
v_cvt_pk_bf16_f32 v90, v149, v53
v_mfma_f32_16x16x32_bf16 v[104:107], a[72:75], a[208:211], v[104:107]
v_cvt_pk_bf16_f32 v92, v150, v54
v_cvt_pk_bf16_f32 v94, v151, v55
v_mfma_f32_16x16x32_bf16 v[104:107], a[88:91], a[212:215], v[104:107]
v_cvt_pk_bf16_f32 v192, v152, v56
v_cvt_pk_bf16_f32 v194, v153, v57
v_mfma_f32_16x16x32_bf16 v[108:111], v[208:211], a[208:211], v[108:111]
ds_read_b128 a[208:211], v230 offset:12288
v_cvt_pk_bf16_f32 v196, v154, v58
v_mfma_f32_16x16x32_bf16 v[108:111], v[212:215], a[212:215], v[108:111]
s_waitcnt lgkmcnt(5)
ds_read_b128 a[212:215], v230 offset:13312
v_cvt_pk_bf16_f32 v198, v155, v59
v_mfma_f32_16x16x32_bf16 v[96:99], a[96:99], a[216:219], v[96:99]
v_cvt_pk_bf16_f32 v200, v156, v60
v_cvt_pk_bf16_f32 v202, v157, v61
v_mfma_f32_16x16x32_bf16 v[96:99], a[112:115], a[220:223], v[96:99]
v_cvt_pk_bf16_f32 v204, v158, v62
v_cvt_pk_bf16_f32 v206, v159, v63
v_mfma_f32_16x16x32_bf16 v[100:103], a[100:103], a[216:219], v[100:103]
buffer_store_dword v80, v176, s[16:19], s61 offen offset:0 sc1 nt
v_mfma_f32_16x16x32_bf16 v[100:103], a[116:119], a[220:223], v[100:103]
v_mfma_f32_16x16x32_bf16 v[104:107], a[104:107], a[216:219], v[104:107]
v_mfma_f32_16x16x32_bf16 v[104:107], a[120:123], a[220:223], v[104:107]
buffer_store_dword v82, v177, s[16:19], s61 offen offset:0 sc1 nt
v_mfma_f32_16x16x32_bf16 v[108:111], v[216:219], a[216:219], v[108:111]
ds_read_b128 a[216:219], v230 offset:14336
v_mfma_f32_16x16x32_bf16 v[108:111], v[220:223], a[220:223], v[108:111]
s_waitcnt lgkmcnt(5)
ds_read_b128 a[220:223], v230 offset:15360
v_mfma_f32_16x16x32_bf16 v[96:99], a[128:131], a[192:195], v[96:99]
buffer_store_dword v84, v178, s[16:19], s61 offen offset:0 sc1 nt
v_mfma_f32_16x16x32_bf16 v[96:99], a[144:147], a[196:199], v[96:99]
v_mfma_f32_16x16x32_bf16 v[100:103], a[132:135], a[192:195], v[100:103]
v_mfma_f32_16x16x32_bf16 v[100:103], a[148:151], a[196:199], v[100:103]
buffer_store_dword v86, v179, s[16:19], s61 offen offset:0 sc1 nt
v_mfma_f32_16x16x32_bf16 v[104:107], a[136:139], a[192:195], v[104:107]
v_mfma_f32_16x16x32_bf16 v[104:107], a[152:155], a[196:199], v[104:107]
v_mfma_f32_16x16x32_bf16 v[108:111], v[32:35], a[192:195], v[108:111]
ds_read_b128 a[192:195], v230 offset:16384
v_mfma_f32_16x16x32_bf16 v[108:111], v[36:39], a[196:199], v[108:111]
s_waitcnt lgkmcnt(5)
ds_read_b128 a[196:199], v230 offset:17408
v_mfma_f32_16x16x32_bf16 v[96:99], a[160:163], a[200:203], v[96:99]
buffer_store_dword v88, v180, s[16:19], s61 offen offset:0 sc1 nt
v_mfma_f32_16x16x32_bf16 v[96:99], a[176:179], a[204:207], v[96:99]
v_mfma_f32_16x16x32_bf16 v[100:103], a[164:167], a[200:203], v[100:103]
v_mfma_f32_16x16x32_bf16 v[100:103], a[180:183], a[204:207], v[100:103]
buffer_store_dword v90, v181, s[16:19], s61 offen offset:0 sc1 nt
v_mfma_f32_16x16x32_bf16 v[104:107], a[168:171], a[200:203], v[104:107]
v_mfma_f32_16x16x32_bf16 v[104:107], a[184:187], a[204:207], v[104:107]
v_mfma_f32_16x16x32_bf16 v[108:111], v[40:43], a[200:203], v[108:111]
ds_read_b128 a[200:203], v230 offset:18432
v_mfma_f32_16x16x32_bf16 v[108:111], v[44:47], a[204:207], v[108:111]
s_waitcnt lgkmcnt(5)
v_cvt_pk_bf16_f32 v112, v96, v97
v_cvt_pk_bf16_f32 v113, v98, v99
v_mfma_f32_16x16x32_bf16 v[160:163], a[0:3], a[208:211], 0
v_cvt_pk_bf16_f32 v114, v100, v101
v_cvt_pk_bf16_f32 v115, v102, v103
v_mfma_f32_16x16x32_bf16 v[160:163], a[16:19], a[212:215], v[160:163]
v_cvt_pk_bf16_f32 v116, v104, v105
v_cvt_pk_bf16_f32 v117, v106, v107
v_mfma_f32_16x16x32_bf16 v[164:167], a[4:7], a[208:211], 0
v_cvt_pk_bf16_f32 v118, v108, v109
v_cvt_pk_bf16_f32 v119, v110, v111
v_mfma_f32_16x16x32_bf16 v[164:167], a[20:23], a[212:215], v[164:167]
ds_read_b128 a[204:207], v230 offset:19456
v_mfma_f32_16x16x32_bf16 v[168:171], a[8:11], a[208:211], 0
buffer_store_dword v92, v182, s[16:19], s61 offen offset:0 sc1 nt
v_mfma_f32_16x16x32_bf16 v[168:171], a[24:27], a[212:215], v[168:171]
v_mfma_f32_16x16x32_bf16 v[172:175], v[16:19], a[208:211], 0
ds_read_b128 a[208:211], v230 offset:20480
v_mfma_f32_16x16x32_bf16 v[172:175], v[20:23], a[212:215], v[172:175]
s_waitcnt lgkmcnt(5)
ds_read_b128 a[212:215], v230 offset:21504
v_mfma_f32_16x16x32_bf16 v[160:163], a[32:35], a[216:219], v[160:163]
buffer_store_dword v94, v183, s[16:19], s61 offen offset:0 sc1 nt
v_mfma_f32_16x16x32_bf16 v[160:163], a[48:51], a[220:223], v[160:163]
v_mfma_f32_16x16x32_bf16 v[164:167], a[36:39], a[216:219], v[164:167]
v_mfma_f32_16x16x32_bf16 v[164:167], a[52:55], a[220:223], v[164:167]
buffer_store_dword v192, v184, s[16:19], s61 offen offset:0 sc1 nt
v_mfma_f32_16x16x32_bf16 v[168:171], a[40:43], a[216:219], v[168:171]
v_mfma_f32_16x16x32_bf16 v[168:171], a[56:59], a[220:223], v[168:171]
v_mfma_f32_16x16x32_bf16 v[172:175], v[24:27], a[216:219], v[172:175]
buffer_store_dword v194, v185, s[16:19], s61 offen offset:0 sc1 nt
v_mfma_f32_16x16x32_bf16 v[172:175], v[28:31], a[220:223], v[172:175]
ds_read_b128 a[216:219], v230 offset:22528
v_mfma_f32_16x16x32_bf16 v[144:147], v[0:3], v[112:115], 0
ds_read_b128 a[220:223], v230 offset:23552
v_mfma_f32_16x16x32_bf16 v[144:147], v[4:7], v[116:119], v[144:147]
buffer_store_dword v196, v186, s[16:19], s61 offen offset:0 sc1 nt
v_mfma_f32_16x16x32_bf16 v[148:151], v[8:11], v[112:115], 0
v_mfma_f32_16x16x32_bf16 v[148:151], v[12:15], v[116:119], v[148:151]
v_mfma_f32_16x16x32_bf16 v[152:155], v[64:67], v[112:115], 0
buffer_store_dword v198, v187, s[16:19], s61 offen offset:0 sc1 nt
v_mfma_f32_16x16x32_bf16 v[152:155], v[68:71], v[116:119], v[152:155]
v_mfma_f32_16x16x32_bf16 v[156:159], v[72:75], v[112:115], 0
v_mfma_f32_16x16x32_bf16 v[156:159], v[76:79], v[116:119], v[156:159]
s_waitcnt lgkmcnt(6)
buffer_store_dword v200, v188, s[16:19], s61 offen offset:0 sc1 nt
v_mfma_f32_16x16x32_bf16 v[160:163], a[64:67], a[192:195], v[160:163]
v_mfma_f32_16x16x32_bf16 v[160:163], a[80:83], a[196:199], v[160:163]
v_mfma_f32_16x16x32_bf16 v[164:167], a[68:71], a[192:195], v[164:167]
buffer_store_dword v202, v189, s[16:19], s61 offen offset:0 sc1 nt
v_mfma_f32_16x16x32_bf16 v[164:167], a[84:87], a[196:199], v[164:167]
v_mfma_f32_16x16x32_bf16 v[168:171], a[72:75], a[192:195], v[168:171]
v_mfma_f32_16x16x32_bf16 v[168:171], a[88:91], a[196:199], v[168:171]
buffer_store_dword v204, v190, s[16:19], s61 offen offset:0 sc1 nt
v_mfma_f32_16x16x32_bf16 v[172:175], v[208:211], a[192:195], v[172:175]
v_mfma_f32_16x16x32_bf16 v[172:175], v[212:215], a[196:199], v[172:175]
s_waitcnt lgkmcnt(4)
v_mfma_f32_16x16x32_bf16 v[160:163], a[96:99], a[200:203], v[160:163]
buffer_store_dword v206, v191, s[16:19], s61 offen offset:0 sc1 nt
v_mfma_f32_16x16x32_bf16 v[160:163], a[112:115], a[204:207], v[160:163]
v_mfma_f32_16x16x32_bf16 v[164:167], a[100:103], a[200:203], v[164:167]
v_mfma_f32_16x16x32_bf16 v[164:167], a[116:119], a[204:207], v[164:167]
v_mfma_f32_16x16x32_bf16 v[168:171], a[104:107], a[200:203], v[168:171]
v_mfma_f32_16x16x32_bf16 v[168:171], a[120:123], a[204:207], v[168:171]
v_mfma_f32_16x16x32_bf16 v[172:175], v[216:219], a[200:203], v[172:175]
v_mfma_f32_16x16x32_bf16 v[172:175], v[220:223], a[204:207], v[172:175]
s_waitcnt lgkmcnt(2)
v_mfma_f32_16x16x32_bf16 v[160:163], a[128:131], a[208:211], v[160:163]
v_mfma_f32_16x16x32_bf16 v[160:163], a[144:147], a[212:215], v[160:163]
v_mfma_f32_16x16x32_bf16 v[164:167], a[132:135], a[208:211], v[164:167]
v_mfma_f32_16x16x32_bf16 v[164:167], a[148:151], a[212:215], v[164:167]
v_mfma_f32_16x16x32_bf16 v[168:171], a[136:139], a[208:211], v[168:171]
v_mfma_f32_16x16x32_bf16 v[168:171], a[152:155], a[212:215], v[168:171]
v_mfma_f32_16x16x32_bf16 v[172:175], v[32:35], a[208:211], v[172:175]
v_mfma_f32_16x16x32_bf16 v[172:175], v[36:39], a[212:215], v[172:175]
s_waitcnt lgkmcnt(0)
v_mfma_f32_16x16x32_bf16 v[160:163], a[160:163], a[216:219], v[160:163]
v_mfma_f32_16x16x32_bf16 v[160:163], a[176:179], a[220:223], v[160:163]
v_mfma_f32_16x16x32_bf16 v[164:167], a[164:167], a[216:219], v[164:167]
v_mfma_f32_16x16x32_bf16 v[164:167], a[180:183], a[220:223], v[164:167]
v_mfma_f32_16x16x32_bf16 v[168:171], a[168:171], a[216:219], v[168:171]
v_mfma_f32_16x16x32_bf16 v[168:171], a[184:187], a[220:223], v[168:171]
v_mfma_f32_16x16x32_bf16 v[172:175], v[40:43], a[216:219], v[172:175]
v_mfma_f32_16x16x32_bf16 v[172:175], v[44:47], a[220:223], v[172:175]
s_nop 1
v_cvt_pk_bf16_f32 v120, v160, v161
v_cvt_pk_bf16_f32 v121, v162, v163
v_cvt_pk_bf16_f32 v122, v164, v165
v_cvt_pk_bf16_f32 v123, v166, v167
s_nop 1
v_mfma_f32_16x16x32_bf16 v[48:51], v[0:3], v[120:123], 0
v_cvt_pk_bf16_f32 v124, v168, v169
v_cvt_pk_bf16_f32 v125, v170, v171
v_cvt_pk_bf16_f32 v126, v172, v173
v_cvt_pk_bf16_f32 v127, v174, v175
s_nop 1
v_mfma_f32_16x16x32_bf16 v[48:51], v[4:7], v[124:127], v[48:51]
v_mfma_f32_16x16x32_bf16 v[52:55], v[8:11], v[120:123], 0
v_mfma_f32_16x16x32_bf16 v[52:55], v[12:15], v[124:127], v[52:55]
v_mfma_f32_16x16x32_bf16 v[56:59], v[64:67], v[120:123], 0
v_mfma_f32_16x16x32_bf16 v[56:59], v[68:71], v[124:127], v[56:59]
v_mfma_f32_16x16x32_bf16 v[60:63], v[72:75], v[120:123], 0
v_mfma_f32_16x16x32_bf16 v[60:63], v[76:79], v[124:127], v[60:63]
s_nop 1
v_cvt_pk_bf16_f32 v81, v144, v48
v_cvt_pk_bf16_f32 v83, v145, v49
v_cvt_pk_bf16_f32 v85, v146, v50
v_cvt_pk_bf16_f32 v87, v147, v51
buffer_store_dword v81, v176, s[16:19], s61 offen offset:64 sc1 nt
buffer_store_dword v83, v177, s[16:19], s61 offen offset:64 sc1 nt
buffer_store_dword v85, v178, s[16:19], s61 offen offset:64 sc1 nt
buffer_store_dword v87, v179, s[16:19], s61 offen offset:64 sc1 nt
v_cvt_pk_bf16_f32 v89, v148, v52
v_cvt_pk_bf16_f32 v91, v149, v53
v_cvt_pk_bf16_f32 v93, v150, v54
v_cvt_pk_bf16_f32 v95, v151, v55
buffer_store_dword v89, v180, s[16:19], s61 offen offset:64 sc1 nt
buffer_store_dword v91, v181, s[16:19], s61 offen offset:64 sc1 nt
buffer_store_dword v93, v182, s[16:19], s61 offen offset:64 sc1 nt
buffer_store_dword v95, v183, s[16:19], s61 offen offset:64 sc1 nt
v_cvt_pk_bf16_f32 v193, v152, v56
v_cvt_pk_bf16_f32 v195, v153, v57
v_cvt_pk_bf16_f32 v197, v154, v58
v_cvt_pk_bf16_f32 v199, v155, v59
buffer_store_dword v193, v184, s[16:19], s61 offen offset:64 sc1 nt
buffer_store_dword v195, v185, s[16:19], s61 offen offset:64 sc1 nt
buffer_store_dword v197, v186, s[16:19], s61 offen offset:64 sc1 nt
buffer_store_dword v199, v187, s[16:19], s61 offen offset:64 sc1 nt
v_cvt_pk_bf16_f32 v201, v156, v60
v_cvt_pk_bf16_f32 v203, v157, v61
v_cvt_pk_bf16_f32 v205, v158, v62
v_cvt_pk_bf16_f32 v207, v159, v63
buffer_store_dword v201, v188, s[16:19], s61 offen offset:64 sc1 nt
buffer_store_dword v203, v189, s[16:19], s61 offen offset:64 sc1 nt
buffer_store_dword v205, v190, s[16:19], s61 offen offset:64 sc1 nt
buffer_store_dword v207, v191, s[16:19], s61 offen offset:64 sc1 nt

s_endpgm
L_nspin:
s_sleep 8
buffer_load_dword v234, v235, s[92:95], 0 offen sc1
s_waitcnt vmcnt(0)
v_readfirstlane_b32 s28, v234
s_nop 0
s_cmp_lt_u32 s28, s69
s_cbranch_scc1 L_nspin
s_branch L_nchk1
L_full:
v_cvt_pk_bf16_f32 v25, v26, v27
ds_read_b64_tr_b16 a[12:13], v239 offset:8
v_mfma_f32_16x16x32_bf16 v[68:71], a[204:207], a[180:183], v[68:71]
ds_read_b64_tr_b16 a[14:15], v239 offset:12296
v_mfma_f32_16x16x32_bf16 v[72:75], a[200:203], a[168:171], v[72:75]
v_cvt_pk_bf16_f32 v18, v64, v65
v_cvt_pk_bf16_f32 v19, v66, v67
v_mfma_f32_16x16x32_bf16 v[72:75], a[204:207], a[184:187], v[72:75]
ds_read_b128 v[64:67], v236 offset:32768
v_mfma_f32_16x16x32_bf16 v[76:79], a[200:203], a[172:175], v[76:79]
ds_read_b128 a[200:203], v228 offset:43008
v_cvt_pk_bf16_f32 v22, v68, v69
v_mfma_f32_16x16x32_bf16 v[76:79], a[204:207], a[188:191], v[76:79]
s_waitcnt lgkmcnt(12)
ds_read_b128 a[204:207], v228 offset:44032
v_cvt_pk_bf16_f32 v23, v70, v71
v_mfma_f32_16x16x32_bf16 v[208:211], a[208:211], a[160:163], v[208:211]
v_cvt_pk_bf16_f32 v26, v72, v73
v_cvt_pk_bf16_f32 v27, v74, v75
v_mfma_f32_16x16x32_bf16 v[208:211], a[212:215], a[176:179], v[208:211]
ds_read_b128 v[68:71], v236 offset:33792
v_mfma_f32_16x16x32_bf16 v[212:215], a[208:211], a[164:167], v[212:215]
v_cvt_pk_bf16_f32 v30, v76, v77
v_cvt_pk_bf16_f32 v31, v78, v79
v_mfma_f32_16x16x32_bf16 v[212:215], a[212:215], a[180:183], v[212:215]
ds_read_b128 v[72:75], v238 offset:512
v_mfma_f32_16x16x32_bf16 v[216:219], a[208:211], a[168:171], v[216:219]
ds_read_b128 v[76:79], v238 offset:576
v_cvt_pk_bf16_f32 v208, v208, v209
v_mfma_f32_16x16x32_bf16 v[216:219], a[212:215], a[184:187], v[216:219]
v_cvt_pk_bf16_f32 v209, v210, v211
ds_read_b64_tr_b16 a[28:29], v239 offset:24584
v_mfma_f32_16x16x32_bf16 v[220:223], a[208:211], a[172:175], v[220:223]
ds_read_b128 a[208:211], v228 offset:45056
v_cvt_pk_bf16_f32 v212, v212, v213
v_mfma_f32_16x16x32_bf16 v[220:223], a[212:215], a[188:191], v[220:223]
s_waitcnt lgkmcnt(15)
ds_read_b128 a[212:215], v228 offset:46080
v_cvt_pk_bf16_f32 v213, v214, v215
v_mfma_f32_16x16x32_bf16 v[180:183], v[8:11], a[248:251], v[180:183]
ds_read_b128 v[8:11], v238 offset:384
v_cvt_pk_bf16_f32 v216, v216, v217
v_mfma_f32_16x16x32_bf16 v[180:183], v[12:15], a[252:255], v[180:183]
s_waitcnt lgkmcnt(15)
ds_read_b128 v[12:15], v238 offset:448
v_cvt_pk_bf16_f32 v217, v218, v219
v_mfma_f32_16x16x32_bf16 v[128:131], a[216:219], a[160:163], v[128:131]
v_cvt_pk_bf16_f32 v220, v220, v221
v_cvt_pk_bf16_f32 v221, v222, v223
v_mfma_f32_16x16x32_bf16 v[128:131], a[220:223], a[176:179], v[128:131]
ds_read_b64_tr_b16 a[30:31], v241 offset:8
v_mfma_f32_16x16x32_bf16 v[132:135], a[216:219], a[164:167], v[132:135]
ds_read_b64_tr_b16 a[44:45], v240 offset:8
v_mfma_f32_16x16x32_bf16 v[132:135], a[220:223], a[180:183], v[132:135]
ds_read_b64_tr_b16 a[46:47], v240 offset:12296
v_mfma_f32_16x16x32_bf16 v[136:139], a[216:219], a[168:171], v[136:139]
ds_read_b64_tr_b16 a[60:61], v240 offset:24584
v_mfma_f32_16x16x32_bf16 v[136:139], a[220:223], a[184:187], v[136:139]
v_cvt_pk_bf16_f32 v210, v128, v129
v_cvt_pk_bf16_f32 v211, v130, v131
v_mfma_f32_16x16x32_bf16 v[140:143], a[216:219], a[172:175], v[140:143]
ds_read_b128 a[216:219], v228 offset:47104
v_cvt_pk_bf16_f32 v214, v132, v133
v_mfma_f32_16x16x32_bf16 v[140:143], a[220:223], a[188:191], v[140:143]
s_waitcnt lgkmcnt(15)
ds_read_b128 a[220:223], v228 offset:48128
v_cvt_pk_bf16_f32 v215, v134, v135
v_mfma_f32_16x16x32_bf16 v[32:35], a[192:195], a[160:163], v[32:35]
v_cvt_pk_bf16_f32 v218, v136, v137
v_cvt_pk_bf16_f32 v219, v138, v139
v_mfma_f32_16x16x32_bf16 v[32:35], a[196:199], a[176:179], v[32:35]
ds_read_b64_tr_b16 a[76:77], v239 offset:1024
v_mfma_f32_16x16x32_bf16 v[36:39], a[192:195], a[164:167], v[36:39]
v_cvt_pk_bf16_f32 v222, v140, v141
v_cvt_pk_bf16_f32 v223, v142, v143
v_mfma_f32_16x16x32_bf16 v[36:39], a[196:199], a[180:183], v[36:39]
ds_read_b64_tr_b16 a[78:79], v239 offset:13312
v_mfma_f32_16x16x32_bf16 v[40:43], a[192:195], a[168:171], v[40:43]
ds_read_b64_tr_b16 a[92:93], v239 offset:25600
v_cvt_pk_bf16_f32 v32, v32, v33
v_mfma_f32_16x16x32_bf16 v[40:43], a[196:199], a[184:187], v[40:43]
v_cvt_pk_bf16_f32 v33, v34, v35
ds_read_b64_tr_b16 a[94:95], v241 offset:64
v_mfma_f32_16x16x32_bf16 v[44:47], a[192:195], a[172:175], v[44:47]
v_cvt_pk_bf16_f32 v36, v36, v37
v_cvt_pk_bf16_f32 v37, v38, v39
v_mfma_f32_16x16x32_bf16 v[44:47], a[196:199], a[188:191], v[44:47]
ds_read_b64_tr_b16 a[108:109], v240 offset:1024
v_mfma_f32_16x16x32_bf16 v[184:187], v[0:3], a[248:251], v[184:187]
s_waitcnt vmcnt(6) lgkmcnt(5)
s_barrier
v_cvt_pk_bf16_f32 v40, v40, v41
v_mfma_f32_16x16x32_bf16 v[184:187], v[4:7], a[252:255], v[184:187]
s_add_u32 m0, s34, 24576
v_cvt_pk_bf16_f32 v41, v42, v43
ds_read_b128 a[192:195], v229 offset:0
v_mfma_f32_16x16x32_bf16 v[192:195], a[200:203], a[160:163], v[192:195]
s_add_u32 s54, s34, 344064
v_cvt_pk_bf16_f32 v44, v44, v45
v_cvt_pk_bf16_f32 v45, v46, v47
v_mfma_f32_16x16x32_bf16 v[192:195], a[204:207], a[176:179], v[192:195]
ds_read_b128 a[196:199], v229 offset:1024
v_mfma_f32_16x16x32_bf16 v[196:199], a[200:203], a[164:167], v[196:199]
ds_read_b64_tr_b16 a[110:111], v240 offset:13312
v_mfma_f32_16x16x32_bf16 v[196:199], a[204:207], a[180:183], v[196:199]
ds_read_b64_tr_b16 a[124:125], v240 offset:25600
v_mfma_f32_16x16x32_bf16 v[200:203], a[200:203], a[168:171], v[200:203]
v_mfma_f32_16x16x32_bf16 v[200:203], a[204:207], a[184:187], v[200:203]
v_mfma_f32_16x16x32_bf16 v[204:207], a[200:203], a[172:175], v[204:207]
v_cvt_pk_bf16_f32 v34, v192, v193
v_cvt_pk_bf16_f32 v35, v194, v195
v_mfma_f32_16x16x32_bf16 v[204:207], a[204:207], a[188:191], v[204:207]
ds_read_b128 v[192:195], v236 offset:10240
v_cvt_pk_bf16_f32 v38, v196, v197
v_mfma_f32_16x16x32_bf16 v[96:99], a[208:211], a[160:163], v[96:99]
v_cvt_pk_bf16_f32 v39, v198, v199
v_cvt_pk_bf16_f32 v42, v200, v201
v_mfma_f32_16x16x32_bf16 v[96:99], a[212:215], a[176:179], v[96:99]
v_cvt_pk_bf16_f32 v43, v202, v203
ds_read_b128 v[196:199], v236 offset:11264
v_mfma_f32_16x16x32_bf16 v[100:103], a[208:211], a[164:167], v[100:103]
v_cvt_pk_bf16_f32 v46, v204, v205
ds_read_b128 v[200:203], v236 offset:22528
v_mfma_f32_16x16x32_bf16 v[100:103], a[212:215], a[180:183], v[100:103]
v_cvt_pk_bf16_f32 v47, v206, v207
ds_read_b128 v[204:207], v236 offset:23552
v_mfma_f32_16x16x32_bf16 v[104:107], a[208:211], a[168:171], v[104:107]
v_cvt_pk_bf16_f32 v96, v96, v97
v_cvt_pk_bf16_f32 v97, v98, v99
v_mfma_f32_16x16x32_bf16 v[104:107], a[212:215], a[184:187], v[104:107]
ds_read_b128 a[200:203], v229 offset:2048
v_mfma_f32_16x16x32_bf16 v[108:111], a[208:211], a[172:175], v[108:111]
v_cvt_pk_bf16_f32 v100, v100, v101
v_cvt_pk_bf16_f32 v101, v102, v103
v_mfma_f32_16x16x32_bf16 v[108:111], a[212:215], a[188:191], v[108:111]
ds_read_b128 a[204:207], v229 offset:3072
v_mfma_f32_16x16x32_bf16 v[188:191], v[8:11], a[248:251], v[188:191]
ds_read_b128 a[208:211], v229 offset:4096
v_cvt_pk_bf16_f32 v104, v104, v105
v_mfma_f32_16x16x32_bf16 v[188:191], v[12:15], a[252:255], v[188:191]
v_cvt_pk_bf16_f32 v105, v106, v107
ds_read_b128 a[212:215], v229 offset:5120
v_mfma_f32_16x16x32_bf16 v[160:163], a[216:219], a[160:163], v[160:163]
v_cvt_pk_bf16_f32 v108, v108, v109
v_cvt_pk_bf16_f32 v109, v110, v111
v_mfma_f32_16x16x32_bf16 v[160:163], a[220:223], a[176:179], v[160:163]
v_mov_b32 v15, 0
v_mfma_f32_16x16x32_bf16 v[164:167], a[216:219], a[164:167], v[164:167]
v_mfma_f32_16x16x32_bf16 v[164:167], a[220:223], a[180:183], v[164:167]
v_mfma_f32_16x16x32_bf16 v[168:171], a[216:219], a[168:171], v[168:171]
v_mfma_f32_16x16x32_bf16 v[168:171], a[220:223], a[184:187], v[168:171]
v_mfma_f32_16x16x32_bf16 v[172:175], a[216:219], a[172:175], v[172:175]
ds_read_b128 a[216:219], v229 offset:6144
v_mfma_f32_16x16x32_bf16 v[172:175], a[220:223], a[188:191], v[172:175]
v_cvt_pk_bf16_f32 v98, v160, v161
v_cvt_pk_bf16_f32 v99, v162, v163
v_mfma_f32_16x16x32_bf16 v[156:159], a[128:131], v[28:31], v[156:159]
v_cvt_pk_bf16_f32 v102, v164, v165
v_cvt_pk_bf16_f32 v103, v166, v167
v_mfma_f32_16x16x32_bf16 v[156:159], a[144:147], v[220:223], v[156:159]
ds_read_b128 v[160:163], v236 offset:8192
v_cvt_pk_bf16_f32 v106, v168, v169
v_mfma_f32_16x16x32_bf16 v[60:63], a[132:135], v[28:31], v[60:63]
ds_read_b128 v[164:167], v236 offset:9216
v_cvt_pk_bf16_f32 v107, v170, v171
v_mfma_f32_16x16x32_bf16 v[60:63], a[148:151], v[220:223], v[60:63]
v_cvt_pk_bf16_f32 v110, v172, v173
v_cvt_pk_bf16_f32 v111, v174, v175
v_mfma_f32_16x16x32_bf16 v[92:95], a[136:139], v[28:31], v[92:95]
ds_read_b128 v[168:171], v236 offset:20480
v_mfma_f32_16x16x32_bf16 v[92:95], a[152:155], v[220:223], v[92:95]
s_waitcnt lgkmcnt(1)
ds_read_b128 v[172:175], v236 offset:21504
v_mfma_f32_16x16x32_bf16 v[176:179], v[160:163], v[28:31], v[176:179]
ds_read_b128 v[160:163], v236 offset:34816
v_mfma_f32_16x16x32_bf16 v[176:179], v[164:167], v[220:223], v[176:179]
s_waitcnt lgkmcnt(1)
ds_read_b128 v[164:167], v236 offset:35840
v_mfma_f32_16x16x32_bf16 v[180:183], v[168:171], v[28:31], v[180:183]
ds_read_b128 v[168:171], v238 offset:640
v_mfma_f32_16x16x32_bf16 v[180:183], v[172:175], v[220:223], v[180:183]
ds_read_b128 v[172:175], v238 offset:704
v_mfma_f32_16x16x32_bf16 v[184:187], v[64:67], v[28:31], v[184:187]
ds_read_b128 v[64:67], v237 offset:0
v_mfma_f32_16x16x32_bf16 v[184:187], v[68:71], v[220:223], v[184:187]
ds_read_b128 v[68:71], v237 offset:1024
v_mfma_f32_16x16x32_bf16 v[188:191], v[72:75], v[28:31], v[188:191]
ds_read_b128 v[72:75], v237 offset:12288
v_mfma_f32_16x16x32_bf16 v[188:191], v[76:79], v[220:223], v[188:191]
ds_read_b128 v[76:79], v237 offset:13312
v_mfma_f32_16x16x32_bf16 v[156:159], a[160:163], v[44:47], v[156:159]
ds_read_b128 a[220:223], v229 offset:7168
v_mfma_f32_16x16x32_bf16 v[156:159], a[176:179], v[108:111], v[156:159]
v_mfma_f32_16x16x32_bf16 v[60:63], a[164:167], v[44:47], v[60:63]
v_mfma_f32_16x16x32_bf16 v[60:63], a[180:183], v[108:111], v[60:63]
v_mfma_f32_16x16x32_bf16 v[92:95], a[168:171], v[44:47], v[92:95]
v_mfma_f32_16x16x32_bf16 v[92:95], a[184:187], v[108:111], v[92:95]
v_mfma_f32_16x16x32_bf16 v[176:179], v[192:195], v[44:47], v[176:179]
ds_read_b128 v[192:195], v237 offset:24576
v_mfma_f32_16x16x32_bf16 v[176:179], v[196:199], v[108:111], v[176:179]
ds_read_b128 v[196:199], v237 offset:25600
v_mfma_f32_16x16x32_bf16 v[180:183], v[200:203], v[44:47], v[180:183]
ds_read_b128 v[200:203], v237 offset:2048
v_mfma_f32_16x16x32_bf16 v[180:183], v[204:207], v[108:111], v[180:183]
s_waitcnt lgkmcnt(10)
ds_read_b128 v[204:207], v237 offset:3072
v_mfma_f32_16x16x32_bf16 v[184:187], v[160:163], v[44:47], v[184:187]
ds_read_b128 v[160:163], v237 offset:14336
v_mfma_f32_16x16x32_bf16 v[184:187], v[164:167], v[108:111], v[184:187]
s_waitcnt lgkmcnt(10)
ds_read_b128 v[164:167], v237 offset:15360
v_cndmask_b32 v156, v176, v156, s[36:37]
v_mfma_f32_16x16x32_bf16 v[188:191], v[168:171], v[44:47], v[188:191]
ds_read_b128 v[168:171], v237 offset:26624
v_cndmask_b32 v157, v177, v157, s[36:37]
v_mfma_f32_16x16x32_bf16 v[188:191], v[172:175], v[108:111], v[188:191]
s_waitcnt lgkmcnt(10)
ds_read_b128 v[172:175], v237 offset:27648
v_cndmask_b32 v158, v178, v158, s[36:37]
v_mfma_f32_16x16x32_bf16 v[0:3], v[64:67], a[224:227], 0
ds_read_b128 v[64:67], v237 offset:4096
v_cndmask_b32 v159, v179, v159, s[36:37]
v_mfma_f32_16x16x32_bf16 v[0:3], v[68:71], a[228:231], v[0:3]
s_waitcnt lgkmcnt(10)
ds_read_b128 v[68:71], v237 offset:5120
v_cndmask_b32 v60, v180, v60, s[36:37]
v_mfma_f32_16x16x32_bf16 v[4:7], v[72:75], a[224:227], 0
ds_read_b128 v[72:75], v237 offset:16384
v_cndmask_b32 v124, v188, v189, s[36:37]
v_mfma_f32_16x16x32_bf16 v[4:7], v[76:79], a[228:231], v[4:7]
s_waitcnt lgkmcnt(9)
ds_read_b128 v[76:79], v237 offset:17408
v_cndmask_b32 v61, v181, v61, s[36:37]
v_mfma_f32_16x16x32_bf16 v[8:11], v[192:195], a[224:227], 0
ds_read_b128 v[192:195], v237 offset:28672
v_cndmask_b32 v62, v182, v62, s[36:37]
v_mfma_f32_16x16x32_bf16 v[8:11], v[196:199], a[228:231], v[8:11]
s_waitcnt lgkmcnt(9)
ds_read_b128 v[196:199], v237 offset:29696
v_cndmask_b32 v63, v183, v63, s[36:37]
v_mfma_f32_16x16x32_bf16 v[0:3], v[200:203], a[232:235], v[0:3]
ds_read_b128 v[200:203], v237 offset:6144
v_cndmask_b32 v92, v184, v92, s[36:37]
v_mfma_f32_16x16x32_bf16 v[0:3], v[204:207], a[236:239], v[0:3]
s_waitcnt lgkmcnt(9)
ds_read_b128 v[204:207], v237 offset:7168
v_cndmask_b32 v93, v185, v93, s[36:37]
v_mfma_f32_16x16x32_bf16 v[4:7], v[160:163], a[232:235], v[4:7]
ds_read_b128 v[160:163], v237 offset:18432
v_cndmask_b32 v94, v186, v94, s[36:37]
v_mfma_f32_16x16x32_bf16 v[4:7], v[164:167], a[236:239], v[4:7]
s_waitcnt lgkmcnt(9)
ds_read_b128 v[164:167], v237 offset:19456
v_cndmask_b32 v95, v187, v95, s[36:37]
v_mfma_f32_16x16x32_bf16 v[8:11], v[168:171], a[232:235], v[8:11]
ds_read_b128 v[168:171], v237 offset:30720
v_cndmask_b32 v124, v124, v190, s[42:43]
v_mfma_f32_16x16x32_bf16 v[8:11], v[172:175], a[236:239], v[8:11]
s_waitcnt lgkmcnt(9)
ds_read_b128 v[172:175], v237 offset:31744
v_cndmask_b32 v248, v243, v124, s[38:39]
v_mfma_f32_16x16x32_bf16 v[0:3], v[64:67], a[240:243], v[0:3]
ds_read_b128 v[64:67], v237 offset:8192
v_mfma_f32_16x16x32_bf16 v[0:3], v[68:71], a[244:247], v[0:3]
s_waitcnt lgkmcnt(9)
ds_read_b128 v[68:71], v237 offset:9216
v_mfma_f32_16x16x32_bf16 v[4:7], v[72:75], a[240:243], v[4:7]
ds_read_b128 v[72:75], v237 offset:20480
v_mfma_f32_16x16x32_bf16 v[4:7], v[76:79], a[244:247], v[4:7]
s_waitcnt lgkmcnt(9)
ds_read_b128 v[76:79], v237 offset:21504
v_mfma_f32_16x16x32_bf16 v[8:11], v[192:195], a[240:243], v[8:11]
ds_read_b128 v[192:195], v237 offset:32768
v_mfma_f32_16x16x32_bf16 v[8:11], v[196:199], a[244:247], v[8:11]
s_waitcnt lgkmcnt(9)
ds_read_b128 v[196:199], v237 offset:33792
v_mfma_f32_16x16x32_bf16 v[0:3], v[200:203], a[248:251], v[0:3]
ds_read_b128 v[200:203], v237 offset:10240
v_mfma_f32_16x16x32_bf16 v[0:3], v[204:207], a[252:255], v[0:3]
s_waitcnt lgkmcnt(9)
ds_read_b128 v[204:207], v237 offset:11264
v_mfma_f32_16x16x32_bf16 v[4:7], v[160:163], a[248:251], v[4:7]
ds_read_b128 v[160:163], v237 offset:22528
v_mfma_f32_16x16x32_bf16 v[4:7], v[164:167], a[252:255], v[4:7]
s_waitcnt lgkmcnt(9)
ds_read_b128 v[164:167], v237 offset:23552
v_mfma_f32_16x16x32_bf16 v[8:11], v[168:171], a[248:251], v[8:11]
ds_read_b128 v[168:171], v237 offset:34816
v_mfma_f32_16x16x32_bf16 v[8:11], v[172:175], a[252:255], v[8:11]
s_waitcnt lgkmcnt(9)
ds_read_b128 v[172:175], v237 offset:35840
v_mfma_f32_16x16x32_bf16 v[0:3], v[64:67], v[28:31], v[0:3]
ds_read_b64_tr_b16 a[240:241], v239 offset:0
v_mfma_f32_16x16x32_bf16 v[0:3], v[68:71], v[220:223], v[0:3]
s_waitcnt lgkmcnt(9)
ds_read_b64_tr_b16 a[242:243], v239 offset:12288
v_mov_b32 v71, 0
v_mfma_f32_16x16x32_bf16 v[4:7], v[72:75], v[28:31], v[4:7]
ds_read_b64_tr_b16 a[244:245], v239 offset:24576
v_mfma_f32_16x16x32_bf16 v[4:7], v[76:79], v[220:223], v[4:7]
s_waitcnt lgkmcnt(9)
ds_read_b64_tr_b16 a[246:247], v241 offset:0
v_mov_b32 v79, v245
v_mfma_f32_16x16x32_bf16 v[8:11], v[192:195], v[28:31], v[8:11]
ds_read_b64_tr_b16 a[248:249], v240 offset:0
v_mfma_f32_16x16x32_bf16 v[8:11], v[196:199], v[220:223], v[8:11]
s_waitcnt lgkmcnt(9)
ds_read_b64_tr_b16 a[250:251], v240 offset:12288
v_mfma_f32_16x16x32_bf16 v[0:3], v[200:203], v[44:47], v[0:3]
ds_read_b64_tr_b16 a[252:253], v240 offset:24576
v_mfma_f32_16x16x32_bf16 v[0:3], v[204:207], v[108:111], v[0:3]
s_waitcnt lgkmcnt(9)
ds_read_b64_tr_b16 a[224:225], v239 offset:2048
v_mov_b32 v207, 0
v_mfma_f32_16x16x32_bf16 v[4:7], v[160:163], v[44:47], v[4:7]
ds_read_b64_tr_b16 a[226:227], v239 offset:14336
v_mfma_f32_16x16x32_bf16 v[4:7], v[164:167], v[108:111], v[4:7]
s_waitcnt lgkmcnt(9)
ds_read_b64_tr_b16 a[228:229], v239 offset:26624
v_mfma_f32_16x16x32_bf16 v[8:11], v[168:171], v[44:47], v[8:11]
ds_read_b64_tr_b16 a[230:231], v241 offset:128
v_cndmask_b32 v156, v156, v0, s[42:43]
v_mfma_f32_16x16x32_bf16 v[8:11], v[172:175], v[108:111], v[8:11]
v_cndmask_b32 v157, v157, v1, s[42:43]
v_cndmask_b32 v158, v158, v2, s[42:43]
v_mfma_f32_16x16x32_bf16 v[144:147], a[128:131], v[16:19], v[144:147]
v_cndmask_b32 v159, v159, v3, s[42:43]
v_cndmask_b32 v60, v60, v4, s[42:43]
v_mfma_f32_16x16x32_bf16 v[144:147], a[144:147], v[208:211], v[144:147]
v_cndmask_b32 v61, v61, v5, s[42:43]
v_cndmask_b32 v62, v62, v6, s[42:43]
v_mfma_f32_16x16x32_bf16 v[148:151], a[128:131], v[20:23], v[148:151]
v_cndmask_b32 v63, v63, v7, s[42:43]
v_cndmask_b32 v92, v92, v8, s[42:43]
v_mfma_f32_16x16x32_bf16 v[148:151], a[144:147], v[212:215], v[148:151]
v_cndmask_b32 v93, v93, v9, s[42:43]
v_cndmask_b32 v94, v94, v10, s[42:43]
v_mfma_f32_16x16x32_bf16 v[152:155], a[128:131], v[24:27], v[152:155]
v_cndmask_b32 v95, v95, v11, s[42:43]
v_max3_f32 v249, v156, v157, v158
v_mfma_f32_16x16x32_bf16 v[152:155], a[144:147], v[216:219], v[152:155]
v_max3_f32 v251, v159, v60, v61
v_max3_f32 v252, v62, v63, v92
v_mfma_f32_16x16x32_bf16 v[48:51], a[132:135], v[16:19], v[48:51]
v_max3_f32 v253, v93, v94, v95
v_max3_f32 v249, v249, v251, v248
v_mfma_f32_16x16x32_bf16 v[48:51], a[148:151], v[208:211], v[48:51]
v_max3_f32 v249, v249, v252, v253
v_mov_b32 v250, v249
v_mfma_f32_16x16x32_bf16 v[52:55], a[132:135], v[20:23], v[52:55]
s_nop 0
v_permlane32_swap_b32 v250, v249
v_mfma_f32_16x16x32_bf16 v[52:55], a[148:151], v[212:215], v[52:55]
v_max_f32 v249, v250, v249
v_mov_b32 v250, v249
v_mfma_f32_16x16x32_bf16 v[56:59], a[132:135], v[24:27], v[56:59]
s_nop 0
v_permlane16_swap_b32 v250, v249
v_mfma_f32_16x16x32_bf16 v[56:59], a[148:151], v[216:219], v[56:59]
v_max_f32 v249, v250, v249
v_mul_f32 v254, s35, v249
v_mfma_f32_16x16x32_bf16 v[80:83], a[136:139], v[16:19], v[80:83]
v_fma_f32 v156, v156, s35, -v254
v_fma_f32 v157, v157, s35, -v254
v_mfma_f32_16x16x32_bf16 v[80:83], a[152:155], v[208:211], v[80:83]
v_fma_f32 v158, v158, s35, -v254
v_fma_f32 v159, v159, s35, -v254
v_mfma_f32_16x16x32_bf16 v[84:87], a[136:139], v[20:23], v[84:87]
v_fma_f32 v60, v60, s35, -v254
v_fma_f32 v61, v61, s35, -v254
v_mfma_f32_16x16x32_bf16 v[84:87], a[152:155], v[212:215], v[84:87]
v_fma_f32 v62, v62, s35, -v254
v_fma_f32 v63, v63, s35, -v254
v_mfma_f32_16x16x32_bf16 v[88:91], a[136:139], v[24:27], v[88:91]
v_exp_f32 v156, v156
v_mfma_f32_16x16x32_bf16 v[88:91], a[152:155], v[216:219], v[88:91]
v_exp_f32 v157, v157
v_mfma_f32_16x16x32_bf16 v[112:115], a[140:143], v[16:19], v[112:115]
v_fma_f32 v92, v92, s35, -v254
v_fma_f32 v93, v93, s35, -v254
v_mfma_f32_16x16x32_bf16 v[112:115], a[156:159], v[208:211], v[112:115]
v_exp_f32 v158, v158
v_mfma_f32_16x16x32_bf16 v[116:119], a[140:143], v[20:23], v[116:119]
v_exp_f32 v159, v159
v_mfma_f32_16x16x32_bf16 v[116:119], a[156:159], v[212:215], v[116:119]
v_exp_f32 v60, v60
v_mfma_f32_16x16x32_bf16 v[120:123], a[140:143], v[24:27], v[120:123]
v_exp_f32 v61, v61
v_mfma_f32_16x16x32_bf16 v[120:123], a[156:159], v[216:219], v[120:123]
v_fma_f32 v94, v94, s35, -v254
v_fma_f32 v95, v95, s35, -v254
v_mfma_f32_16x16x32_bf16 v[144:147], a[160:163], v[32:35], v[144:147]
v_exp_f32 v62, v62
v_mfma_f32_16x16x32_bf16 v[144:147], a[176:179], v[96:99], v[144:147]
v_exp_f32 v63, v63
v_mfma_f32_16x16x32_bf16 v[148:151], a[160:163], v[36:39], v[148:151]
v_exp_f32 v92, v92
v_mfma_f32_16x16x32_bf16 v[148:151], a[176:179], v[100:103], v[148:151]
v_fma_f32 v248, v248, s35, -v254
v_add_f32 v249, v156, v157
v_mfma_f32_16x16x32_bf16 v[152:155], a[160:163], v[40:43], v[152:155]
v_exp_f32 v93, v93
v_mfma_f32_16x16x32_bf16 v[152:155], a[176:179], v[104:107], v[152:155]
v_exp_f32 v94, v94
v_mfma_f32_16x16x32_bf16 v[48:51], a[164:167], v[32:35], v[48:51]
v_add_f32 v251, v158, v159
v_add_f32 v252, v60, v61
v_mfma_f32_16x16x32_bf16 v[48:51], a[180:183], v[96:99], v[48:51]
v_exp_f32 v95, v95
v_mfma_f32_16x16x32_bf16 v[52:55], a[164:167], v[36:39], v[52:55]
v_exp_f32 v248, v248
v_mfma_f32_16x16x32_bf16 v[52:55], a[180:183], v[100:103], v[52:55]
v_add_f32 v253, v62, v63
v_add_f32 v249, v249, v92
v_mfma_f32_16x16x32_bf16 v[56:59], a[164:167], v[40:43], v[56:59]
v_add_f32 v251, v251, v93
v_add_f32 v252, v252, v94
v_mfma_f32_16x16x32_bf16 v[56:59], a[180:183], v[104:107], v[56:59]
v_add_f32 v253, v253, v95
v_add_f32 v249, v249, v248
v_mfma_f32_16x16x32_bf16 v[80:83], a[168:171], v[32:35], v[80:83]
v_add_f32 v251, v251, v252
v_add_f32 v249, v249, v253
v_mfma_f32_16x16x32_bf16 v[80:83], a[184:187], v[96:99], v[80:83]
v_add_f32 v249, v249, v251
v_mov_b32 v250, v249
v_mfma_f32_16x16x32_bf16 v[84:87], a[168:171], v[36:39], v[84:87]
s_nop 0
v_permlane32_swap_b32 v250, v249
v_mfma_f32_16x16x32_bf16 v[84:87], a[184:187], v[100:103], v[84:87]
v_add_f32 v249, v250, v249
v_mov_b32 v250, v249
v_mfma_f32_16x16x32_bf16 v[88:91], a[168:171], v[40:43], v[88:91]
s_nop 0
v_permlane16_swap_b32 v250, v249
v_mfma_f32_16x16x32_bf16 v[88:91], a[184:187], v[104:107], v[88:91]
v_add_f32 v249, v250, v249
ds_read_b64_tr_b16 a[140:141], v239 offset:1032
v_mfma_f32_16x16x32_bf16 v[112:115], a[172:175], v[32:35], v[112:115]
v_rcp_f32 v254, v249
v_mfma_f32_16x16x32_bf16 v[112:115], a[188:191], v[96:99], v[112:115]
v_mul_f32 v156, v156, v254
v_mul_f32 v157, v157, v254
v_mfma_f32_16x16x32_bf16 v[116:119], a[172:175], v[36:39], v[116:119]
v_mul_f32 v158, v158, v254
v_mul_f32 v159, v159, v254
v_mfma_f32_16x16x32_bf16 v[116:119], a[188:191], v[100:103], v[116:119]
v_mul_f32 v60, v60, v254
v_mul_f32 v61, v61, v254
v_mfma_f32_16x16x32_bf16 v[120:123], a[172:175], v[40:43], v[120:123]
v_mul_f32 v62, v62, v254
v_mul_f32 v63, v63, v254
v_mfma_f32_16x16x32_bf16 v[120:123], a[188:191], v[104:107], v[120:123]
v_mul_f32 v92, v92, v254
v_mul_f32 v93, v93, v254
v_mfma_f32_16x16x32_bf16 v[96:99], a[0:3], a[192:195], 0
v_mul_f32 v94, v94, v254
v_mul_f32 v95, v95, v254
v_mfma_f32_16x16x32_bf16 v[96:99], a[16:19], a[196:199], v[96:99]
v_mul_f32 v248, v248, v254
v_cvt_pk_bf16_f32 v200, v156, v157
v_cvt_pk_bf16_f32 v201, v158, v159
v_mfma_f32_16x16x32_bf16 v[100:103], a[4:7], a[192:195], 0
v_cvt_pk_bf16_f32 v202, v60, v61
v_cvt_pk_bf16_f32 v203, v62, v63
v_mfma_f32_16x16x32_bf16 v[100:103], a[20:23], a[196:199], v[100:103]
v_cvt_pk_bf16_f32 v204, v92, v93
v_cvt_pk_bf16_f32 v205, v94, v95
v_cvt_pk_bf16_f32 v206, v248, 0
v_mfma_f32_16x16x32_bf16 v[104:107], a[8:11], a[192:195], 0
ds_read_b128 a[192:195], v229 offset:8192
v_cndmask_b32 v192, 0, v200, s[40:41]
v_mfma_f32_16x16x32_bf16 v[104:107], a[24:27], a[196:199], v[104:107]
ds_read_b128 a[196:199], v229 offset:9216
v_cndmask_b32 v72, 0, v200, s[36:37]
v_mfma_f32_16x16x32_bf16 v[96:99], a[32:35], a[200:203], v[96:99]
ds_read_b64_tr_b16 a[142:143], v239 offset:13320
ds_read_b64_tr_b16 a[156:157], v239 offset:25608
v_cndmask_b32 v193, 0, v201, s[40:41]
v_mfma_f32_16x16x32_bf16 v[96:99], a[48:51], a[204:207], v[96:99]
v_cndmask_b32 v73, 0, v201, s[36:37]
ds_read_b64_tr_b16 a[158:159], v241 offset:72
v_mfma_f32_16x16x32_bf16 v[100:103], a[36:39], a[200:203], v[100:103]
v_cndmask_b32 v194, 0, v202, s[40:41]
ds_read_b64_tr_b16 a[172:173], v240 offset:1032
v_cndmask_b32 v195, 0, v203, s[40:41]
v_mfma_f32_16x16x32_bf16 v[100:103], a[52:55], a[204:207], v[100:103]
ds_read_b64_tr_b16 a[174:175], v240 offset:13320
v_cndmask_b32 v74, 0, v202, s[36:37]
v_mfma_f32_16x16x32_bf16 v[104:107], a[40:43], a[200:203], v[104:107]
ds_read_b128 a[200:203], v229 offset:10240
v_cndmask_b32 v75, 0, v203, s[36:37]
v_mfma_f32_16x16x32_bf16 v[104:107], a[56:59], a[204:207], v[104:107]
ds_read_b128 a[204:207], v229 offset:11264
ds_read_b64_tr_b16 a[188:189], v240 offset:25608
v_cndmask_b32 v196, 0, v204, s[40:41]
v_mfma_f32_16x16x32_bf16 v[96:99], a[64:67], a[208:211], v[96:99]
v_cndmask_b32 v197, 0, v205, s[40:41]
v_cndmask_b32 v76, 0, v204, s[36:37]
v_mfma_f32_16x16x32_bf16 v[96:99], a[80:83], a[212:215], v[96:99]
v_cndmask_b32 v198, v246, v206, s[40:41]
v_cndmask_b32 v199, 0, v206, s[42:43]
v_cndmask_b32 v77, 0, v205, s[36:37]
v_mfma_f32_16x16x32_bf16 v[100:103], a[68:71], a[208:211], v[100:103]
v_cndmask_b32 v200, 0, v200, s[42:43]
v_cndmask_b32 v201, 0, v201, s[42:43]
v_mfma_f32_16x16x32_bf16 v[100:103], a[84:87], a[212:215], v[100:103]
v_cndmask_b32 v202, 0, v202, s[42:43]
v_cndmask_b32 v203, 0, v203, s[42:43]
v_mfma_f32_16x16x32_bf16 v[104:107], a[72:75], a[208:211], v[104:107]
ds_read_b128 a[208:211], v229 offset:12288
ds_read_b64_tr_b16 a[232:233], v240 offset:2048
v_cndmask_b32 v78, v244, v206, s[36:37]
v_mfma_f32_16x16x32_bf16 v[104:107], a[88:91], a[212:215], v[104:107]
ds_read_b128 a[212:215], v229 offset:13312
v_cndmask_b32 v204, 0, v204, s[42:43]
v_mfma_f32_16x16x32_bf16 v[96:99], a[96:99], a[216:219], v[96:99]
ds_read_b64_tr_b16 a[234:235], v240 offset:14336
ds_read_b64_tr_b16 a[236:237], v240 offset:26624
v_cndmask_b32 v205, 0, v205, s[42:43]
v_mfma_f32_16x16x32_bf16 v[96:99], a[112:115], a[220:223], v[96:99]
v_mov_b32 v206, 0
v_cndmask_b32 v128, v243, v112, s[38:39]
v_mfma_f32_16x16x32_bf16 v[100:103], a[100:103], a[216:219], v[100:103]
v_max3_f32 v132, v144, v145, v146
v_max3_f32 v136, v147, v48, v49
v_mfma_f32_16x16x32_bf16 v[100:103], a[116:119], a[220:223], v[100:103]
v_max3_f32 v137, v50, v51, v80
v_max3_f32 v142, v81, v82, v83
v_max3_f32 v132, v132, v136, v128
v_mfma_f32_16x16x32_bf16 v[104:107], a[104:107], a[216:219], v[104:107]
ds_read_b128 a[216:219], v229 offset:14336
v_max3_f32 v132, v132, v137, v142
v_mfma_f32_16x16x32_bf16 v[104:107], a[120:123], a[220:223], v[104:107]
s_waitcnt lgkmcnt(14)
ds_read_b128 a[220:223], v229 offset:15360
v_cndmask_b32 v130, v243, v120, s[38:39]
v_max3_f32 v134, v152, v153, v154
v_mfma_f32_16x16x32_bf16 v[96:99], a[128:131], a[192:195], v[96:99]
v_max3_f32 v140, v155, v56, v57
v_cndmask_b32 v129, v243, v116, s[38:39]
v_mfma_f32_16x16x32_bf16 v[96:99], a[144:147], a[196:199], v[96:99]
v_max3_f32 v133, v148, v149, v150
v_max3_f32 v138, v151, v52, v53
v_mfma_f32_16x16x32_bf16 v[100:103], a[132:135], a[192:195], v[100:103]
v_max3_f32 v141, v58, v59, v88
v_max3_f32 v142, v89, v90, v91
v_max3_f32 v134, v134, v140, v130
v_mfma_f32_16x16x32_bf16 v[100:103], a[148:151], a[196:199], v[100:103]
v_max3_f32 v139, v54, v55, v84
v_max3_f32 v143, v85, v86, v87
v_mfma_f32_16x16x32_bf16 v[104:107], a[136:139], a[192:195], v[104:107]
ds_read_b128 a[192:195], v229 offset:16384
v_max3_f32 v133, v133, v138, v129
v_max3_f32 v134, v134, v141, v142
v_mfma_f32_16x16x32_bf16 v[104:107], a[152:155], a[196:199], v[104:107]
s_waitcnt lgkmcnt(9)
ds_read_b128 a[196:199], v229 offset:17408
v_max3_f32 v133, v133, v139, v143
v_mfma_f32_16x16x32_bf16 v[96:99], a[160:163], a[200:203], v[96:99]
v_mov_b32 v135, v134
v_mov_b32 v7, 0
v_mfma_f32_16x16x32_bf16 v[96:99], a[176:179], a[204:207], v[96:99]
v_permlane32_swap_b32 v132, v133
v_max_f32 v132, v132, v133
v_mfma_f32_16x16x32_bf16 v[100:103], a[164:167], a[200:203], v[100:103]
v_permlane32_swap_b32 v135, v134
v_mfma_f32_16x16x32_bf16 v[100:103], a[180:183], a[204:207], v[100:103]
v_max_f32 v134, v135, v134
s_nop 1
v_permlane16_swap_b32 v132, v134
v_mfma_f32_16x16x32_bf16 v[104:107], a[168:171], a[200:203], v[104:107]
ds_read_b128 a[200:203], v229 offset:18432
v_cvt_pk_bf16_f32 v112, v96, v97
v_mfma_f32_16x16x32_bf16 v[104:107], a[184:187], a[204:207], v[104:107]
ds_read_b128 a[204:207], v229 offset:19456
v_cvt_pk_bf16_f32 v113, v98, v99
v_mfma_f32_16x16x32_bf16 v[176:179], a[240:243], v[192:195], 0
ds_read_b64_tr_b16 a[240:241], v239 offset:2056
ds_read_b64_tr_b16 a[242:243], v239 offset:14344
v_cvt_pk_bf16_f32 v114, v100, v101
v_mfma_f32_16x16x32_bf16 v[176:179], a[244:247], v[196:199], v[176:179]
ds_read_b64_tr_b16 a[244:245], v239 offset:26632
v_cvt_pk_bf16_f32 v115, v102, v103
v_mfma_f32_16x16x32_bf16 v[176:179], a[248:251], v[200:203], v[176:179]
ds_read_b64_tr_b16 a[246:247], v241 offset:136
ds_read_b64_tr_b16 a[248:249], v240 offset:2056
v_cvt_pk_bf16_f32 v116, v104, v105
v_mfma_f32_16x16x32_bf16 v[176:179], a[252:255], v[204:207], v[176:179]
ds_read_b64_tr_b16 a[250:251], v240 offset:14344
v_cvt_pk_bf16_f32 v117, v106, v107
v_mfma_f32_16x16x32_bf16 v[180:183], a[12:15], v[192:195], 0
ds_read_b64_tr_b16 a[252:253], v240 offset:26632
v_max_f32 v134, v132, v134
v_mfma_f32_16x16x32_bf16 v[180:183], a[28:31], v[196:199], v[180:183]
ds_read_b64_tr_b16 a[12:13], v239 offset:3072
ds_read_b64_tr_b16 a[14:15], v239 offset:15360
v_mul_f32 v134, s35, v134
v_mfma_f32_16x16x32_bf16 v[180:183], a[44:47], v[200:203], v[180:183]
ds_read_b64_tr_b16 a[28:29], v239 offset:27648
v_cvt_pk_bf16_f32 v16, v176, v177
v_mfma_f32_16x16x32_bf16 v[180:183], a[60:63], v[204:207], v[180:183]
s_waitcnt lgkmcnt(15)
ds_read_b64_tr_b16 a[30:31], v241 offset:192
ds_read_b64_tr_b16 a[44:45], v240 offset:3072
v_cvt_pk_bf16_f32 v17, v178, v179
v_mfma_f32_16x16x32_bf16 v[160:163], a[0:3], a[208:211], 0
ds_read_b64_tr_b16 a[46:47], v240 offset:15360
v_mov_b32 v133, v134
v_mfma_f32_16x16x32_bf16 v[160:163], a[16:19], a[212:215], v[160:163]
ds_read_b64_tr_b16 a[60:61], v240 offset:27648
v_mfma_f32_16x16x32_bf16 v[164:167], a[4:7], a[208:211], 0
v_cvt_pk_bf16_f32 v18, v180, v181
v_cvt_pk_bf16_f32 v19, v182, v183
v_mfma_f32_16x16x32_bf16 v[164:167], a[20:23], a[212:215], v[164:167]
buffer_load_dwordx4 v228, s[20:23], s54 offen offset:0 sc1 lds
v_mfma_f32_16x16x32_bf16 v[168:171], a[8:11], a[208:211], 0
ds_read_b128 a[208:211], v229 offset:20480
v_permlane16_swap_b32 v133, v134
v_mfma_f32_16x16x32_bf16 v[168:171], a[24:27], a[212:215], v[168:171]
ds_read_b128 a[212:215], v229 offset:21504
v_mov_b32 v132, v133
v_mfma_f32_16x16x32_bf16 v[184:187], a[76:79], v[192:195], 0
ds_read_b64_tr_b16 a[76:77], v239 offset:3080
v_fma_f32 v152, v152, s35, -v134
v_mfma_f32_16x16x32_bf16 v[184:187], a[92:95], v[196:199], v[184:187]
ds_read_b64_tr_b16 a[78:79], v239 offset:15368
ds_read_b64_tr_b16 a[92:93], v239 offset:27656
v_fma_f32 v153, v153, s35, -v134
v_mfma_f32_16x16x32_bf16 v[184:187], a[108:111], v[200:203], v[184:187]
ds_read_b64_tr_b16 a[94:95], v241 offset:200
v_fma_f32 v154, v154, s35, -v134
v_mfma_f32_16x16x32_bf16 v[184:187], a[124:127], v[204:207], v[184:187]
ds_read_b64_tr_b16 a[108:109], v240 offset:3080
ds_read_b64_tr_b16 a[110:111], v240 offset:15368
v_fma_f32 v155, v155, s35, -v134
v_mfma_f32_16x16x32_bf16 v[188:191], a[140:143], v[192:195], 0
ds_read_b64_tr_b16 a[124:125], v240 offset:27656
v_fma_f32 v56, v56, s35, -v134
v_mfma_f32_16x16x32_bf16 v[188:191], a[156:159], v[196:199], v[188:191]
ds_read_b64_tr_b16 a[140:141], v239 offset:4096
v_fma_f32 v57, v57, s35, -v134
v_mfma_f32_16x16x32_bf16 v[188:191], a[172:175], v[200:203], v[188:191]
ds_read_b64_tr_b16 a[142:143], v239 offset:16384
ds_read_b64_tr_b16 a[156:157], v239 offset:28672
v_cvt_pk_bf16_f32 v20, v184, v185
v_mfma_f32_16x16x32_bf16 v[188:191], a[188:191], v[204:207], v[188:191]
s_waitcnt lgkmcnt(15)
ds_read_b64_tr_b16 a[158:159], v241 offset:256
v_cvt_pk_bf16_f32 v21, v186, v187
v_mfma_f32_16x16x32_bf16 v[160:163], a[32:35], a[216:219], v[160:163]
ds_read_b64_tr_b16 a[172:173], v240 offset:4096
ds_read_b64_tr_b16 a[174:175], v240 offset:16384
v_fma_f32 v58, v58, s35, -v134
v_mfma_f32_16x16x32_bf16 v[160:163], a[48:51], a[220:223], v[160:163]
ds_read_b64_tr_b16 a[188:189], v240 offset:28672
v_fma_f32 v59, v59, s35, -v134
v_mfma_f32_16x16x32_bf16 v[164:167], a[36:39], a[216:219], v[164:167]
v_cvt_pk_bf16_f32 v22, v188, v189
v_cvt_pk_bf16_f32 v23, v190, v191
v_mfma_f32_16x16x32_bf16 v[164:167], a[52:55], a[220:223], v[164:167]
buffer_load_dwordx4 v228, s[20:23], s54 offen offset:1024 sc1 lds
v_mfma_f32_16x16x32_bf16 v[168:171], a[40:43], a[216:219], v[168:171]
ds_read_b128 a[216:219], v229 offset:22528
v_fma_f32 v88, v88, s35, -v134
v_mfma_f32_16x16x32_bf16 v[168:171], a[56:59], a[220:223], v[168:171]
ds_read_b128 a[220:223], v229 offset:23552
v_permlane32_swap_b32 v132, v133
v_mfma_f32_16x16x32_bf16 v[176:179], a[224:227], v[192:195], 0
ds_read_b64_tr_b16 a[224:225], v239 offset:4104
v_fma_f32 v144, v144, s35, -v132
v_mfma_f32_16x16x32_bf16 v[176:179], a[228:231], v[196:199], v[176:179]
ds_read_b64_tr_b16 a[226:227], v239 offset:16392
v_fma_f32 v145, v145, s35, -v132
v_mfma_f32_16x16x32_bf16 v[176:179], a[232:235], v[200:203], v[176:179]
ds_read_b64_tr_b16 a[228:229], v239 offset:28680
ds_read_b64_tr_b16 a[230:231], v241 offset:264
v_fma_f32 v146, v146, s35, -v132
v_mfma_f32_16x16x32_bf16 v[176:179], a[236:239], v[204:207], v[176:179]
ds_read_b64_tr_b16 a[232:233], v240 offset:4104
v_fma_f32 v147, v147, s35, -v132
v_mfma_f32_16x16x32_bf16 v[180:183], a[240:243], v[192:195], 0
ds_read_b64_tr_b16 a[234:235], v240 offset:16392
ds_read_b64_tr_b16 a[236:237], v240 offset:28680
v_fma_f32 v48, v48, s35, -v132
v_mfma_f32_16x16x32_bf16 v[180:183], a[244:247], v[196:199], v[180:183]
ds_read_b64_tr_b16 a[240:241], v239 offset:5120
v_fma_f32 v49, v49, s35, -v132
v_mfma_f32_16x16x32_bf16 v[180:183], a[248:251], v[200:203], v[180:183]
ds_read_b64_tr_b16 a[242:243], v239 offset:17408
v_cvt_pk_bf16_f32 v24, v176, v177
v_mfma_f32_16x16x32_bf16 v[180:183], a[252:255], v[204:207], v[180:183]
ds_read_b64_tr_b16 a[244:245], v239 offset:29696
ds_read_b64_tr_b16 a[246:247], v241 offset:320
v_cvt_pk_bf16_f32 v25, v178, v179
v_mfma_f32_16x16x32_bf16 v[160:163], a[64:67], a[192:195], v[160:163]
ds_read_b64_tr_b16 a[248:249], v240 offset:5120
v_fma_f32 v148, v148, s35, -v133
v_mfma_f32_16x16x32_bf16 v[160:163], a[80:83], a[196:199], v[160:163]
ds_read_b64_tr_b16 a[250:251], v240 offset:17408
ds_read_b64_tr_b16 a[252:253], v240 offset:29696
v_cvt_pk_bf16_f32 v26, v180, v181
v_mfma_f32_16x16x32_bf16 v[164:167], a[68:71], a[192:195], v[164:167]
v_cvt_pk_bf16_f32 v27, v182, v183
v_fma_f32 v149, v149, s35, -v133
v_mfma_f32_16x16x32_bf16 v[164:167], a[84:87], a[196:199], v[164:167]
buffer_load_dwordx4 v228, s[20:23], s54 offen offset:2048 sc1 lds
v_mfma_f32_16x16x32_bf16 v[168:171], a[72:75], a[192:195], v[168:171]
v_fma_f32 v150, v150, s35, -v133
v_fma_f32 v151, v151, s35, -v133
v_fma_f32 v52, v52, s35, -v133
v_mfma_f32_16x16x32_bf16 v[168:171], a[88:91], a[196:199], v[168:171]
s_waitcnt lgkmcnt(15)
v_exp_f32 v144, v144
v_mfma_f32_16x16x32_bf16 v[184:187], a[12:15], v[192:195], 0
ds_read_b64_tr_b16 a[12:13], v239 offset:5128
ds_read_b64_tr_b16 a[14:15], v239 offset:17416
v_fma_f32 v53, v53, s35, -v133
v_mfma_f32_16x16x32_bf16 v[184:187], a[28:31], v[196:199], v[184:187]
ds_read_b64_tr_b16 a[28:29], v239 offset:29704
v_fma_f32 v50, v50, s35, -v132
v_mfma_f32_16x16x32_bf16 v[184:187], a[44:47], v[200:203], v[184:187]
ds_read_b64_tr_b16 a[30:31], v241 offset:328
v_fma_f32 v51, v51, s35, -v132
v_mfma_f32_16x16x32_bf16 v[184:187], a[60:63], v[204:207], v[184:187]
ds_read_b64_tr_b16 a[44:45], v240 offset:5128
ds_read_b64_tr_b16 a[46:47], v240 offset:17416
v_fma_f32 v80, v80, s35, -v132
v_mfma_f32_16x16x32_bf16 v[188:191], a[76:79], v[192:195], 0
ds_read_b64_tr_b16 a[60:61], v240 offset:29704
v_fma_f32 v81, v81, s35, -v132
v_mfma_f32_16x16x32_bf16 v[188:191], a[92:95], v[196:199], v[188:191]
ds_read_b64_tr_b16 a[76:77], v239 offset:6144
ds_read_b64_tr_b16 a[78:79], v239 offset:18432
v_cvt_pk_bf16_f32 v28, v184, v185
v_mfma_f32_16x16x32_bf16 v[188:191], a[108:111], v[200:203], v[188:191]
ds_read_b64_tr_b16 a[92:93], v239 offset:30720
v_cvt_pk_bf16_f32 v29, v186, v187
v_mfma_f32_16x16x32_bf16 v[188:191], a[124:127], v[204:207], v[188:191]
ds_read_b64_tr_b16 a[94:95], v241 offset:384
v_fma_f32 v82, v82, s35, -v132
v_mfma_f32_16x16x32_bf16 v[160:163], a[96:99], a[200:203], v[160:163]
ds_read_b64_tr_b16 a[108:109], v240 offset:6144
ds_read_b64_tr_b16 a[110:111], v240 offset:18432
v_fma_f32 v83, v83, s35, -v132
v_mfma_f32_16x16x32_bf16 v[160:163], a[112:115], a[204:207], v[160:163]
ds_read_b64_tr_b16 a[124:125], v240 offset:30720
v_fma_f32 v128, v128, s35, -v132
v_mfma_f32_16x16x32_bf16 v[164:167], a[100:103], a[200:203], v[164:167]
s_waitcnt vmcnt(3)
s_barrier
ds_read_b128 a[192:195], v228 offset:0
v_cvt_pk_bf16_f32 v30, v188, v189
v_mfma_f32_16x16x32_bf16 v[164:167], a[116:119], a[204:207], v[164:167]
ds_read_b128 a[196:199], v228 offset:1024
v_cvt_pk_bf16_f32 v31, v190, v191
v_mfma_f32_16x16x32_bf16 v[168:171], a[104:107], a[200:203], v[168:171]
ds_read_b128 a[200:203], v228 offset:2048
v_fma_f32 v54, v54, s35, -v133
v_mfma_f32_16x16x32_bf16 v[168:171], a[120:123], a[204:207], v[168:171]
ds_read_b128 a[204:207], v228 offset:3072
v_fma_f32 v55, v55, s35, -v133
v_fma_f32 v84, v84, s35, -v133
v_mfma_f32_16x16x32_bf16 v[176:179], a[140:143], v[192:195], 0
ds_read_b64_tr_b16 a[140:141], v239 offset:6152
v_fma_f32 v85, v85, s35, -v133
v_mfma_f32_16x16x32_bf16 v[176:179], a[156:159], v[196:199], v[176:179]
ds_read_b64_tr_b16 a[142:143], v239 offset:18440
ds_read_b64_tr_b16 a[156:157], v239 offset:30728
v_fma_f32 v86, v86, s35, -v133
v_mfma_f32_16x16x32_bf16 v[176:179], a[172:175], v[200:203], v[176:179]
ds_read_b64_tr_b16 a[158:159], v241 offset:392
v_fma_f32 v87, v87, s35, -v133
v_mfma_f32_16x16x32_bf16 v[176:179], a[188:191], v[204:207], v[176:179]
s_waitcnt lgkmcnt(15)
ds_read_b64_tr_b16 a[172:173], v240 offset:6152
v_fma_f32 v129, v129, s35, -v133
v_mfma_f32_16x16x32_bf16 v[180:183], a[224:227], v[192:195], 0
ds_read_b64_tr_b16 a[174:175], v240 offset:18440
ds_read_b64_tr_b16 a[188:189], v240 offset:30728
v_fma_f32 v89, v89, s35, -v134
v_mfma_f32_16x16x32_bf16 v[180:183], a[228:231], v[196:199], v[180:183]
ds_read_b64_tr_b16 a[224:225], v239 offset:7168
v_fma_f32 v90, v90, s35, -v134
v_mfma_f32_16x16x32_bf16 v[180:183], a[232:235], v[200:203], v[180:183]
ds_read_b64_tr_b16 a[226:227], v239 offset:19456
ds_read_b64_tr_b16 a[228:229], v239 offset:31744
v_cvt_pk_bf16_f32 v208, v176, v177
v_mfma_f32_16x16x32_bf16 v[180:183], a[236:239], v[204:207], v[180:183]
ds_read_b64_tr_b16 a[230:231], v241 offset:448
v_cvt_pk_bf16_f32 v209, v178, v179
v_mfma_f32_16x16x32_bf16 v[160:163], a[128:131], a[208:211], v[160:163]
ds_read_b64_tr_b16 a[232:233], v240 offset:7168
v_fma_f32 v91, v91, s35, -v134
v_mfma_f32_16x16x32_bf16 v[160:163], a[144:147], a[212:215], v[160:163]
ds_read_b64_tr_b16 a[234:235], v240 offset:19456
ds_read_b64_tr_b16 a[236:237], v240 offset:31744
v_fma_f32 v130, v130, s35, -v134
v_mfma_f32_16x16x32_bf16 v[164:167], a[132:135], a[208:211], v[164:167]
v_cvt_pk_bf16_f32 v210, v180, v181
v_cvt_pk_bf16_f32 v211, v182, v183
v_mfma_f32_16x16x32_bf16 v[164:167], a[148:151], a[212:215], v[164:167]
buffer_load_dwordx4 v228, s[20:23], s54 offen offset:3072 sc1 lds
v_mfma_f32_16x16x32_bf16 v[168:171], a[136:139], a[208:211], v[168:171]
s_add_u32 m0, s34, 28672
ds_read_b128 a[208:211], v228 offset:4096
v_mfma_f32_16x16x32_bf16 v[168:171], a[152:155], a[212:215], v[168:171]
s_add_u32 s55, s34, 348160
ds_read_b128 a[212:215], v228 offset:5120
v_mfma_f32_16x16x32_bf16 v[184:187], a[240:243], v[192:195], 0
ds_read_b64_tr_b16 a[240:241], v239 offset:7176
ds_read_b64_tr_b16 a[242:243], v239 offset:19464
v_mfma_f32_16x16x32_bf16 v[184:187], a[244:247], v[196:199], v[184:187]
ds_read_b64_tr_b16 a[244:245], v239 offset:31752
v_mfma_f32_16x16x32_bf16 v[184:187], a[248:251], v[200:203], v[184:187]
ds_read_b64_tr_b16 a[246:247], v241 offset:456
ds_read_b64_tr_b16 a[248:249], v240 offset:7176
v_mfma_f32_16x16x32_bf16 v[184:187], a[252:255], v[204:207], v[184:187]
ds_read_b64_tr_b16 a[250:251], v240 offset:19464
v_mfma_f32_16x16x32_bf16 v[188:191], a[12:15], v[192:195], 0
ds_read_b64_tr_b16 a[252:253], v240 offset:31752
v_mfma_f32_16x16x32_bf16 v[188:191], a[28:31], v[196:199], v[188:191]
ds_read_b64_tr_b16 a[12:13], v239 offset:8192
ds_read_b64_tr_b16 a[14:15], v239 offset:20480
v_mfma_f32_16x16x32_bf16 v[188:191], a[44:47], v[200:203], v[188:191]
ds_read_b64_tr_b16 a[28:29], v239 offset:32768
v_cvt_pk_bf16_f32 v212, v184, v185
v_mfma_f32_16x16x32_bf16 v[188:191], a[60:63], v[204:207], v[188:191]
ds_read_b64_tr_b16 a[30:31], v241 offset:512
ds_read_b64_tr_b16 a[44:45], v240 offset:8192
v_cvt_pk_bf16_f32 v213, v186, v187
v_mfma_f32_16x16x32_bf16 v[160:163], a[160:163], a[216:219], v[160:163]
ds_read_b64_tr_b16 a[46:47], v240 offset:20480
v_mfma_f32_16x16x32_bf16 v[160:163], a[176:179], a[220:223], v[160:163]
ds_read_b64_tr_b16 a[60:61], v240 offset:32768
v_mfma_f32_16x16x32_bf16 v[164:167], a[164:167], a[216:219], v[164:167]
v_cvt_pk_bf16_f32 v214, v188, v189
v_cvt_pk_bf16_f32 v215, v190, v191
v_mfma_f32_16x16x32_bf16 v[164:167], a[180:183], a[220:223], v[164:167]
buffer_load_dwordx4 v228, s[20:23], s55 offen offset:0 sc1 lds
v_mfma_f32_16x16x32_bf16 v[168:171], a[168:171], a[216:219], v[168:171]
ds_read_b128 a[216:219], v228 offset:6144
v_cvt_pk_bf16_f32 v120, v160, v161
v_cvt_pk_bf16_f32 v121, v162, v163
v_mfma_f32_16x16x32_bf16 v[168:171], a[184:187], a[220:223], v[168:171]
s_waitcnt lgkmcnt(15)
ds_read_b128 a[220:223], v228 offset:7168
v_mfma_f32_16x16x32_bf16 v[176:179], a[76:79], v[192:195], 0
ds_read_b64_tr_b16 a[76:77], v239 offset:8200
v_cvt_pk_bf16_f32 v122, v164, v165
v_mfma_f32_16x16x32_bf16 v[176:179], a[92:95], v[196:199], v[176:179]
ds_read_b64_tr_b16 a[78:79], v239 offset:20488
ds_read_b64_tr_b16 a[92:93], v239 offset:32776
v_cvt_pk_bf16_f32 v123, v166, v167
v_mfma_f32_16x16x32_bf16 v[176:179], a[108:111], v[200:203], v[176:179]
ds_read_b64_tr_b16 a[94:95], v241 offset:520
v_cvt_pk_bf16_f32 v124, v168, v169
v_mfma_f32_16x16x32_bf16 v[176:179], a[124:127], v[204:207], v[176:179]
ds_read_b64_tr_b16 a[108:109], v240 offset:8200
ds_read_b64_tr_b16 a[110:111], v240 offset:20488
v_cvt_pk_bf16_f32 v125, v170, v171
v_mfma_f32_16x16x32_bf16 v[180:183], a[140:143], v[192:195], 0
ds_read_b64_tr_b16 a[124:125], v240 offset:32776
v_mfma_f32_16x16x32_bf16 v[180:183], a[156:159], v[196:199], v[180:183]
ds_read_b64_tr_b16 a[140:141], v239 offset:9216
v_mfma_f32_16x16x32_bf16 v[180:183], a[172:175], v[200:203], v[180:183]
ds_read_b64_tr_b16 a[142:143], v239 offset:21504
ds_read_b64_tr_b16 a[156:157], v239 offset:33792
v_cvt_pk_bf16_f32 v216, v176, v177
v_mfma_f32_16x16x32_bf16 v[180:183], a[188:191], v[204:207], v[180:183]
ds_read_b64_tr_b16 a[158:159], v241 offset:576
v_cvt_pk_bf16_f32 v217, v178, v179
v_mfma_f32_16x16x32_bf16 v[96:99], a[0:3], a[192:195], 0
ds_read_b64_tr_b16 a[172:173], v240 offset:9216
ds_read_b64_tr_b16 a[174:175], v240 offset:21504
v_mfma_f32_16x16x32_bf16 v[96:99], a[16:19], a[196:199], v[96:99]
ds_read_b64_tr_b16 a[188:189], v240 offset:33792
v_mfma_f32_16x16x32_bf16 v[100:103], a[4:7], a[192:195], 0
buffer_load_dwordx4 v228, s[20:23], s55 offen offset:1024 sc1 lds
v_mfma_f32_16x16x32_bf16 v[100:103], a[20:23], a[196:199], v[100:103]
v_cvt_pk_bf16_f32 v218, v180, v181
v_cvt_pk_bf16_f32 v219, v182, v183
v_mfma_f32_16x16x32_bf16 v[104:107], a[8:11], a[192:195], 0
ds_read_b128 a[192:195], v228 offset:8192
v_mfma_f32_16x16x32_bf16 v[104:107], a[24:27], a[196:199], v[104:107]
ds_read_b128 a[196:199], v228 offset:9216
v_mfma_f32_16x16x32_bf16 v[184:187], a[224:227], v[192:195], 0
ds_read_b64_tr_b16 a[224:225], v239 offset:9224
v_mfma_f32_16x16x32_bf16 v[184:187], a[228:231], v[196:199], v[184:187]
ds_read_b64_tr_b16 a[226:227], v239 offset:21512
v_mfma_f32_16x16x32_bf16 v[184:187], a[232:235], v[200:203], v[184:187]
ds_read_b64_tr_b16 a[228:229], v239 offset:33800
ds_read_b64_tr_b16 a[230:231], v241 offset:584
v_mfma_f32_16x16x32_bf16 v[184:187], a[236:239], v[204:207], v[184:187]
s_waitcnt lgkmcnt(15)
ds_read_b64_tr_b16 a[232:233], v240 offset:9224
v_mfma_f32_16x16x32_bf16 v[188:191], a[240:243], v[192:195], 0
ds_read_b64_tr_b16 a[234:235], v240 offset:21512
ds_read_b64_tr_b16 a[236:237], v240 offset:33800
v_mfma_f32_16x16x32_bf16 v[188:191], a[244:247], v[196:199], v[188:191]
ds_read_b64_tr_b16 a[240:241], v239 offset:10240
v_mfma_f32_16x16x32_bf16 v[188:191], a[248:251], v[200:203], v[188:191]
ds_read_b64_tr_b16 a[242:243], v239 offset:22528
v_cvt_pk_bf16_f32 v220, v184, v185
v_mfma_f32_16x16x32_bf16 v[188:191], a[252:255], v[204:207], v[188:191]
ds_read_b64_tr_b16 a[244:245], v239 offset:34816
ds_read_b64_tr_b16 a[246:247], v241 offset:640
v_cvt_pk_bf16_f32 v221, v186, v187
v_mfma_f32_16x16x32_bf16 v[96:99], a[32:35], a[200:203], v[96:99]
ds_read_b64_tr_b16 a[248:249], v240 offset:10240
v_mfma_f32_16x16x32_bf16 v[96:99], a[48:51], a[204:207], v[96:99]
ds_read_b64_tr_b16 a[250:251], v240 offset:22528
ds_read_b64_tr_b16 a[252:253], v240 offset:34816
v_cvt_pk_bf16_f32 v222, v188, v189
v_mfma_f32_16x16x32_bf16 v[100:103], a[36:39], a[200:203], v[100:103]
v_cvt_pk_bf16_f32 v223, v190, v191
v_mfma_f32_16x16x32_bf16 v[100:103], a[52:55], a[204:207], v[100:103]
v_exp_f32 v145, v145
v_mfma_f32_16x16x32_bf16 v[104:107], a[40:43], a[200:203], v[104:107]
v_exp_f32 v146, v146
v_add_f32 v132, v144, v145
v_mfma_f32_16x16x32_bf16 v[104:107], a[56:59], a[204:207], v[104:107]
v_exp_f32 v147, v147
v_mfma_f32_16x16x32_bf16 v[176:179], a[12:15], v[192:195], 0
ds_read_b64_tr_b16 a[12:13], v239 offset:10248
ds_read_b64_tr_b16 a[14:15], v239 offset:22536
v_add_f32 v136, v146, v147
v_mfma_f32_16x16x32_bf16 v[176:179], a[28:31], v[196:199], v[176:179]
ds_read_b64_tr_b16 a[28:29], v239 offset:34824
v_mfma_f32_16x16x32_bf16 v[176:179], a[44:47], v[200:203], v[176:179]
ds_read_b64_tr_b16 a[30:31], v241 offset:648
v_mfma_f32_16x16x32_bf16 v[176:179], a[60:63], v[204:207], v[176:179]
s_waitcnt lgkmcnt(15)
ds_read_b64_tr_b16 a[44:45], v240 offset:10248
ds_read_b64_tr_b16 a[46:47], v240 offset:22536
v_mfma_f32_16x16x32_bf16 v[180:183], a[76:79], v[192:195], 0
ds_read_b64_tr_b16 a[60:61], v240 offset:34824
v_mfma_f32_16x16x32_bf16 v[180:183], a[92:95], v[196:199], v[180:183]
ds_read_b64_tr_b16 a[76:77], v239 offset:11264
ds_read_b64_tr_b16 a[78:79], v239 offset:23552
v_mfma_f32_16x16x32_bf16 v[180:183], a[108:111], v[200:203], v[180:183]
ds_read_b64_tr_b16 a[92:93], v239 offset:35840
v_cvt_pk_bf16_f32 v32, v176, v177
v_mfma_f32_16x16x32_bf16 v[180:183], a[124:127], v[204:207], v[180:183]
ds_read_b64_tr_b16 a[94:95], v241 offset:704
v_cvt_pk_bf16_f32 v33, v178, v179
v_mfma_f32_16x16x32_bf16 v[96:99], a[64:67], a[208:211], v[96:99]
ds_read_b64_tr_b16 a[108:109], v240 offset:11264
ds_read_b64_tr_b16 a[110:111], v240 offset:23552
v_mfma_f32_16x16x32_bf16 v[96:99], a[80:83], a[212:215], v[96:99]
ds_read_b64_tr_b16 a[124:125], v240 offset:35840
v_mfma_f32_16x16x32_bf16 v[100:103], a[68:71], a[208:211], v[100:103]
v_cvt_pk_bf16_f32 v34, v180, v181
v_cvt_pk_bf16_f32 v35, v182, v183
ds_read_b128 a[200:203], v228 offset:10240
v_mfma_f32_16x16x32_bf16 v[100:103], a[84:87], a[212:215], v[100:103]
v_exp_f32 v48, v48
v_mfma_f32_16x16x32_bf16 v[104:107], a[72:75], a[208:211], v[104:107]
v_exp_f32 v49, v49
v_mfma_f32_16x16x32_bf16 v[104:107], a[88:91], a[212:215], v[104:107]
v_exp_f32 v148, v148
v_add_f32 v137, v48, v49
v_mfma_f32_16x16x32_bf16 v[184:187], a[140:143], v[192:195], 0
ds_read_b64_tr_b16 a[140:141], v239 offset:11272
v_mfma_f32_16x16x32_bf16 v[184:187], a[156:159], v[196:199], v[184:187]
ds_read_b64_tr_b16 a[142:143], v239 offset:23560
ds_read_b64_tr_b16 a[156:157], v239 offset:35848
v_mfma_f32_16x16x32_bf16 v[184:187], a[172:175], v[200:203], v[184:187]
ds_read_b64_tr_b16 a[158:159], v241 offset:712
v_mfma_f32_16x16x32_bf16 v[184:187], a[188:191], v[204:207], v[184:187]
s_waitcnt lgkmcnt(15)
ds_read_b64_tr_b16 a[172:173], v240 offset:11272
v_mfma_f32_16x16x32_bf16 v[188:191], a[224:227], v[192:195], 0
ds_read_b64_tr_b16 a[174:175], v240 offset:23560
ds_read_b64_tr_b16 a[188:189], v240 offset:35848
v_mfma_f32_16x16x32_bf16 v[188:191], a[228:231], v[196:199], v[188:191]
v_exp_f32 v149, v149
v_mfma_f32_16x16x32_bf16 v[188:191], a[232:235], v[200:203], v[188:191]
ds_read_b128 a[204:207], v228 offset:11264
v_cvt_pk_bf16_f32 v36, v184, v185
v_cvt_pk_bf16_f32 v37, v186, v187
v_mfma_f32_16x16x32_bf16 v[188:191], a[236:239], v[204:207], v[188:191]
v_exp_f32 v150, v150
v_mfma_f32_16x16x32_bf16 v[96:99], a[96:99], a[216:219], v[96:99]
v_exp_f32 v151, v151
v_mfma_f32_16x16x32_bf16 v[96:99], a[112:115], a[220:223], v[96:99]
ds_read_b128 a[208:211], v228 offset:12288
ds_read_b128 a[212:215], v228 offset:13312
v_add_f32 v133, v148, v149
v_mfma_f32_16x16x32_bf16 v[100:103], a[100:103], a[216:219], v[100:103]
v_cvt_pk_bf16_f32 v38, v188, v189
ds_read_b128 a[224:227], v229 offset:0
v_mfma_f32_16x16x32_bf16 v[100:103], a[116:119], a[220:223], v[100:103]
v_exp_f32 v52, v52
v_cvt_pk_bf16_f32 v39, v190, v191
v_mfma_f32_16x16x32_bf16 v[104:107], a[104:107], a[216:219], v[104:107]
s_waitcnt lgkmcnt(4)
s_barrier
s_add_u32 m0, s34, 73728
v_mfma_f32_16x16x32_bf16 v[104:107], a[120:123], a[220:223], v[104:107]
s_add_u32 s50, s34, 368640
buffer_load_dwordx4 v228, s[20:23], s50 offen offset:0 sc1 lds
v_mfma_f32_16x16x32_bf16 v[176:179], a[240:243], v[192:195], 0
ds_read_b128 a[232:235], v229 offset:2048
ds_read_b128 a[228:231], v229 offset:1024
v_add_f32 v138, v150, v151
v_mfma_f32_16x16x32_bf16 v[176:179], a[244:247], v[196:199], v[176:179]
v_exp_f32 v53, v53
v_mfma_f32_16x16x32_bf16 v[176:179], a[248:251], v[200:203], v[176:179]
ds_read_b128 a[236:239], v229 offset:3072
ds_read_b128 a[244:247], v229 offset:5120
v_add_f32 v139, v52, v53
v_mfma_f32_16x16x32_bf16 v[176:179], a[252:255], v[204:207], v[176:179]
buffer_load_dwordx4 v228, s[20:23], s50 offen offset:1024 sc1 lds
v_mfma_f32_16x16x32_bf16 v[180:183], a[12:15], v[192:195], 0
ds_read_b128 a[240:243], v229 offset:4096
v_mfma_f32_16x16x32_bf16 v[180:183], a[28:31], v[196:199], v[180:183]
ds_read_b128 a[248:251], v229 offset:6144
ds_read_b128 a[12:15], v229 offset:8192
v_mfma_f32_16x16x32_bf16 v[180:183], a[44:47], v[200:203], v[180:183]
v_exp_f32 v50, v50
v_mfma_f32_16x16x32_bf16 v[180:183], a[60:63], v[204:207], v[180:183]
buffer_load_dwordx4 v228, s[20:23], s50 offen offset:2048 sc1 lds
v_mfma_f32_16x16x32_bf16 v[96:99], a[128:131], a[192:195], v[96:99]
ds_read_b128 a[252:255], v229 offset:7168
v_cvt_pk_bf16_f32 v40, v176, v177
v_mfma_f32_16x16x32_bf16 v[96:99], a[144:147], a[196:199], v[96:99]
v_exp_f32 v51, v51
v_mfma_f32_16x16x32_bf16 v[100:103], a[132:135], a[192:195], v[100:103]
ds_read_b128 a[28:31], v229 offset:9216
ds_read_b128 a[60:63], v229 offset:11264
v_cvt_pk_bf16_f32 v41, v178, v179
v_mfma_f32_16x16x32_bf16 v[100:103], a[148:151], a[196:199], v[100:103]
buffer_load_dwordx4 v228, s[20:23], s50 offen offset:3072 sc1 lds
v_mfma_f32_16x16x32_bf16 v[104:107], a[136:139], a[192:195], v[104:107]
s_add_u32 m0, s34, 77824
s_add_u32 s51, s34, 372736
ds_read_b128 a[44:47], v229 offset:10240
v_cvt_pk_bf16_f32 v42, v180, v181
v_mfma_f32_16x16x32_bf16 v[104:107], a[152:155], a[196:199], v[104:107]
s_mov_b32 s50, 24576
v_exp_f32 v80, v80
v_mfma_f32_16x16x32_bf16 v[184:187], a[76:79], v[192:195], 0
v_exp_f32 v54, v54
v_mfma_f32_16x16x32_bf16 v[184:187], a[92:95], v[196:199], v[184:187]
buffer_load_dwordx4 v228, s[20:23], s51 offen offset:0 sc1 lds
v_mfma_f32_16x16x32_bf16 v[184:187], a[108:111], v[200:203], v[184:187]
ds_read_b128 a[216:219], v228 offset:14336
v_cvt_pk_bf16_f32 v43, v182, v183
v_mfma_f32_16x16x32_bf16 v[184:187], a[124:127], v[204:207], v[184:187]
v_exp_f32 v55, v55
v_add_f32 v132, v132, v50
v_mfma_f32_16x16x32_bf16 v[188:191], a[140:143], v[192:195], 0
ds_read_b128 a[220:223], v228 offset:15360
v_add_f32 v136, v136, v51
v_mfma_f32_16x16x32_bf16 v[188:191], a[156:159], v[196:199], v[188:191]
buffer_load_dwordx4 v228, s[20:23], s51 offen offset:1024 sc1 lds
v_mfma_f32_16x16x32_bf16 v[188:191], a[172:175], v[200:203], v[188:191]
s_add_u32 m0, s34, 98304
v_exp_f32 v84, v84
v_cvt_pk_bf16_f32 v44, v184, v185
v_mfma_f32_16x16x32_bf16 v[188:191], a[188:191], v[204:207], v[188:191]
s_waitcnt lgkmcnt(15)
s_add_u32 s52, s34, 393216
v_exp_f32 v152, v152
v_mfma_f32_16x16x32_bf16 v[96:99], a[160:163], a[200:203], v[96:99]
s_mov_b32 s51, 73728
v_exp_f32 v153, v153
v_cvt_pk_bf16_f32 v45, v186, v187
v_mfma_f32_16x16x32_bf16 v[96:99], a[176:179], a[204:207], v[96:99]
v_exp_f32 v154, v154
v_mfma_f32_16x16x32_bf16 v[100:103], a[164:167], a[200:203], v[100:103]
v_exp_f32 v155, v155
v_mfma_f32_16x16x32_bf16 v[100:103], a[180:183], a[204:207], v[100:103]
ds_read_b128 a[76:79], v229 offset:12288
ds_read_b128 a[108:111], v229 offset:14336
v_cvt_pk_bf16_f32 v46, v188, v189
v_mfma_f32_16x16x32_bf16 v[104:107], a[168:171], a[200:203], v[104:107]
ds_read_b128 a[92:95], v229 offset:13312
v_cvt_pk_bf16_f32 v47, v190, v191
v_mfma_f32_16x16x32_bf16 v[104:107], a[184:187], a[204:207], v[104:107]
s_waitcnt lgkmcnt(15)
v_exp_f32 v56, v56
v_add_f32 v137, v137, v80
v_mfma_f32_16x16x32_bf16 v[160:163], a[0:3], a[208:211], 0
v_exp_f32 v57, v57
v_mfma_f32_16x16x32_bf16 v[160:163], a[16:19], a[212:215], v[160:163]
v_exp_f32 v81, v81
v_mfma_f32_16x16x32_bf16 v[164:167], a[4:7], a[208:211], 0
v_exp_f32 v82, v82
v_add_f32 v133, v133, v54
v_mfma_f32_16x16x32_bf16 v[164:167], a[20:23], a[212:215], v[164:167]
ds_read_b128 a[124:127], v229 offset:15360
v_add_f32 v138, v138, v55
v_mfma_f32_16x16x32_bf16 v[168:171], a[8:11], a[208:211], 0
ds_read_b128 a[156:159], v229 offset:17408
ds_read_b128 a[140:143], v229 offset:16384
v_add_f32 v139, v139, v84
v_mfma_f32_16x16x32_bf16 v[168:171], a[24:27], a[212:215], v[168:171]
v_exp_f32 v83, v83
v_mfma_f32_16x16x32_bf16 v[108:111], v[16:19], a[224:227], 0
s_waitcnt lgkmcnt(15)
v_exp_f32 v85, v85
v_mfma_f32_16x16x32_bf16 v[108:111], v[20:23], a[228:231], v[108:111]
v_exp_f32 v86, v86
v_add_f32 v134, v152, v153
v_mfma_f32_16x16x32_bf16 v[108:111], v[24:27], a[232:235], v[108:111]
ds_read_b128 a[172:175], v229 offset:18432
v_add_f32 v140, v154, v155
v_mfma_f32_16x16x32_bf16 v[108:111], v[28:31], a[236:239], v[108:111]
s_waitcnt lgkmcnt(15)
ds_read_b128 a[224:227], v229 offset:20480
ds_read_b128 a[188:191], v229 offset:19456
v_add_f32 v141, v56, v57
v_mfma_f32_16x16x32_bf16 v[108:111], v[208:211], a[240:243], v[108:111]
v_exp_f32 v87, v87
v_mfma_f32_16x16x32_bf16 v[108:111], v[212:215], a[244:247], v[108:111]
s_waitcnt lgkmcnt(15)
v_exp_f32 v58, v58
v_mfma_f32_16x16x32_bf16 v[108:111], v[216:219], a[248:251], v[108:111]
s_waitcnt lgkmcnt(14)
v_exp_f32 v59, v59
v_add_f32 v132, v132, v81
v_mfma_f32_16x16x32_bf16 v[108:111], v[220:223], a[252:255], v[108:111]
ds_read_b128 a[228:231], v229 offset:21504
v_add_f32 v136, v136, v82
v_mfma_f32_16x16x32_bf16 v[108:111], v[32:35], a[12:15], v[108:111]
s_waitcnt lgkmcnt(13)
v_exp_f32 v88, v88
v_add_f32 v137, v137, v83
v_mfma_f32_16x16x32_bf16 v[108:111], v[36:39], a[28:31], v[108:111]
s_waitcnt lgkmcnt(12)
ds_read_b128 a[236:239], v229 offset:23552
v_add_f32 v133, v133, v85
v_mfma_f32_16x16x32_bf16 v[108:111], v[40:43], a[44:47], v[108:111]
ds_read_b128 a[232:235], v229 offset:22528
v_add_f32 v138, v138, v86
v_mfma_f32_16x16x32_bf16 v[108:111], v[44:47], a[60:63], v[108:111]
s_waitcnt lgkmcnt(12)
v_exp_f32 v128, v128
v_add_f32 v139, v139, v87
v_mfma_f32_16x16x32_bf16 v[160:163], a[32:35], a[216:219], v[160:163]
v_exp_f32 v129, v129
v_mfma_f32_16x16x32_bf16 v[160:163], a[48:51], a[220:223], v[160:163]
ds_read_b128 a[192:195], v228 offset:16384
ds_read_b128 a[196:199], v228 offset:17408
v_add_f32 v134, v134, v58
v_mfma_f32_16x16x32_bf16 v[164:167], a[36:39], a[216:219], v[164:167]
v_exp_f32 v89, v89
v_mfma_f32_16x16x32_bf16 v[164:167], a[52:55], a[220:223], v[164:167]
v_exp_f32 v90, v90
v_mfma_f32_16x16x32_bf16 v[168:171], a[40:43], a[216:219], v[168:171]
v_add_f32 v140, v140, v59
v_exp_f32 v91, v91
v_mfma_f32_16x16x32_bf16 v[168:171], a[56:59], a[220:223], v[168:171]
s_waitcnt lgkmcnt(12)
v_add_f32 v141, v141, v88
v_add_f32 v132, v132, v128
v_mfma_f32_16x16x32_bf16 v[172:175], v[16:19], a[76:79], 0
s_waitcnt lgkmcnt(11)
v_exp_f32 v130, v130
v_add_f32 v136, v136, v137
v_mfma_f32_16x16x32_bf16 v[172:175], v[20:23], a[92:95], v[172:175]
ds_read_b128 a[240:243], v228 offset:0
v_add_f32 v133, v133, v129
v_mfma_f32_16x16x32_bf16 v[172:175], v[24:27], a[108:111], v[172:175]
s_waitcnt lgkmcnt(10)
ds_read_b128 a[248:251], v228 offset:2048
v_add_f32 v138, v138, v139
v_mfma_f32_16x16x32_bf16 v[172:175], v[28:31], a[124:127], v[172:175]
s_waitcnt lgkmcnt(10)
ds_read_b128 a[244:247], v228 offset:1024
v_add_f32 v134, v134, v89
v_add_f32 v140, v140, v90
v_mfma_f32_16x16x32_bf16 v[172:175], v[208:211], a[140:143], v[172:175]
ds_read_b128 a[252:255], v228 offset:3072
v_add_f32 v141, v141, v91
v_mfma_f32_16x16x32_bf16 v[172:175], v[212:215], a[156:159], v[172:175]
s_waitcnt lgkmcnt(10)
ds_read_b128 a[28:31], v228 offset:5120
v_add_f32 v132, v132, v136
v_add_f32 v133, v133, v138
v_mfma_f32_16x16x32_bf16 v[172:175], v[216:219], a[172:175], v[172:175]
s_waitcnt lgkmcnt(10)
ds_read_b128 a[12:15], v228 offset:4096
v_add_f32 v134, v134, v130
v_mfma_f32_16x16x32_bf16 v[172:175], v[220:223], a[188:191], v[172:175]
ds_read_b128 a[44:47], v228 offset:6144
v_add_f32 v140, v140, v141
v_mfma_f32_16x16x32_bf16 v[172:175], v[32:35], a[224:227], v[172:175]
s_waitcnt lgkmcnt(10)
ds_read_b128 a[76:79], v228 offset:8192
v_permlane32_swap_b32 v132, v133
v_mfma_f32_16x16x32_bf16 v[172:175], v[36:39], a[228:231], v[172:175]
s_waitcnt lgkmcnt(10)
ds_read_b128 a[60:63], v228 offset:7168
v_add_f32 v134, v134, v140
v_mfma_f32_16x16x32_bf16 v[172:175], v[40:43], a[232:235], v[172:175]
ds_read_b128 a[92:95], v228 offset:9216
v_mov_b32 v135, v134
v_cvt_pk_bf16_f32 v118, v108, v109
v_mfma_f32_16x16x32_bf16 v[172:175], v[44:47], a[236:239], v[172:175]
s_waitcnt lgkmcnt(10)
ds_read_b128 a[124:127], v228 offset:11264
v_cvt_pk_bf16_f32 v119, v110, v111
v_mfma_f32_16x16x32_bf16 v[160:163], a[64:67], a[192:195], v[160:163]
v_permlane32_swap_b32 v135, v134
v_mfma_f32_16x16x32_bf16 v[160:163], a[80:83], a[196:199], v[160:163]
ds_read_b128 a[108:111], v228 offset:10240
ds_read_b128 a[200:203], v228 offset:18432
v_add_f32 v132, v132, v133
v_mfma_f32_16x16x32_bf16 v[164:167], a[68:71], a[192:195], v[164:167]
ds_read_b128 a[204:207], v228 offset:19456
v_add_f32 v134, v135, v134
v_mfma_f32_16x16x32_bf16 v[164:167], a[84:87], a[196:199], v[164:167]
ds_read_b128 a[140:143], v228 offset:12288
ds_read_b128 a[172:175], v228 offset:14336
v_cvt_pk_bf16_f32 v126, v172, v173
v_mfma_f32_16x16x32_bf16 v[168:171], a[72:75], a[192:195], v[168:171]
v_permlane16_swap_b32 v132, v134
v_mfma_f32_16x16x32_bf16 v[168:171], a[88:91], a[196:199], v[168:171]
s_waitcnt lgkmcnt(14)
ds_read_b128 a[156:159], v228 offset:13312
v_add_f32 v134, v132, v134
v_mfma_f32_16x16x32_bf16 v[108:111], v[16:19], a[240:243], 0
s_waitcnt lgkmcnt(14)
ds_read_b128 a[188:191], v228 offset:15360
ds_read_b128 a[228:231], v228 offset:17408
v_cvt_pk_bf16_f32 v127, v174, v175
v_mfma_f32_16x16x32_bf16 v[108:111], v[20:23], a[244:247], v[108:111]
v_rcp_f32 v134, v134
v_mfma_f32_16x16x32_bf16 v[108:111], v[24:27], a[248:251], v[108:111]
s_waitcnt lgkmcnt(14)
ds_read_b128 a[224:227], v228 offset:16384
v_mov_b32 v133, v134
v_cvt_pk_bf16_f32 v248, v96, v97
v_mfma_f32_16x16x32_bf16 v[108:111], v[28:31], a[252:255], v[108:111]
s_waitcnt lgkmcnt(14)
ds_read_b128 a[232:235], v228 offset:18432
v_cvt_pk_bf16_f32 v249, v98, v99
v_mfma_f32_16x16x32_bf16 v[108:111], v[208:211], a[12:15], v[108:111]
v_permlane16_swap_b32 v133, v134
v_mfma_f32_16x16x32_bf16 v[108:111], v[212:215], a[28:31], v[108:111]
s_waitcnt lgkmcnt(13)
ds_read_b128 a[240:243], v228 offset:20480
v_mov_b32 v132, v133
v_mul_f32 v152, v152, v134
v_mfma_f32_16x16x32_bf16 v[108:111], v[216:219], a[44:47], v[108:111]
s_waitcnt lgkmcnt(13)
ds_read_b128 a[236:239], v228 offset:19456
v_mul_f32 v153, v153, v134
v_mfma_f32_16x16x32_bf16 v[108:111], v[220:223], a[60:63], v[108:111]
v_permlane32_swap_b32 v132, v133
ds_read_b128 a[244:247], v228 offset:21504
v_mfma_f32_16x16x32_bf16 v[108:111], v[32:35], a[76:79], v[108:111]
s_waitcnt lgkmcnt(13)
buffer_load_dwordx4 v228, s[20:23], s52 offen offset:0 sc1 lds
v_mfma_f32_16x16x32_bf16 v[108:111], v[36:39], a[92:95], v[108:111]
s_waitcnt lgkmcnt(12)
ds_read_b128 a[252:255], v228 offset:23552
v_mul_f32 v144, v144, v132
v_mfma_f32_16x16x32_bf16 v[108:111], v[40:43], a[108:111], v[108:111]
ds_read_b128 a[248:251], v228 offset:22528
ds_read_b128 a[208:211], v228 offset:20480
v_mul_f32 v145, v145, v132
v_mfma_f32_16x16x32_bf16 v[108:111], v[44:47], a[124:127], v[108:111]
s_waitcnt lgkmcnt(13)
ds_read_b128 a[212:215], v228 offset:21504
v_mul_f32 v146, v146, v132
v_mfma_f32_16x16x32_bf16 v[160:163], a[96:99], a[200:203], v[160:163]
buffer_load_dwordx4 v228, s[20:23], s52 offen offset:1024 sc1 lds
v_mfma_f32_16x16x32_bf16 v[160:163], a[112:115], a[204:207], v[160:163]
v_mul_f32 v147, v147, v132
v_mul_f32 v48, v48, v132
v_mfma_f32_16x16x32_bf16 v[164:167], a[100:103], a[200:203], v[164:167]
v_mul_f32 v49, v49, v132
v_mul_f32 v50, v50, v132
v_mfma_f32_16x16x32_bf16 v[164:167], a[116:119], a[204:207], v[164:167]
v_mul_f32 v51, v51, v132
v_mul_f32 v80, v80, v132
v_mul_f32 v81, v81, v132
v_mfma_f32_16x16x32_bf16 v[168:171], a[104:107], a[200:203], v[168:171]
buffer_load_dwordx4 v228, s[20:23], s52 offen offset:2048 sc1 lds
v_mfma_f32_16x16x32_bf16 v[168:171], a[120:123], a[204:207], v[168:171]
s_waitcnt lgkmcnt(12)
v_mul_f32 v82, v82, v132
v_mul_f32 v83, v83, v132
v_mul_f32 v128, v128, v132
v_mfma_f32_16x16x32_bf16 v[172:175], v[16:19], a[140:143], 0
s_waitcnt lgkmcnt(11)
v_mul_f32 v148, v148, v133
v_mul_f32 v149, v149, v133
v_mfma_f32_16x16x32_bf16 v[172:175], v[20:23], a[156:159], v[172:175]
v_mul_f32 v150, v150, v133
v_mul_f32 v151, v151, v133
v_mfma_f32_16x16x32_bf16 v[172:175], v[24:27], a[172:175], v[172:175]
s_waitcnt lgkmcnt(9)
buffer_load_dwordx4 v228, s[20:23], s52 offen offset:3072 sc1 lds
v_mfma_f32_16x16x32_bf16 v[172:175], v[28:31], a[188:191], v[172:175]
s_waitcnt lgkmcnt(8)
s_add_u32 m0, s34, 102400
s_add_u32 s53, s34, 397312
v_mul_f32 v52, v52, v133
v_mfma_f32_16x16x32_bf16 v[172:175], v[208:211], a[224:227], v[172:175]
s_mov_b32 s52, 98304
v_mul_f32 v53, v53, v133
v_mul_f32 v54, v54, v133
v_mul_f32 v55, v55, v133
v_mfma_f32_16x16x32_bf16 v[172:175], v[212:215], a[228:231], v[172:175]
s_waitcnt lgkmcnt(6)
v_mul_f32 v84, v84, v133
v_mul_f32 v85, v85, v133
v_mfma_f32_16x16x32_bf16 v[172:175], v[216:219], a[232:235], v[172:175]
s_waitcnt lgkmcnt(5)
v_mul_f32 v86, v86, v133
v_mul_f32 v87, v87, v133
v_mfma_f32_16x16x32_bf16 v[172:175], v[220:223], a[236:239], v[172:175]
buffer_load_dwordx4 v228, s[20:23], s53 offen offset:0 sc1 lds
v_mfma_f32_16x16x32_bf16 v[172:175], v[32:35], a[240:243], v[172:175]
s_waitcnt lgkmcnt(3)
v_cvt_pk_bf16_f32 v0, v144, v145
v_mul_f32 v129, v129, v133
v_mfma_f32_16x16x32_bf16 v[172:175], v[36:39], a[244:247], v[172:175]
s_waitcnt lgkmcnt(2)
v_cvt_pk_bf16_f32 v1, v146, v147
ds_read_b128 a[216:219], v228 offset:22528
v_cvt_pk_bf16_f32 v2, v48, v49
v_mfma_f32_16x16x32_bf16 v[172:175], v[40:43], a[248:251], v[172:175]
v_cvt_pk_bf16_f32 v3, v50, v51
ds_read_b128 a[220:223], v228 offset:23552
v_mfma_f32_16x16x32_bf16 v[172:175], v[44:47], a[252:255], v[172:175]
s_waitcnt lgkmcnt(2)
v_cvt_pk_bf16_f32 v4, v80, v81
v_cvt_pk_bf16_f32 v5, v82, v83
v_mfma_f32_16x16x32_bf16 v[160:163], a[128:131], a[208:211], v[160:163]
v_cvt_pk_bf16_f32 v6, v128, 0
v_cvt_pk_bf16_f32 v8, v148, v149
v_cvt_pk_bf16_f32 v9, v150, v151
v_mfma_f32_16x16x32_bf16 v[160:163], a[144:147], a[212:215], v[160:163]
v_cvt_pk_bf16_f32 v10, v52, v53
v_cvt_pk_bf16_f32 v11, v54, v55
v_mfma_f32_16x16x32_bf16 v[164:167], a[132:135], a[208:211], v[164:167]
v_mul_f32 v154, v154, v134
v_mul_f32 v155, v155, v134
v_mul_f32 v56, v56, v134
v_mfma_f32_16x16x32_bf16 v[164:167], a[148:151], a[212:215], v[164:167]
v_mul_f32 v57, v57, v134
v_cvt_pk_bf16_f32 v12, v84, v85
v_mfma_f32_16x16x32_bf16 v[168:171], a[136:139], a[208:211], v[168:171]
v_cvt_pk_bf16_f32 v13, v86, v87
v_cvt_pk_bf16_f32 v14, v129, 0
v_mfma_f32_16x16x32_bf16 v[168:171], a[152:155], a[212:215], v[168:171]
buffer_load_dwordx4 v228, s[20:23], s53 offen offset:1024 sc1 lds
v_mfma_f32_16x16x32_bf16 v[144:147], v[0:3], v[112:115], 0
s_add_u32 m0, s34, 122880
v_mul_f32 v58, v58, v134
v_mul_f32 v59, v59, v134
v_mfma_f32_16x16x32_bf16 v[144:147], v[4:7], v[116:119], v[144:147]
s_add_u32 s54, s34, 417792
v_mul_f32 v88, v88, v134
v_mul_f32 v89, v89, v134
v_mfma_f32_16x16x32_bf16 v[148:151], v[8:11], v[112:115], 0
s_waitcnt vmcnt(6) lgkmcnt(0)
s_barrier
v_mul_f32 v90, v90, v134
v_mfma_f32_16x16x32_bf16 v[148:151], v[12:15], v[116:119], v[148:151]
s_mov_b32 s53, 122880
v_mul_f32 v91, v91, v134
v_cvt_pk_bf16_f32 v64, v152, v153
v_cvt_pk_bf16_f32 v65, v154, v155
v_cvt_pk_bf16_f32 v66, v56, v57
v_cvt_pk_bf16_f32 v67, v58, v59
s_nop 1
v_mfma_f32_16x16x32_bf16 v[152:155], v[64:67], v[112:115], 0
v_mul_f32 v130, v130, v134
v_cvt_pk_bf16_f32 v68, v88, v89
v_cvt_pk_bf16_f32 v69, v90, v91
v_cvt_pk_bf16_f32 v70, v130, 0
s_nop 1
v_mfma_f32_16x16x32_bf16 v[152:155], v[68:71], v[116:119], v[152:155]
buffer_load_dwordx4 v228, s[20:23], s54 offen offset:0 sc1 lds
v_mfma_f32_16x16x32_bf16 v[156:159], v[72:75], v[112:115], 0
v_cvt_pk_bf16_f32 v250, v100, v101
v_cvt_pk_bf16_f32 v251, v102, v103
v_mfma_f32_16x16x32_bf16 v[156:159], v[76:79], v[116:119], v[156:159]
ds_read_b128 a[192:195], v228 offset:24576
v_cvt_pk_bf16_f32 v252, v104, v105
v_mfma_f32_16x16x32_bf16 v[160:163], a[160:163], a[216:219], v[160:163]
ds_read_b128 a[196:199], v228 offset:25600
v_cvt_pk_bf16_f32 v253, v106, v107
v_mfma_f32_16x16x32_bf16 v[160:163], a[176:179], a[220:223], v[160:163]
buffer_load_dwordx4 v228, s[20:23], s54 offen offset:1024 sc1 lds
v_mfma_f32_16x16x32_bf16 v[164:167], a[164:167], a[216:219], v[164:167]
v_cvt_pk_bf16_f32 v254, v108, v109
v_cvt_pk_bf16_f32 v255, v110, v111
v_mfma_f32_16x16x32_bf16 v[164:167], a[180:183], a[220:223], v[164:167]
ds_read_b128 a[200:203], v228 offset:26624
v_add_u32_dpp v176, v224, v247 row_newbcast:0 row_mask:0xf bank_mask:0xf
v_mfma_f32_16x16x32_bf16 v[168:171], a[168:171], a[216:219], v[168:171]
ds_read_b128 a[204:207], v228 offset:27648
v_add_u32_dpp v177, v224, v247 row_newbcast:4 row_mask:0xf bank_mask:0xf
v_mfma_f32_16x16x32_bf16 v[168:171], a[184:187], a[220:223], v[168:171]
buffer_load_dwordx4 v228, s[20:23], s54 offen offset:2048 sc1 lds
v_mfma_f32_16x16x32_bf16 v[48:51], v[0:3], v[120:123], 0
ds_read_b128 a[208:211], v228 offset:28672
v_add_u32_dpp v178, v224, v247 row_newbcast:8 row_mask:0xf bank_mask:0xf
v_mfma_f32_16x16x32_bf16 v[48:51], v[4:7], v[124:127], v[48:51]
ds_read_b128 a[212:215], v228 offset:29696
v_add_u32_dpp v179, v224, v247 row_newbcast:12 row_mask:0xf bank_mask:0xf
v_mfma_f32_16x16x32_bf16 v[52:55], v[8:11], v[120:123], 0
v_add_u32_dpp v180, v225, v247 row_newbcast:0 row_mask:0xf bank_mask:0xf
v_add_u32_dpp v181, v225, v247 row_newbcast:4 row_mask:0xf bank_mask:0xf
v_mfma_f32_16x16x32_bf16 v[52:55], v[12:15], v[124:127], v[52:55]
buffer_load_dwordx4 v228, s[20:23], s54 offen offset:3072 sc1 lds
v_mfma_f32_16x16x32_bf16 v[56:59], v[64:67], v[120:123], 0
s_add_u32 m0, s34, 126976
s_add_u32 s55, s34, 421888
v_cvt_pk_bf16_f32 v80, v144, v48
v_mfma_f32_16x16x32_bf16 v[56:59], v[68:71], v[124:127], v[56:59]
s_mov_b32 s54, 49152
v_cvt_pk_bf16_f32 v82, v145, v49
v_cvt_pk_bf16_f32 v84, v146, v50
v_mfma_f32_16x16x32_bf16 v[60:63], v[72:75], v[120:123], 0
v_cvt_pk_bf16_f32 v86, v147, v51
v_cvt_pk_bf16_f32 v88, v148, v52
v_mfma_f32_16x16x32_bf16 v[60:63], v[76:79], v[124:127], v[60:63]
buffer_load_dwordx4 v228, s[20:23], s55 offen offset:0 sc1 lds
v_mfma_f32_16x16x32_bf16 v[144:147], v[0:3], v[248:251], 0
v_cvt_pk_bf16_f32 v90, v149, v53
v_cvt_pk_bf16_f32 v92, v150, v54
v_mfma_f32_16x16x32_bf16 v[144:147], v[4:7], v[252:255], v[144:147]
v_cvt_pk_bf16_f32 v94, v151, v55
v_cvt_pk_bf16_f32 v192, v152, v56
v_mfma_f32_16x16x32_bf16 v[148:151], v[8:11], v[248:251], 0
v_cvt_pk_bf16_f32 v194, v153, v57
v_cvt_pk_bf16_f32 v196, v154, v58
v_mfma_f32_16x16x32_bf16 v[148:151], v[12:15], v[252:255], v[148:151]
buffer_load_dwordx4 v228, s[20:23], s55 offen offset:1024 sc1 lds
v_cvt_pk_bf16_f32 v198, v155, v59
v_mfma_f32_16x16x32_bf16 v[152:155], v[64:67], v[248:251], 0
s_mov_b32 s55, 0
v_cvt_pk_bf16_f32 v200, v156, v60
v_cvt_pk_bf16_f32 v202, v157, v61
v_mfma_f32_16x16x32_bf16 v[152:155], v[68:71], v[252:255], v[152:155]
v_cvt_pk_bf16_f32 v204, v158, v62
v_cvt_pk_bf16_f32 v206, v159, v63
v_mfma_f32_16x16x32_bf16 v[156:159], v[72:75], v[248:251], 0
v_add_u32_dpp v182, v225, v247 row_newbcast:8 row_mask:0xf bank_mask:0xf
v_add_u32_dpp v183, v225, v247 row_newbcast:12 row_mask:0xf bank_mask:0xf
v_mfma_f32_16x16x32_bf16 v[156:159], v[76:79], v[252:255], v[156:159]
v_add_u32_dpp v184, v226, v247 row_newbcast:0 row_mask:0xf bank_mask:0xf
v_add_u32_dpp v185, v226, v247 row_newbcast:4 row_mask:0xf bank_mask:0xf
v_add_u32_dpp v186, v226, v247 row_newbcast:8 row_mask:0xf bank_mask:0xf
v_add_u32_dpp v187, v226, v247 row_newbcast:12 row_mask:0xf bank_mask:0xf
v_add_u32_dpp v188, v227, v247 row_newbcast:0 row_mask:0xf bank_mask:0xf
v_add_u32_dpp v189, v227, v247 row_newbcast:4 row_mask:0xf bank_mask:0xf
v_add_u32_dpp v190, v227, v247 row_newbcast:8 row_mask:0xf bank_mask:0xf
v_add_u32_dpp v191, v227, v247 row_newbcast:12 row_mask:0xf bank_mask:0xf
s_branch L_merge
L_end:
s_endpgm

.section .rodata,"a"
.p2align 6
.amdhsa_kernel standalone__swin_window_attn__vision_kernel
  .amdhsa_next_free_vgpr 512
  .amdhsa_next_free_sgpr 102
  .amdhsa_accum_offset 256
  .amdhsa_group_segment_fixed_size 0
  .amdhsa_kernarg_size 48
  .amdhsa_user_sgpr_count 2
  .amdhsa_user_sgpr_kernarg_segment_ptr 1
  .amdhsa_system_sgpr_workgroup_id_x 1
.end_amdhsa_kernel
```
